```python
import torch

def _softmax(x, axis=-1):
    return torch.softmax(x, dim=axis)
def _gelu(x):
    return torch.nn.functional.gelu(x, approximate="tanh")
def _silu(x):
    return torch.nn.functional.silu(x)
def _sigmoid(x):
    return torch.sigmoid(x)
def _layernorm(x, axis=-1, eps=1e-5):
    m = x.mean(dim=axis, keepdim=True)
    v = x.var(dim=axis, keepdim=True, unbiased=False)
    return (x - m) / torch.sqrt(v + eps)
def _scatter_add(tgt, idx, src, axis=0):
    return tgt.clone().index_add_(axis, idx, src)
def _segment_sum(src, seg, n):
    out = torch.zeros((n,) + src.shape[1:], dtype=src.dtype)
    return out.index_add_(0, seg, src)
def _pad(x, pw):
    flat = tuple(v for pair in reversed(pw) for v in pair)
    return torch.nn.functional.pad(x, flat)

kernel_name = 'gated_mix__sliding_block__swiglu_ffn__prompt'

def setup_inputs():

    _w = (lambda a: (lambda t: t.to(torch.bfloat16) if t.is_floating_point() else t)(torch.as_tensor(a)))
    def _A_setup():
        B, S, D = 1, 2048, 512
        return {
            "x": _w((lambda *s: torch.randn(*s, dtype=torch.bfloat16) * 0.05)(B, S, D)),
            "wqkv": _w((lambda *s: torch.randn(*s, dtype=torch.bfloat16) * 0.8)(D, 3 * D)),
            "wo": _w((lambda *s: torch.randn(*s, dtype=torch.bfloat16) * 0.05)(D, D)),
        }
    _A_in = _A_setup()

    def _B_setup():
        B, S, D, F = 1, 2048, 512, 1792
        return {
            "x": _w((lambda *s: torch.randn(*s, dtype=torch.bfloat16) * 0.05)(B, S, D)),
            "w_gate": _w((lambda *s: torch.randn(*s, dtype=torch.bfloat16) * 0.2)(D, F)),
            "w_up": _w((lambda *s: torch.randn(*s, dtype=torch.bfloat16) * 0.2)(D, F)),
            "w_down": _w((lambda *s: torch.randn(*s, dtype=torch.bfloat16) * 0.2)(F, D)),
        }
    _B_in = _B_setup()

    return {
        "A_x": _A_in["x"],
        "A_wqkv": _A_in["wqkv"],
        "A_wo": _A_in["wo"],
        "B_x": _B_in["x"],
        "B_w_gate": _B_in["w_gate"],
        "B_w_up": _B_in["w_up"],
        "B_w_down": _B_in["w_down"],
        "gate_w": _w((lambda *s: torch.randn(*s, dtype=torch.bfloat16) * 0.05)(512) * 16.0),
    }

def reference(A_x, A_wqkv, A_wo, B_x, B_w_gate, B_w_up, B_w_down, gate_w):
    def _A_ref(x, wqkv, wo):
        B, S, D = x.shape
        H = 32; Dh = D // H; W = 256
        qkv = (lambda x, *d: x.permute(*d))((x @ wqkv).reshape(B, S, 3, H, Dh), 2, 0, 3, 1, 4)
        q, k, v = qkv[0], qkv[1], qkv[2]
        scores = torch.einsum("bhqd,bhkd->bhqk", q, k) * (Dh ** -0.5)
        idx = torch.arange(S)
        mask = (idx[:, None] - idx[None, :] >= 0) & (idx[:, None] - idx[None, :] < W)
        scores = torch.where(mask[None, None], scores, -1e9)
        p = _softmax(scores, axis=-1)
        o = torch.einsum("bhqk,bhkd->bhqd", p, v)
        return (lambda x, *d: x.permute(*d))(o, 0, 2, 1, 3).reshape(B, S, D) @ wo

    def _B_ref(x, w_gate, w_up, w_down):
        g = _silu(x @ w_gate)
        u = x @ w_up
        return (g * u) @ w_down

    x = A_x
    g = _sigmoid((x * gate_w).sum(-1, keepdims=True))
    a = _A_ref(x, A_wqkv, A_wo)
    b = _B_ref(x, B_w_gate, B_w_up, B_w_down)
    return g * a + (1 - g) * b
```

```asm
; @launch grid=(256,1,1) block=(256,1,1) lds=163840
.amdgcn_target "amdgcn-amd-amdhsa--gfx950"
.text
.globl gated_mix__sliding_block__swiglu_ffn__prompt_kernel
.p2align 8
.type gated_mix__sliding_block__swiglu_ffn__prompt_kernel,@function
gated_mix__sliding_block__swiglu_ffn__prompt_kernel:
  s_cmp_ge_u32 s2, 256
  s_cbranch_scc1 L_end
  s_load_dwordx16 s[4:19], s[0:1], 0
  s_load_dwordx4 s[20:23], s[0:1], 64
  s_load_dwordx2 s[24:25], s[0:1], 80
  s_getpc_b64 s[98:99]
L_pc:
  s_lshr_b32 s97, s2, 3
  s_lshl_b32 s97, s97, 4
  v_and_b32 v2, 15, v0
  v_add_u32 v2, s97, v2
  v_min_u32 v2, 298, v2
  v_lshlrev_b32 v2, 7, v2
  v_add_u32 v2, L_mainA-L_pc, v2
  v_mov_b32 v15, s99
  v_add_co_u32 v14, vcc, s98, v2
  s_nop 1
  v_addc_co_u32 v15, vcc, 0, v15, vcc
  global_load_dword v253, v[14:15], off
  v_and_b32 v3, 31, v0
  v_min_u32 v3, 16, v3
  v_lshlrev_b32 v3, 7, v3
  v_mov_b32 v17, s99
  v_add_co_u32 v16, vcc, s98, v3
  s_nop 1
  v_addc_co_u32 v17, vcc, 0, v17, vcc
  global_load_dword v254, v[16:17], off
  s_and_b32 s27, s2, 7
  s_lshr_b32 s3, s2, 3
  s_and_b32 s62, s27, 1
  s_and_b32 s63, s3, 7
  s_lshl3_add_u32 s56, s62, s63
  s_lshr_b32 s62, s3, 3
  s_mul_i32 s62, s62, 2
  v_lshrrev_b32 v1, 6, v0
  s_add_u32 s62, s62, s3
  v_and_b32 v213, 63, v0
  s_and_b32 s58, s62, 3
  v_readfirstlane_b32 s26, v1
  s_lshr_b32 s62, s62, 2
  v_lshrrev_b32 v4, 4, v213
  s_and_b32 s76, s62, 1
  v_and_b32 v8, 1, v4
  s_lshl_b32 s62, s26, 1
  v_lshrrev_b32 v2, 3, v213
  v_and_b32 v3, 7, v213
  v_lshlrev_b32 v8, 1, v8
  s_lshl_b32 s61, s26, 4
  s_add_u32 s62, s62, s76
  v_xor_b32 v5, v3, v4
  s_lshl_b32 s65, s26, 5
  v_xor_b32 v8, v3, v8
  v_add_u32 v9, s61, v2
  s_lshl_b32 s59, s62, 11
  s_add_u32 m0, s59, 0
  v_lshlrev_b32 v5, 4, v5
  v_add_u32 v6, s65, v2
  v_lshlrev_b32 v8, 4, v8
  v_mul_u32_u24 v10, 3072, v9
  v_mul_u32_u24 v11, 3584, v9
  s_lshr_b32 s72, s27, 1
  s_lshr_b32 s73, s3, 3
  s_lshl_b32 s62, s62, 10
  v_lshl_add_u32 v6, v6, 10, v5
  v_add_u32 v10, v10, v8
  v_add_u32 v11, v11, v8
  s_lshl2_add_u32 s57, s72, s73
  s_add_u32 s60, s62, 16384
  s_xor_b32 s62, s58, 0
  s_lshl_b32 s63, s62, 7
  s_mul_i32 s64, s62, 196608
  s_lshl_b32 s77, s76, 14
  v_xor_b32 v7, 64, v6
  v_xor_b32 v12, 64, v10
  v_xor_b32 v13, 64, v11
  s_lshl_b32 s75, s57, 7
  s_xor_b32 s78, s77, 16384
  v_add_u32 v7, 7168, v7
  v_add_u32 v12, 24576, v12
  v_add_u32 v13, 28672, v13
  s_lshl_b32 s74, s56, 17
  s_mov_b32 s30, 131072
  s_mov_b32 s31, 0x20000
  s_sub_u32 s34, 1572864, s75
  s_mov_b32 s35, 0x20000
  s_mov_b32 s54, 20971520
  s_mov_b32 s55, 0x20000
  v_add_u32 v196, s77, v6
  v_add_u32 v197, s77, v7
  v_add_u32 v198, s78, v6
  v_add_u32 v199, s78, v7
  s_cmp_eq_u32 s76, 0
  s_cselect_b64 vcc, -1, 0
  v_cndmask_b32 v200, v12, v10, vcc
  v_cndmask_b32 v201, v10, v12, vcc
  s_cmp_eq_u32 s76, 0
  s_cselect_b64 vcc, -1, 0
  v_cndmask_b32 v202, v13, v11, vcc
  v_cndmask_b32 v203, v11, v13, vcc
  s_waitcnt lgkmcnt(0)
  s_add_u32 s28, s4, s74
  s_addc_u32 s29, s5, 0
  buffer_load_dwordx4 v196, s[28:31], s63 offen offset:0 lds
  buffer_load_dwordx4 v197, s[28:31], s63 offen offset:1024 lds
  s_add_u32 m0, s60, 0
  s_add_u32 s32, s6, s75
  s_addc_u32 s33, s7, 0
  buffer_load_dwordx4 v200, s[32:35], s64 offen offset:0 lds
  v_lshlrev_b32 v211, 4, v213
  s_xor_b32 s11, s59, 2048
  s_xor_b32 s10, s60, 1024
  s_mov_b32 s52, s24
  s_mov_b32 s53, s25
  s_and_b32 s76, s57, 3
  s_sub_u32 s74, 2, s76
  s_cmp_ge_u32 s57, 12
  s_cselect_b32 s74, s74, s76
  s_lshr_b32 s73, s57, 2
  s_mul_i32 s75, s73, 3
  s_add_u32 s75, s75, s74
  s_add_u32 s72, s75, 16
  s_lshl_b32 s75, s73, 8
  s_add_u32 s75, s75, 2048
  s_lshl_b32 s74, s72, 7
  s_add_u32 s77, s75, 128
  s_cmp_eq_u32 s76, 3
  s_cselect_b64 s[36:37], s[6:7], s[12:13]
  s_cselect_b64 s[40:41], s[6:7], s[14:15]
  s_cselect_b32 s77, s77, s74
  s_cselect_b32 s74, s75, s74
  s_mov_b32 s75, 1572864
  s_cselect_b32 s75, s75, 1835008
  s_add_u32 s36, s36, s74
  s_addc_u32 s37, s37, 0
  s_add_u32 s40, s40, s77
  s_addc_u32 s41, s41, 0
  s_sub_u32 s38, s75, s74
  s_mov_b32 s39, 0x20000
  s_sub_u32 s42, s75, s77
  s_mov_b32 s43, 0x20000
L_walk:
  s_mov_b64 exec, 0
  s_cmp_eq_u32 s26, 0
  s_cbranch_scc1 L_pg0
  s_cmp_eq_u32 s26, 1
  s_cbranch_scc1 L_pg1
  s_cmp_eq_u32 s26, 2
  s_cbranch_scc1 L_pg2
  s_branch L_pg3
L_walked:
  s_mov_b64 exec, -1
  s_cmp_ge_u32 s2, 192
  s_cbranch_scc1 L_typeB
  s_add_u32 m0, s60, 8192
  s_mul_i32 s65, s62, 229376
  buffer_load_dwordx4 v202, s[36:39], s65 offen offset:0 lds
  s_add_u32 m0, s60, 16384
  s_nop 0
  buffer_load_dwordx4 v202, s[40:43], s65 offen offset:0 lds
  s_add_u32 m0, s11, 0
  s_nop 0
  buffer_load_dwordx4 v198, s[28:31], s63 offen offset:0 lds
  buffer_load_dwordx4 v199, s[28:31], s63 offen offset:1024 lds
  s_add_u32 m0, s10, 0
  s_nop 0
  buffer_load_dwordx4 v201, s[32:35], s64 offen offset:0 lds
  s_add_u32 m0, s10, 8192
  s_nop 0
  buffer_load_dwordx4 v203, s[36:39], s65 offen offset:0 lds
  s_add_u32 m0, s10, 16384
  s_nop 0
  buffer_load_dwordx4 v203, s[40:43], s65 offen offset:0 lds
L_typeB_back:
  global_load_dwordx4 v[142:145], v211, s[18:19]
  s_lshr_b32 s76, s26, 1
  v_lshrrev_b32 v123, 4, v213
  v_and_b32 v122, 15, v213
  v_bfe_u32 v124, v213, 1, 3
  s_lshl_b32 s100, s76, 13
  v_add_u32 v126, 0, v123
  v_lshl_add_u32 v125, v122, 7, s100
  v_xor_b32 v126, v126, v124
  v_lshl_add_u32 v204, v126, 4, v125
  v_add_u32 v126, 4, v123
  v_xor_b32 v126, v126, v124
  v_lshl_add_u32 v205, v126, 4, v125
  v_bfe_u32 v124, v213, 2, 2
  v_lshrrev_b32 v126, 1, v124
  v_and_b32 v127, 1, v123
  v_lshl_or_b32 v126, v127, 1, v126
  v_and_b32 v127, 3, v213
  v_lshlrev_b32 v127, 3, v127
  s_and_b32 s77, s26, 1
  v_lshl_add_u32 v126, v126, 5, v127
  v_lshl_add_u32 v125, v123, 3, v124
  v_lshl_add_u32 v125, v125, 7, v126
  s_lshl_b32 s100, s77, 6
  v_xor_b32 v125, s100, v125
  v_add_u32 v206, 16384, v125
  v_lshl_add_u32 v125, v123, 2, v124
  v_lshl_add_u32 v125, v125, 7, v126
  s_mul_i32 s100, s76, 4160
  v_xor_b32 v236, s100, v125
  s_lshr_b32 s100, s26, 1
  s_lshl_b32 s100, s100, 5
  s_lshl_b32 s101, s57, 1
  s_add_u32 s100, s100, s101
  s_and_b32 s101, s26, 1
  s_add_u32 s100, s100, s101
  s_lshl_b32 s100, s100, 11
  v_add_u32 v133, s100, v211
  s_lshl_b32 s100, s2, 2
  buffer_load_dwordx4 v[134:137], v133, s[28:31], 0 offen
  buffer_load_dwordx4 v[138:141], v133, s[28:31], 0 offen offset:1024
  s_add_u32 s74, s100, s26
  s_lshr_b32 s100, s74, 1
  s_and_b32 s101, s74, 1
  s_mul_i32 s100, s100, 3584
  s_lshl_b32 s101, s101, 10
  s_add_u32 s100, s100, s101
  v_and_b32 v132, 7, v213
  v_lshl_add_u32 v99, v132, 7, s100
  s_mul_i32 s100, s74, 1792
  v_min_u32 v132, 13, v213
  v_lshl_add_u32 v100, v132, 7, s100
  s_lshl_b32 s100, s74, 9
  v_and_b32 v132, 3, v213
  v_lshl_add_u32 v101, v132, 7, s100
  s_xor_b32 s100, s57, 1
  s_lshl_b32 s100, s100, 7
  v_subrev_u32 v99, s100, v99
  s_lshl_b32 s100, s56, 2
  s_lshl_b32 s101, s76, 1
  s_add_u32 s78, s100, s101
  s_lshl_b32 s100, s57, 1
  s_add_u32 s74, s100, s77
  s_lshl_b32 s100, s74, 17
  s_lshl_b32 s101, s78, 10
  s_add_u32 s67, s100, s101
  s_mul_i32 s79, s78, 147456
  s_xor_b32 s75, s57, 1
  s_add_u32 s79, s79, 6291456
  s_lshl_b32 s100, s77, 11
  s_lshl_b32 s75, s75, 7
  s_add_u32 s79, s79, s100
  s_lshl_b32 s100, s75, 5
  s_add_u32 s70, s79, s100
  s_lshl_b32 s100, s72, 12
  s_add_u32 s69, s79, s100
  s_lshl_b32 s100, s73, 2
  s_add_u32 s100, s100, s77
  s_lshl_b32 s100, s100, 17
  s_lshl_b32 s101, s78, 11
  s_add_u32 s100, s100, s101
  s_add_u32 s68, s100, 4194304
  s_lshl_b32 s100, s78, 4
  s_add_u32 s100, s100, s74
  s_lshl_b32 s100, s100, 5
  s_add_u32 s61, s100, 15794176
  s_lshl_b32 s100, s78, 7
  s_lshl_b32 s101, s74, 3
  s_add_u32 s44, s12, s75
  s_addc_u32 s45, s13, 0
  s_add_u32 s48, s14, s75
  s_addc_u32 s49, s15, 0
  s_add_u32 s100, s100, s101
  s_sub_u32 s46, 1835008, s75
  s_sub_u32 s50, 1835008, s75
  s_add_u32 s71, s100, 15728640
  s_lshl_b32 s100, s27, 2
  s_and_b32 s101, s3, 3
  s_and_b32 s75, s3, 28
  s_add_u32 s72, s100, s101
  s_add_u32 s73, s75, s26
  s_lshl_b32 s100, s72, 16
  s_lshl_b32 s101, s73, 11
  s_add_u32 s74, s100, 2094080
  s_add_u32 s1, s100, s101
  s_add_u32 s80, s24, s74
  s_addc_u32 s81, s25, 0
  s_lshr_b32 s100, s72, 1
  s_lshl_b32 s100, s100, 17
  s_add_u32 s74, s100, 4194304
  s_lshl_b32 s100, s26, 1
  s_add_u32 s84, s24, s74
  s_addc_u32 s85, s25, 0
  s_add_u32 s100, s100, s75
  s_cmp_lt_u32 s57, 8
  s_cselect_b32 s66, 0x3eb8aa3b, 1.0
  s_sub_u32 s79, s100, 4
  s_lshl_b32 s74, s79, 1
  s_cmp_lt_i32 s74, 0
  s_cselect_b32 s57, 1024, 0
  s_cselect_b32 s100, 0, 0x3f803f80
  v_mov_b32 v214, s100
  v_and_b32 v126, 7, v213
  v_lshlrev_b32 v127, 1, v123
  v_lshrrev_b32 v130, 5, v213
  s_lshl_b32 s100, s74, 10
  v_xor_b32 v126, v126, v127
  v_lshlrev_b32 v218, 9, v130
  v_add_u32 v131, s100, v211
  v_lshlrev_b32 v126, 4, v126
  v_lshrrev_b32 v127, 3, v213
  v_max_i32 v219, v131, v218
  v_lshl_add_u32 v232, v127, 10, v126
  s_and_b32 s100, s72, 1
  v_and_b32 v131, 15, v213
  s_lshl_b32 s100, s100, 8
  s_lshl_b32 s101, s74, 11
  v_lshl_add_u32 v131, v131, 4, v218
  v_bfe_u32 v126, v213, 4, 1
  s_add_u32 s100, s100, s101
  v_lshl_add_u32 v131, v126, 10, v131
  v_add_u32 v131, s100, v131
  s_lshl_b32 s100, s26, 11
  s_add_u32 s100, s100, 122880
  v_add_u32 v238, s100, v211
  s_and_b32 s100, s72, 30
  s_and_b32 s101, s72, 1
  s_lshl_b32 s100, s100, 10
  s_lshl_b32 s101, s101, 9
  s_add_u32 s100, s100, s101
  s_mul_i32 s0, s73, 294912
  s_add_u32 s100, s100, 6406144
  v_min_u32 v220, 0x7ffffff0, v131
  s_add_u32 s0, s0, s100
  v_and_b32 v131, 15, v213
  s_lshl_b32 s100, s73, 8
  v_lshlrev_b32 v131, 4, v131
  v_bfe_u32 v126, v213, 4, 1
  s_add_u32 s13, s100, 15728640
  s_lshr_b32 s74, s72, 1
  v_lshl_add_u32 v131, v126, 10, v131
  s_and_b32 s100, s72, 24
  s_and_b32 s101, s74, 1
  v_lshrrev_b32 v126, 1, v218
  s_add_u32 s100, s100, s101
  v_add_u32 v210, v131, v126
  s_add_u32 s100, s100, 1030
  s_add_u32 s74, s74, 16
  v_mov_b32 v126, s100
  v_mov_b32 v131, s74
  v_and_b32 v127, 1, v213
  v_cmp_gt_u32 vcc, 48, v213
  s_nop 1
  v_cndmask_b32 v126, v126, v131, vcc
  v_add_u32 v127, s79, v127
  v_max_i32 v127, 0, v127
  v_lshlrev_b32 v127, 5, v127
  v_and_b32 v129, 31, v213
  v_add_u32 v127, v126, v127
  s_lshl_b32 s100, s73, 5
  v_add_u32 v126, s100, v129
  v_cmp_gt_u32 vcc, 32, v213
  s_nop 1
  v_cndmask_b32 v126, v127, v126, vcc
  v_lshlrev_b32 v246, 5, v126
  s_add_u32 s100, s100, s72
  v_mov_b32 v128, 0x7ffffff0
  v_lshlrev_b32 v130, 2, v130
  s_lshl_b32 s100, s100, 5
  v_subrev_u32 v131, 41216, v238
  v_and_b32 v126, 16, v213
  v_cmp_eq_u32 vcc, 0, v213
  s_nop 1
  v_cndmask_b32 v252, v128, v213, vcc
  v_cmp_eq_u32 vcc, 31, v129
  s_nop 1
  v_cndmask_b32 v212, v128, v130, vcc
  s_add_u32 s78, s100, 15925248
  v_cmp_eq_u32 vcc, 0, v126
  s_nop 1
  v_cndmask_b32 v222, v131, v238, vcc
  s_lshl_b32 s100, s26, 12
  s_add_u32 s100, s100, 98304
  v_xor_b32 v207, 32, v206
  s_mov_b64 s[4:5], s[16:17]
  s_mov_b64 s[6:7], s[8:9]
  s_mov_b32 s47, 0x20000
  s_mov_b32 s51, 0x20000
  v_lshlrev_b32 v223, 2, v129
  s_mov_b32 s82, 68608
  s_mov_b32 s83, 0x20000
  s_mov_b32 s86, 131072
  s_mov_b32 s87, 0x20000
  v_add_u32 v221, s100, v211
  s_xor_b32 s62, s58, 1
  s_add_u32 m0, s59, 40960
  s_lshl_b32 s63, s62, 7
  buffer_load_dwordx4 v196, s[28:31], s63 offen offset:0 lds
  buffer_load_dwordx4 v197, s[28:31], s63 offen offset:1024 lds
  s_add_u32 m0, s60, 40960
  s_mul_i32 s64, s62, 196608
  buffer_load_dwordx4 v200, s[32:35], s64 offen offset:0 lds
  s_or_b32 s100, s2, s26
  s_cmp_lg_u32 s100, 0
  s_cbranch_scc1 L_notag
  s_memrealtime s[100:101]
  s_waitcnt lgkmcnt(0)
  s_or_b32 s100, s100, 1
  s_or_b32 s101, s101, 0x80000000
  v_mov_b32 v0, s100
  v_mov_b32 v1, s101
  v_mov_b32 v2, 0
  s_mov_b64 exec, 1
  global_store_dwordx2 v2, v[0:1], s[22:23] sc1
  s_mov_b64 exec, -1
L_notag:
  s_cmp_ge_u32 s2, 192
  s_cbranch_scc1 L_mainB
  s_branch L_mainA
L_typeB:
  s_add_u32 m0, s60, 8192
  s_nop 0
  buffer_load_dwordx4 v200, s[36:39], s64 offen offset:0 lds
  s_add_u32 m0, s60, 16384
  s_nop 0
  buffer_load_dwordx4 v200, s[40:43], s64 offen offset:0 lds
  s_add_u32 m0, s11, 0
  s_nop 0
  buffer_load_dwordx4 v198, s[28:31], s63 offen offset:0 lds
  buffer_load_dwordx4 v199, s[28:31], s63 offen offset:1024 lds
  s_add_u32 m0, s10, 0
  s_nop 0
  buffer_load_dwordx4 v201, s[32:35], s64 offen offset:0 lds
  s_add_u32 m0, s10, 8192
  s_nop 0
  buffer_load_dwordx4 v201, s[36:39], s64 offen offset:0 lds
  s_add_u32 m0, s10, 16384
  s_nop 0
  buffer_load_dwordx4 v201, s[40:43], s64 offen offset:0 lds
  s_branch L_typeB_back
.p2align 12
L_mainA:
L_pg0:
  s_cbranch_execz L_pg4
  s_waitcnt vmcnt(6)
  s_barrier
  ds_read_b128 a[0:3], v204 offset:0
  ds_read_b64_tr_b16 v[160:161], v206 offset:0
  ds_read_b64_tr_b16 v[162:163], v206 offset:512
  ds_read_b128 a[4:7], v204 offset:2048
  ds_read_b128 a[8:11], v204 offset:4096
  ds_read_b128 a[12:15], v204 offset:6144
  ds_read_b64_tr_b16 v[164:165], v207 offset:0
  ds_read_b64_tr_b16 v[166:167], v207 offset:512
  ds_read_b64_tr_b16 v[168:169], v206 offset:8192
  ds_read_b64_tr_b16 v[170:171], v206 offset:8704
  ds_read_b64_tr_b16 v[172:173], v207 offset:8192
  ds_read_b64_tr_b16 v[174:175], v207 offset:8704
  s_add_u32 m0, s60, 49152
  s_mul_i32 s65, s62, 229376
  s_xor_b32 s62, s58, 2
  s_lshr_b32 s100, s27, 1
  s_lshl_b32 s100, s100, 2
  s_and_b32 s101, s3, 3
  s_add_u32 s73, s100, s101
  s_lshr_b32 s100, s3, 2
  s_lshl_b32 s75, s100, 7
  s_and_b32 s72, s27, 1
  s_lshl_b32 s100, s73, 1
  s_add_u32 s74, s100, s72
  s_add_u32 s88, s16, s75
  s_addc_u32 s89, s17, 0
  s_add_u32 s92, s8, s75
  s_addc_u32 s93, s9, 0
  s_sub_u32 s90, 1835008, s75
  s_waitcnt lgkmcnt(9)
  v_mfma_f32_16x16x32_bf16 v[0:3], v[160:163], a[0:3], 0
  s_waitcnt lgkmcnt(8)
  s_sub_u32 s94, 524288, s75
  v_mfma_f32_16x16x32_bf16 v[8:11], v[160:163], a[4:7], 0
  s_waitcnt lgkmcnt(7)
  buffer_load_dwordx4 v202, s[36:39], s65 offen offset:0 lds
  v_mfma_f32_16x16x32_bf16 v[16:19], v[160:163], a[8:11], 0
  s_waitcnt lgkmcnt(6)
  s_add_u32 m0, s60, 57344
  v_mfma_f32_16x16x32_bf16 v[24:27], v[160:163], a[12:15], 0
  s_waitcnt lgkmcnt(4)
  s_lshl_b32 s100, s74, 16
  v_mfma_f32_16x16x32_bf16 v[4:7], v[164:167], a[0:3], 0
  buffer_load_dwordx4 v202, s[40:43], s65 offen offset:0 lds
  s_add_u32 m0, s11, 40960
  v_mfma_f32_16x16x32_bf16 v[12:15], v[164:167], a[4:7], 0
  s_xor_b32 s79, s74, 1
  s_add_u32 s75, s100, s75
  v_mfma_f32_16x16x32_bf16 v[20:23], v[164:167], a[8:11], 0
  buffer_load_dwordx4 v198, s[28:31], s63 offen offset:0 lds
  s_lshl_b32 s100, s79, 1
  v_mfma_f32_16x16x32_bf16 v[28:31], v[164:167], a[12:15], 0
  s_waitcnt lgkmcnt(0)
  ds_read_b64_tr_b16 v[176:177], v206 offset:16384
  v_mfma_f32_16x16x32_bf16 v[32:35], v[168:171], a[0:3], 0
  ds_read_b64_tr_b16 v[178:179], v206 offset:16896
  s_sub_u32 s98, 2097152, s75
  v_mfma_f32_16x16x32_bf16 v[40:43], v[168:171], a[4:7], 0
  buffer_load_dwordx4 v199, s[28:31], s63 offen offset:1024 lds
  s_add_u32 m0, s10, 40960
  v_mfma_f32_16x16x32_bf16 v[48:51], v[168:171], a[8:11], 0
  ds_read_b64_tr_b16 v[180:181], v207 offset:16384
  ds_read_b64_tr_b16 v[182:183], v207 offset:16896
  v_mfma_f32_16x16x32_bf16 v[56:59], v[168:171], a[12:15], 0
  buffer_load_dwordx4 v201, s[32:35], s64 offen offset:0 lds
  s_add_u32 m0, s10, 49152
  v_mfma_f32_16x16x32_bf16 v[36:39], v[172:175], a[0:3], 0
  s_lshl_b32 s63, s62, 7
  ds_read_b128 a[16:19], v205 offset:0
  v_mfma_f32_16x16x32_bf16 v[44:47], v[172:175], a[4:7], 0
  ds_read_b64_tr_b16 v[184:185], v206 offset:4096
  s_mul_i32 s64, s62, 196608
  v_mfma_f32_16x16x32_bf16 v[52:55], v[172:175], a[8:11], 0
  buffer_load_dwordx4 v203, s[36:39], s65 offen offset:0 lds
  s_add_u32 m0, s10, 57344
  v_mfma_f32_16x16x32_bf16 v[60:63], v[172:175], a[12:15], 0
  s_waitcnt lgkmcnt(4)
  ds_read_b64_tr_b16 v[186:187], v206 offset:4608
  v_mfma_f32_16x16x32_bf16 v[64:67], v[176:179], a[0:3], 0
  ds_read_b128 a[20:23], v205 offset:2048
  s_add_u32 s100, s100, s77
  v_mfma_f32_16x16x32_bf16 v[72:75], v[176:179], a[4:7], 0
  buffer_load_dwordx4 v203, s[40:43], s65 offen offset:0 lds
  s_add_u32 m0, s59, 81920
  v_mfma_f32_16x16x32_bf16 v[80:83], v[176:179], a[8:11], 0
  ds_read_b128 a[24:27], v205 offset:4096
  s_mul_i32 s65, s62, 229376
  v_mfma_f32_16x16x32_bf16 v[88:91], v[176:179], a[12:15], 0
  s_waitcnt lgkmcnt(5)
  buffer_load_dwordx4 v196, s[28:31], s63 offen offset:0 lds
  v_mfma_f32_16x16x32_bf16 v[68:71], v[180:183], a[0:3], 0
  ds_read_b128 a[28:31], v205 offset:6144
  s_xor_b32 s62, s58, 3
  v_mfma_f32_16x16x32_bf16 v[76:79], v[180:183], a[4:7], 0
  ds_read_b64_tr_b16 v[188:189], v207 offset:4096
  s_mul_i32 s101, s77, 196608
  v_mfma_f32_16x16x32_bf16 v[84:87], v[180:183], a[8:11], 0
  buffer_load_dwordx4 v197, s[28:31], s63 offen offset:1024 lds
  s_add_u32 m0, s60, 81920
  v_mfma_f32_16x16x32_bf16 v[92:95], v[180:183], a[12:15], 0
  s_waitcnt lgkmcnt(4)
  ds_read_b64_tr_b16 v[190:191], v207 offset:4608
  v_mfma_f32_16x16x32_bf16 v[0:3], v[184:187], a[16:19], v[0:3]
  s_waitcnt lgkmcnt(4)
  ds_read_b64_tr_b16 v[160:161], v206 offset:12288
  v_mfma_f32_16x16x32_bf16 v[8:11], v[184:187], a[20:23], v[8:11]
  s_waitcnt lgkmcnt(4)
  buffer_load_dwordx4 v200, s[32:35], s64 offen offset:0 lds
  v_mfma_f32_16x16x32_bf16 v[16:19], v[184:187], a[24:27], v[16:19]
  s_add_u32 m0, s60, 90112
  ds_read_b64_tr_b16 v[162:163], v206 offset:12800
  ds_read_b64_tr_b16 v[164:165], v207 offset:12288
  s_waitcnt lgkmcnt(5)
  v_mfma_f32_16x16x32_bf16 v[24:27], v[184:187], a[28:31], v[24:27]
  buffer_load_dwordx4 v202, s[36:39], s65 offen offset:0 lds
  s_add_u32 m0, s60, 98304
  ds_read_b64_tr_b16 v[166:167], v207 offset:12800
  ds_read_b64_tr_b16 v[168:169], v206 offset:20480
  s_add_u32 s96, s20, s75
  s_addc_u32 s97, s21, 0
  ds_read_b64_tr_b16 v[170:171], v206 offset:20992
  s_mul_i32 s75, s100, 147456
  s_sub_u32 s100, s74, s79
  s_mul_i32 s21, s100, 294912
  s_waitcnt lgkmcnt(6)
  v_mfma_f32_16x16x32_bf16 v[4:7], v[188:191], a[16:19], v[4:7]
  ds_read_b64_tr_b16 v[172:173], v207 offset:20480
  ds_read_b64_tr_b16 v[174:175], v207 offset:20992
  v_mfma_f32_16x16x32_bf16 v[12:15], v[188:191], a[20:23], v[12:15]
  s_mul_i32 s100, s72, 24576
  s_add_u32 s73, s100, 65536
  v_mfma_f32_16x16x32_bf16 v[20:23], v[188:191], a[24:27], v[20:23]
  buffer_load_dwordx4 v202, s[40:43], s65 offen offset:0 lds
  s_add_u32 m0, s11, 81920
  v_mfma_f32_16x16x32_bf16 v[28:31], v[188:191], a[28:31], v[28:31]
  s_waitcnt lgkmcnt(6)
  s_mul_i32 s100, s76, 12288
  v_mfma_f32_16x16x32_bf16 v[32:35], v[160:163], a[16:19], v[32:35]
  buffer_load_dwordx4 v198, s[28:31], s63 offen offset:0 lds
  s_add_u32 s75, s75, 6291456
  v_mfma_f32_16x16x32_bf16 v[40:43], v[160:163], a[20:23], v[40:43]
  s_add_u32 s100, s100, s73
  s_add_u32 s18, s100, s75
  v_mfma_f32_16x16x32_bf16 v[48:51], v[160:163], a[24:27], v[48:51]
  s_lshl_b32 s100, s73, 4
  s_add_u32 s100, s100, s101
  v_mfma_f32_16x16x32_bf16 v[56:59], v[160:163], a[28:31], v[56:59]
  s_waitcnt lgkmcnt(3)
  buffer_load_dwordx4 v199, s[28:31], s63 offen offset:1024 lds
  v_mfma_f32_16x16x32_bf16 v[36:39], v[164:167], a[16:19], v[36:39]
  s_waitcnt vmcnt(7) lgkmcnt(0)
  s_barrier
  v_mfma_f32_16x16x32_bf16 v[44:47], v[164:167], a[20:23], v[44:47]
  s_add_u32 m0, s10, 81920
  ds_read_b128 a[32:35], v204 offset:40960
  v_mfma_f32_16x16x32_bf16 v[52:55], v[164:167], a[24:27], v[52:55]
  buffer_load_dwordx4 v201, s[32:35], s64 offen offset:0 lds
  s_add_u32 m0, s10, 90112
  v_mfma_f32_16x16x32_bf16 v[60:63], v[164:167], a[28:31], v[60:63]
  ds_read_b64_tr_b16 v[176:177], v206 offset:40960
  ds_read_b64_tr_b16 v[178:179], v206 offset:41472
  v_mfma_f32_16x16x32_bf16 v[64:67], v[168:171], a[16:19], v[64:67]
  buffer_load_dwordx4 v203, s[36:39], s65 offen offset:0 lds
  s_add_u32 m0, s10, 98304
  v_mfma_f32_16x16x32_bf16 v[72:75], v[168:171], a[20:23], v[72:75]
  s_lshl_b32 s63, s62, 7
  ds_read_b128 a[36:39], v204 offset:43008
  v_mfma_f32_16x16x32_bf16 v[80:83], v[168:171], a[24:27], v[80:83]
  ds_read_b128 a[40:43], v204 offset:45056
  s_mul_i32 s64, s62, 196608
  v_mfma_f32_16x16x32_bf16 v[88:91], v[168:171], a[28:31], v[88:91]
  buffer_load_dwordx4 v203, s[40:43], s65 offen offset:0 lds
  s_add_u32 m0, s59, 122880
  v_mfma_f32_16x16x32_bf16 v[68:71], v[172:175], a[16:19], v[68:71]
  ds_read_b128 a[44:47], v204 offset:47104
  s_mul_i32 s65, s62, 229376
  v_mfma_f32_16x16x32_bf16 v[76:79], v[172:175], a[20:23], v[76:79]
  buffer_load_dwordx4 v196, s[28:31], s63 offen offset:0 lds
  s_xor_b32 s62, s58, 4
  v_mfma_f32_16x16x32_bf16 v[84:87], v[172:175], a[24:27], v[84:87]
  ds_read_b64_tr_b16 v[180:181], v207 offset:40960
  v_add_u32 v204, 0x14000, v204
  v_mfma_f32_16x16x32_bf16 v[92:95], v[172:175], a[28:31], v[92:95]
  s_waitcnt lgkmcnt(4)
  ds_read_b64_tr_b16 v[182:183], v207 offset:41472
  v_mfma_f32_16x16x32_bf16 v[0:3], v[176:179], a[32:35], v[0:3]
  buffer_load_dwordx4 v197, s[28:31], s63 offen offset:1024 lds
  s_waitcnt lgkmcnt(4)
  v_mfma_f32_16x16x32_bf16 v[8:11], v[176:179], a[36:39], v[8:11]
  s_waitcnt lgkmcnt(3)
  s_add_u32 m0, s60, 122880
  v_mfma_f32_16x16x32_bf16 v[16:19], v[176:179], a[40:43], v[16:19]
  ds_read_b64_tr_b16 v[184:185], v206 offset:49152
  ds_read_b64_tr_b16 v[186:187], v206 offset:49664
  s_lshl_b32 s101, s76, 15
  s_waitcnt lgkmcnt(4)
  v_mfma_f32_16x16x32_bf16 v[24:27], v[176:179], a[44:47], v[24:27]
  buffer_load_dwordx4 v200, s[32:35], s64 offen offset:0 lds
  s_add_u32 m0, s60, 131072
  ds_read_b64_tr_b16 v[188:189], v207 offset:49152
  ds_read_b64_tr_b16 v[190:191], v207 offset:49664
  s_add_u32 s14, s100, s101
  ds_read_b64_tr_b16 v[160:161], v206 offset:57344
  s_add_u32 s16, s14, 0
  s_lshl_b32 s100, s77, 18
  s_add_u32 s27, s100, s101
  ds_read_b64_tr_b16 v[162:163], v206 offset:57856
  s_waitcnt lgkmcnt(6)
  v_mfma_f32_16x16x32_bf16 v[4:7], v[180:183], a[32:35], v[4:7]
  ds_read_b64_tr_b16 v[164:165], v207 offset:57344
  s_lshl_b32 s73, s72, 15
  v_mfma_f32_16x16x32_bf16 v[12:15], v[180:183], a[36:39], v[12:15]
  buffer_load_dwordx4 v202, s[36:39], s65 offen offset:0 lds
  s_add_u32 m0, s60, 139264
  v_mfma_f32_16x16x32_bf16 v[20:23], v[180:183], a[40:43], v[20:23]
  ds_read_b64_tr_b16 v[166:167], v207 offset:57856
  ds_read_b128 a[48:51], v205 offset:40960
  v_mfma_f32_16x16x32_bf16 v[28:31], v[180:183], a[44:47], v[28:31]
  s_waitcnt lgkmcnt(7)
  s_lshl_b32 s100, s76, 14
  v_mfma_f32_16x16x32_bf16 v[32:35], v[184:187], a[32:35], v[32:35]
  buffer_load_dwordx4 v202, s[40:43], s65 offen offset:0 lds
  s_add_u32 m0, s11, 122880
  v_mfma_f32_16x16x32_bf16 v[40:43], v[184:187], a[36:39], v[40:43]
  ds_read_b64_tr_b16 v[168:169], v206 offset:45056
  ds_read_b64_tr_b16 v[170:171], v206 offset:45568
  v_mfma_f32_16x16x32_bf16 v[48:51], v[184:187], a[40:43], v[48:51]
  buffer_load_dwordx4 v198, s[28:31], s63 offen offset:0 lds
  ds_read_b128 a[52:55], v205 offset:43008
  v_mfma_f32_16x16x32_bf16 v[56:59], v[184:187], a[44:47], v[56:59]
  s_waitcnt lgkmcnt(8)
  s_add_u32 s101, s100, s73
  v_mfma_f32_16x16x32_bf16 v[36:39], v[188:191], a[32:35], v[36:39]
  ds_read_b128 a[56:59], v205 offset:45056
  s_add_u32 s100, s100, 114688
  v_mfma_f32_16x16x32_bf16 v[44:47], v[188:191], a[36:39], v[44:47]
  buffer_load_dwordx4 v199, s[28:31], s63 offen offset:1024 lds
  s_add_u32 m0, s10, 122880
  v_mfma_f32_16x16x32_bf16 v[52:55], v[188:191], a[40:43], v[52:55]
  s_lshl_b32 s63, s62, 7
  ds_read_b128 a[60:63], v205 offset:47104
  v_mfma_f32_16x16x32_bf16 v[60:63], v[188:191], a[44:47], v[60:63]
  s_waitcnt lgkmcnt(7)
  v_add_u32 v205, 0x14000, v205
  v_mfma_f32_16x16x32_bf16 v[64:67], v[160:163], a[32:35], v[64:67]
  buffer_load_dwordx4 v201, s[32:35], s64 offen offset:0 lds
  s_add_u32 m0, s10, 131072
  v_mfma_f32_16x16x32_bf16 v[72:75], v[160:163], a[36:39], v[72:75]
  ds_read_b64_tr_b16 v[172:173], v207 offset:45056
  ds_read_b64_tr_b16 v[174:175], v207 offset:45568
  v_mfma_f32_16x16x32_bf16 v[80:83], v[160:163], a[40:43], v[80:83]
  buffer_load_dwordx4 v203, s[36:39], s65 offen offset:0 lds
  s_add_u32 m0, s10, 139264
  v_mfma_f32_16x16x32_bf16 v[88:91], v[160:163], a[44:47], v[88:91]
  s_waitcnt lgkmcnt(5)
  s_mul_i32 s64, s62, 196608
  v_mfma_f32_16x16x32_bf16 v[68:71], v[164:167], a[32:35], v[68:71]
  ds_read_b64_tr_b16 v[176:177], v206 offset:53248
  ds_read_b64_tr_b16 v[178:179], v206 offset:53760
  v_mfma_f32_16x16x32_bf16 v[76:79], v[164:167], a[36:39], v[76:79]
  buffer_load_dwordx4 v203, s[40:43], s65 offen offset:0 lds
  s_add_u32 m0, s59, 0
  v_mfma_f32_16x16x32_bf16 v[84:87], v[164:167], a[40:43], v[84:87]
  s_mul_i32 s65, s62, 229376
  ds_read_b64_tr_b16 v[180:181], v207 offset:53248
  v_mfma_f32_16x16x32_bf16 v[92:95], v[164:167], a[44:47], v[92:95]
  buffer_load_dwordx4 v196, s[28:31], s63 offen offset:0 lds
  ds_read_b64_tr_b16 v[182:183], v207 offset:53760
  v_mfma_f32_16x16x32_bf16 v[0:3], v[168:171], a[48:51], v[0:3]
  s_waitcnt lgkmcnt(6)
  ds_read_b64_tr_b16 v[184:185], v206 offset:61440
  v_mfma_f32_16x16x32_bf16 v[8:11], v[168:171], a[52:55], v[8:11]
  ds_read_b64_tr_b16 v[186:187], v206 offset:61952
  ds_read_b64_tr_b16 v[188:189], v207 offset:61440
  v_mfma_f32_16x16x32_bf16 v[16:19], v[168:171], a[56:59], v[16:19]
  buffer_load_dwordx4 v197, s[28:31], s63 offen offset:1024 lds
  s_add_u32 m0, s60, 0
  v_mfma_f32_16x16x32_bf16 v[24:27], v[168:171], a[60:63], v[24:27]
  s_waitcnt lgkmcnt(7)
  ds_read_b64_tr_b16 v[190:191], v207 offset:61952
  v_mfma_f32_16x16x32_bf16 v[4:7], v[172:175], a[48:51], v[4:7]
  buffer_load_dwordx4 v200, s[32:35], s64 offen offset:0 lds
  s_add_u32 m0, s60, 8192
  v_mfma_f32_16x16x32_bf16 v[12:15], v[172:175], a[52:55], v[12:15]
  v_add_u32 v206, 0x14000, v206
  v_add_u32 v207, 0x14000, v207
  v_mfma_f32_16x16x32_bf16 v[20:23], v[172:175], a[56:59], v[20:23]
  s_xor_b32 s62, s58, 5
  s_add_u32 s100, s100, s75
  v_mfma_f32_16x16x32_bf16 v[28:31], v[172:175], a[60:63], v[28:31]
  s_waitcnt lgkmcnt(6)
  buffer_load_dwordx4 v202, s[36:39], s65 offen offset:0 lds
  v_mfma_f32_16x16x32_bf16 v[32:35], v[176:179], a[48:51], v[32:35]
  s_add_u32 m0, s60, 16384
  buffer_load_dword v102, v99, s[44:47], 0 offen
  v_mfma_f32_16x16x32_bf16 v[40:43], v[176:179], a[52:55], v[40:43]
  buffer_load_dword v103, v99, s[48:51], 0 offen
  s_add_u32 s9, s100, s21
  v_mfma_f32_16x16x32_bf16 v[48:51], v[176:179], a[56:59], v[48:51]
  s_lshl_b32 s100, s73, 4
  s_add_u32 s15, s27, s100
  v_mfma_f32_16x16x32_bf16 v[56:59], v[176:179], a[60:63], v[56:59]
  s_waitcnt lgkmcnt(1)
  s_mov_b32 s25, s78
  v_mfma_f32_16x16x32_bf16 v[36:39], v[180:183], a[48:51], v[36:39]
  s_waitcnt vmcnt(16) lgkmcnt(0)
  s_barrier
  v_mfma_f32_16x16x32_bf16 v[44:47], v[180:183], a[52:55], v[44:47]
  buffer_load_dwordx4 v202, s[40:43], s65 offen offset:0 lds
  s_add_u32 m0, s11, 0
  v_mfma_f32_16x16x32_bf16 v[52:55], v[180:183], a[56:59], v[52:55]
  ds_read_b128 a[64:67], v204 offset:0
  s_lshl_b32 s100, s74, 1
  v_mfma_f32_16x16x32_bf16 v[60:63], v[180:183], a[60:63], v[60:63]
  ds_read_b64_tr_b16 v[160:161], v206 offset:0
  s_add_u32 s78, s100, s77
  v_mfma_f32_16x16x32_bf16 v[64:67], v[184:187], a[48:51], v[64:67]
  buffer_load_dwordx4 v198, s[28:31], s63 offen offset:0 lds
  ds_read_b64_tr_b16 v[162:163], v206 offset:512
  v_mfma_f32_16x16x32_bf16 v[72:75], v[184:187], a[52:55], v[72:75]
  ds_read_b128 a[68:71], v204 offset:2048
  s_lshl_b32 s100, s78, 7
  v_mfma_f32_16x16x32_bf16 v[80:83], v[184:187], a[56:59], v[80:83]
  s_add_u32 s19, s101, s75
  s_add_u32 s20, s100, 15728640
  v_mfma_f32_16x16x32_bf16 v[88:91], v[184:187], a[60:63], v[88:91]
  ds_read_b128 a[72:75], v204 offset:4096
  s_lshl_b32 s100, s77, 15
  v_mfma_f32_16x16x32_bf16 v[68:71], v[188:191], a[48:51], v[68:71]
  s_lshl_b32 s101, s76, 6
  s_add_u32 s24, s100, s101
  v_mfma_f32_16x16x32_bf16 v[76:79], v[188:191], a[52:55], v[76:79]
  buffer_load_dwordx4 v199, s[28:31], s63 offen offset:1024 lds
  s_add_u32 m0, s10, 0
  v_mfma_f32_16x16x32_bf16 v[84:87], v[188:191], a[56:59], v[84:87]
  ds_read_b128 a[76:79], v204 offset:6144
  s_lshl_b32 s63, s62, 7
  v_mfma_f32_16x16x32_bf16 v[92:95], v[188:191], a[60:63], v[92:95]
  ds_read_b64_tr_b16 v[164:165], v207 offset:0
  s_waitcnt lgkmcnt(4)
  v_mfma_f32_16x16x32_bf16 v[0:3], v[160:163], a[64:67], v[0:3]
  s_waitcnt lgkmcnt(3)
  ds_read_b64_tr_b16 v[166:167], v207 offset:512
  v_mfma_f32_16x16x32_bf16 v[8:11], v[160:163], a[68:71], v[8:11]
  ds_read_b64_tr_b16 v[168:169], v206 offset:8192
  s_mul_i32 s100, s76, 40960
  s_lshl_b32 s101, s77, 12
  s_waitcnt lgkmcnt(4)
  v_mfma_f32_16x16x32_bf16 v[16:19], v[160:163], a[72:75], v[16:19]
  buffer_load_dwordx4 v201, s[32:35], s64 offen offset:0 lds
  s_add_u32 m0, s10, 8192
  ds_read_b64_tr_b16 v[170:171], v206 offset:8704
  ds_read_b64_tr_b16 v[172:173], v207 offset:8192
  s_mul_i32 s64, s62, 196608
  ds_read_b64_tr_b16 v[174:175], v207 offset:8704
  s_add_u32 s100, s100, s101
  s_add_u32 s8, s100, 32768
  s_lshl_b32 s100, s2, 2
  s_waitcnt lgkmcnt(6)
  v_mfma_f32_16x16x32_bf16 v[24:27], v[160:163], a[76:79], v[24:27]
  ds_read_b64_tr_b16 v[176:177], v206 offset:16384
  ds_read_b64_tr_b16 v[178:179], v206 offset:16896
  s_add_u32 s78, s100, s26
  s_lshl_b32 s100, s78, 12
  s_add_u32 s56, s100, 16777216
  ds_read_b64_tr_b16 v[180:181], v207 offset:16384
  s_waitcnt lgkmcnt(7)
  v_mfma_f32_16x16x32_bf16 v[4:7], v[164:167], a[64:67], v[4:7]
  ds_read_b64_tr_b16 v[182:183], v207 offset:16896
  s_and_b32 s100, s74, 30
  v_mfma_f32_16x16x32_bf16 v[12:15], v[164:167], a[68:71], v[12:15]
  ds_read_b128 a[80:83], v205 offset:0
  s_lshl_b32 s100, s100, 5
  v_mfma_f32_16x16x32_bf16 v[20:23], v[164:167], a[72:75], v[20:23]
  s_lshl_b32 s101, s72, 4
  s_add_u32 s100, s100, s101
  v_mfma_f32_16x16x32_bf16 v[28:31], v[164:167], a[76:79], v[28:31]
  s_waitcnt lgkmcnt(7)
  buffer_load_dwordx4 v203, s[36:39], s65 offen offset:0 lds
  v_mfma_f32_16x16x32_bf16 v[32:35], v[168:171], a[64:67], v[32:35]
  s_add_u32 m0, s10, 16384
  ds_read_b64_tr_b16 v[184:185], v206 offset:4096
  v_mfma_f32_16x16x32_bf16 v[40:43], v[168:171], a[68:71], v[40:43]
  ds_read_b64_tr_b16 v[186:187], v206 offset:4608
  ds_read_b128 a[84:87], v205 offset:2048
  v_mfma_f32_16x16x32_bf16 v[48:51], v[168:171], a[72:75], v[48:51]
  s_lshl_b32 s101, s76, 3
  s_add_u32 s100, s100, s101
  v_mfma_f32_16x16x32_bf16 v[56:59], v[168:171], a[76:79], v[56:59]
  s_waitcnt lgkmcnt(8)
  ds_read_b128 a[88:91], v205 offset:4096
  v_mfma_f32_16x16x32_bf16 v[36:39], v[172:175], a[64:67], v[36:39]
  buffer_load_dwordx4 v203, s[40:43], s65 offen offset:0 lds
  s_add_u32 m0, s59, 40960
  v_mfma_f32_16x16x32_bf16 v[44:47], v[172:175], a[68:71], v[44:47]
  ds_read_b128 a[92:95], v205 offset:6144
  s_mul_i32 s65, s62, 229376
  v_mfma_f32_16x16x32_bf16 v[52:55], v[172:175], a[72:75], v[52:55]
  s_xor_b32 s62, s58, 6
  v_and_b32 v131, 8, v213
  v_mfma_f32_16x16x32_bf16 v[60:63], v[172:175], a[76:79], v[60:63]
  s_waitcnt lgkmcnt(5)
  ds_read_b64_tr_b16 v[188:189], v207 offset:4096
  v_mfma_f32_16x16x32_bf16 v[64:67], v[176:179], a[64:67], v[64:67]
  buffer_load_dwordx4 v196, s[28:31], s63 offen offset:0 lds
  ds_read_b64_tr_b16 v[190:191], v207 offset:4608
  v_mfma_f32_16x16x32_bf16 v[72:75], v[176:179], a[68:71], v[72:75]
  ds_read_b64_tr_b16 v[160:161], v206 offset:12288
  v_lshl_add_u32 v131, v131, 2, s100
  v_mfma_f32_16x16x32_bf16 v[80:83], v[176:179], a[72:75], v[80:83]
  ds_read_b64_tr_b16 v[162:163], v206 offset:12800
  v_and_b32 v127, 7, v213
  v_mfma_f32_16x16x32_bf16 v[88:91], v[176:179], a[76:79], v[88:91]
  ds_read_b64_tr_b16 v[164:165], v207 offset:12288
  v_add_u32 v126, v127, v131
  v_mfma_f32_16x16x32_bf16 v[68:71], v[180:183], a[64:67], v[68:71]
  ds_read_b64_tr_b16 v[166:167], v207 offset:12800
  v_lshlrev_b32 v247, 5, v126
  v_mfma_f32_16x16x32_bf16 v[76:79], v[180:183], a[68:71], v[76:79]
  buffer_load_dwordx4 v197, s[28:31], s63 offen offset:1024 lds
  s_add_u32 m0, s60, 40960
  v_mfma_f32_16x16x32_bf16 v[84:87], v[180:183], a[72:75], v[84:87]
  ds_read_b64_tr_b16 v[168:169], v206 offset:20480
  ds_read_b64_tr_b16 v[170:171], v206 offset:20992
  v_mfma_f32_16x16x32_bf16 v[92:95], v[180:183], a[76:79], v[92:95]
  s_waitcnt lgkmcnt(8)
  ds_read_b64_tr_b16 v[172:173], v207 offset:20480
  v_mfma_f32_16x16x32_bf16 v[0:3], v[184:187], a[80:83], v[0:3]
  ds_read_b64_tr_b16 v[174:175], v207 offset:20992
  v_min_u32 v127, 5, v127
  v_mfma_f32_16x16x32_bf16 v[8:11], v[184:187], a[84:87], v[8:11]
  v_add_u32 v126, v127, v131
  s_lshl_b32 s100, s74, 5
  v_mfma_f32_16x16x32_bf16 v[16:19], v[184:187], a[88:91], v[16:19]
  buffer_load_dwordx4 v200, s[32:35], s64 offen offset:0 lds
  s_add_u32 m0, s60, 49152
  v_mfma_f32_16x16x32_bf16 v[24:27], v[184:187], a[92:95], v[24:27]
  s_waitcnt lgkmcnt(7)
  v_add_u32 v127, s100, v129
  v_mfma_f32_16x16x32_bf16 v[4:7], v[188:191], a[80:83], v[4:7]
  s_lshl_b32 s101, s76, 4
  v_lshlrev_b32 v249, 5, v126
  v_mfma_f32_16x16x32_bf16 v[12:15], v[188:191], a[84:87], v[12:15]
  s_add_u32 s100, s100, s101
  v_and_b32 v126, 15, v213
  v_mfma_f32_16x16x32_bf16 v[20:23], v[188:191], a[88:91], v[20:23]
  s_add_u32 s100, s100, 4096
  v_add_u32 v126, s100, v126
  v_mfma_f32_16x16x32_bf16 v[28:31], v[188:191], a[92:95], v[28:31]
  s_waitcnt lgkmcnt(4)
  buffer_load_dwordx4 v202, s[36:39], s65 offen offset:0 lds
  v_mfma_f32_16x16x32_bf16 v[32:35], v[160:163], a[80:83], v[32:35]
  s_waitcnt vmcnt(16) lgkmcnt(0)
  s_barrier
  v_mfma_f32_16x16x32_bf16 v[40:43], v[160:163], a[84:87], v[40:43]
  s_add_u32 m0, s60, 57344
  ds_read_b128 a[96:99], v204 offset:40960
  v_mfma_f32_16x16x32_bf16 v[48:51], v[160:163], a[88:91], v[48:51]
  ds_read_b64_tr_b16 v[176:177], v206 offset:40960
  s_xor_b32 s100, s78, 4
  v_mfma_f32_16x16x32_bf16 v[56:59], v[160:163], a[92:95], v[56:59]
  ds_read_b64_tr_b16 v[178:179], v206 offset:41472
  v_lshl_add_u32 v242, s26, 12, v211
  v_mfma_f32_16x16x32_bf16 v[36:39], v[164:167], a[80:83], v[36:39]
  buffer_load_dwordx4 v202, s[40:43], s65 offen offset:0 lds
  s_add_u32 m0, s11, 40960
  v_mfma_f32_16x16x32_bf16 v[44:47], v[164:167], a[84:87], v[44:47]
  ds_read_b128 a[100:103], v204 offset:43008
  v_lshrrev_b32 v131, 5, v218
  v_mfma_f32_16x16x32_bf16 v[52:55], v[164:167], a[88:91], v[52:55]
  ds_read_b128 a[104:107], v204 offset:45056
  s_lshl_b32 s100, s100, 5
  v_mfma_f32_16x16x32_bf16 v[60:63], v[164:167], a[92:95], v[60:63]
  v_xor_b32 v243, 8192, v242
  v_lshl_add_u32 v241, v129, 10, v131
  v_mfma_f32_16x16x32_bf16 v[64:67], v[168:171], a[80:83], v[64:67]
  buffer_load_dwordx4 v198, s[28:31], s63 offen offset:0 lds
  ds_read_b128 a[108:111], v204 offset:47104
  v_mfma_f32_16x16x32_bf16 v[72:75], v[168:171], a[84:87], v[72:75]
  v_add_u32 v204, 0xfffec000, v204
  s_mov_b32 s91, 0x20000
  v_mfma_f32_16x16x32_bf16 v[80:83], v[168:171], a[88:91], v[80:83]
  ds_read_b64_tr_b16 v[180:181], v207 offset:40960
  v_add_u32 v233, 7168, v232
  v_mfma_f32_16x16x32_bf16 v[88:91], v[168:171], a[92:95], v[88:91]
  ds_read_b64_tr_b16 v[182:183], v207 offset:41472
  v_add_u32 v234, 14336, v232
  v_mfma_f32_16x16x32_bf16 v[68:71], v[172:175], a[80:83], v[68:71]
  ds_read_b64_tr_b16 v[184:185], v206 offset:49152
  v_add_u32 v235, 21504, v232
  v_mfma_f32_16x16x32_bf16 v[76:79], v[172:175], a[84:87], v[76:79]
  buffer_load_dwordx4 v199, s[28:31], s63 offen offset:1024 lds
  s_add_u32 m0, s10, 40960
  v_mfma_f32_16x16x32_bf16 v[84:87], v[172:175], a[88:91], v[84:87]
  ds_read_b64_tr_b16 v[186:187], v206 offset:49664
  ds_read_b64_tr_b16 v[188:189], v207 offset:49152
  v_mfma_f32_16x16x32_bf16 v[92:95], v[172:175], a[92:95], v[92:95]
  s_waitcnt lgkmcnt(7)
  ds_read_b64_tr_b16 v[190:191], v207 offset:49664
  v_mfma_f32_16x16x32_bf16 v[0:3], v[176:179], a[96:99], v[0:3]
  ds_read_b64_tr_b16 v[160:161], v206 offset:57344
  s_lshl_b32 s63, s62, 7
  v_mfma_f32_16x16x32_bf16 v[8:11], v[176:179], a[100:103], v[8:11]
  s_waitcnt lgkmcnt(8)
  ds_read_b64_tr_b16 v[162:163], v206 offset:57856
  v_mfma_f32_16x16x32_bf16 v[16:19], v[176:179], a[104:107], v[16:19]
  s_waitcnt lgkmcnt(8)
  buffer_load_dwordx4 v201, s[32:35], s64 offen offset:0 lds
  v_mfma_f32_16x16x32_bf16 v[24:27], v[176:179], a[108:111], v[24:27]
  s_waitcnt lgkmcnt(6)
  s_add_u32 m0, s10, 49152
  v_mfma_f32_16x16x32_bf16 v[4:7], v[180:183], a[96:99], v[4:7]
  ds_read_b64_tr_b16 v[164:165], v207 offset:57344
  ds_read_b64_tr_b16 v[166:167], v207 offset:57856
  v_mfma_f32_16x16x32_bf16 v[12:15], v[180:183], a[100:103], v[12:15]
  ds_read_b128 a[112:115], v205 offset:40960
  s_mul_i32 s64, s62, 196608
  v_mfma_f32_16x16x32_bf16 v[20:23], v[180:183], a[104:107], v[20:23]
  v_cmp_gt_u32 vcc, 32, v213
  s_nop 1
  v_cndmask_b32 v126, v127, v126, vcc
  v_mfma_f32_16x16x32_bf16 v[28:31], v[180:183], a[108:111], v[28:31]
  s_waitcnt lgkmcnt(7)
  buffer_load_dwordx4 v203, s[36:39], s65 offen offset:0 lds
  v_mfma_f32_16x16x32_bf16 v[32:35], v[184:187], a[96:99], v[32:35]
  s_add_u32 m0, s10, 57344
  ds_read_b64_tr_b16 v[168:169], v206 offset:45056
  v_mfma_f32_16x16x32_bf16 v[40:43], v[184:187], a[100:103], v[40:43]
  ds_read_b64_tr_b16 v[170:171], v206 offset:45568
  ds_read_b128 a[116:119], v205 offset:43008
  v_mfma_f32_16x16x32_bf16 v[48:51], v[184:187], a[104:107], v[48:51]
  v_lshlrev_b32 v248, 5, v126
  s_mov_b32 s95, 0x20000
  v_mfma_f32_16x16x32_bf16 v[56:59], v[184:187], a[108:111], v[56:59]
  s_waitcnt lgkmcnt(6)
  ds_read_b128 a[120:123], v205 offset:45056
  v_mfma_f32_16x16x32_bf16 v[36:39], v[188:191], a[96:99], v[36:39]
  buffer_load_dwordx4 v203, s[40:43], s65 offen offset:0 lds
  s_add_u32 m0, s59, 81920
  v_mfma_f32_16x16x32_bf16 v[44:47], v[188:191], a[100:103], v[44:47]
  ds_read_b128 a[124:127], v205 offset:47104
  s_mul_i32 s65, s62, 229376
  v_mfma_f32_16x16x32_bf16 v[52:55], v[188:191], a[104:107], v[52:55]
  s_xor_b32 s62, s58, 7
  v_add_u32 v205, 0xfffec000, v205
  v_mfma_f32_16x16x32_bf16 v[60:63], v[188:191], a[108:111], v[60:63]
  ds_read_b64_tr_b16 v[172:173], v207 offset:45056
  s_mov_b32 s99, 0x20000
  v_mfma_f32_16x16x32_bf16 v[64:67], v[160:163], a[96:99], v[64:67]
  buffer_load_dwordx4 v196, s[28:31], s63 offen offset:0 lds
  ds_read_b64_tr_b16 v[174:175], v207 offset:45568
  v_mfma_f32_16x16x32_bf16 v[72:75], v[160:163], a[100:103], v[72:75]
  ds_read_b64_tr_b16 v[176:177], v206 offset:53248
  v_mov_b32 v245, s100
  v_mfma_f32_16x16x32_bf16 v[80:83], v[160:163], a[104:107], v[80:83]
  ds_read_b64_tr_b16 v[178:179], v206 offset:53760
  v_xor_b32 v237, 32, v236
  v_mfma_f32_16x16x32_bf16 v[88:91], v[160:163], a[108:111], v[88:91]
  s_waitcnt lgkmcnt(6)
  ds_read_b64_tr_b16 v[180:181], v207 offset:53248
  v_mfma_f32_16x16x32_bf16 v[68:71], v[164:167], a[96:99], v[68:71]
  ds_read_b64_tr_b16 v[182:183], v207 offset:53760
  v_xor_b32 v208, 64, v236
  v_mfma_f32_16x16x32_bf16 v[76:79], v[164:167], a[100:103], v[76:79]
  buffer_load_dwordx4 v197, s[28:31], s63 offen offset:1024 lds
  s_add_u32 m0, s60, 81920
  v_mfma_f32_16x16x32_bf16 v[84:87], v[164:167], a[104:107], v[84:87]
  ds_read_b64_tr_b16 v[184:185], v206 offset:61440
  ds_read_b64_tr_b16 v[186:187], v206 offset:61952
  v_mfma_f32_16x16x32_bf16 v[92:95], v[164:167], a[108:111], v[92:95]
  ds_read_b64_tr_b16 v[188:189], v207 offset:61440
  v_add_u32 v206, 0xfffec000, v206
  v_mfma_f32_16x16x32_bf16 v[0:3], v[168:171], a[112:115], v[0:3]
  ds_read_b64_tr_b16 v[190:191], v207 offset:61952
  v_add_u32 v207, 0xfffec000, v207
  v_mfma_f32_16x16x32_bf16 v[8:11], v[168:171], a[116:119], v[8:11]
  s_waitcnt lgkmcnt(9)
  v_xor_b32 v209, 96, v236
  v_mfma_f32_16x16x32_bf16 v[16:19], v[168:171], a[120:123], v[16:19]
  buffer_load_dwordx4 v200, s[32:35], s64 offen offset:0 lds
  s_add_u32 m0, s60, 90112
  v_mfma_f32_16x16x32_bf16 v[24:27], v[168:171], a[124:127], v[24:27]
  s_waitcnt lgkmcnt(7)
  v_add_u32 v240, 139264, v242
  v_mfma_f32_16x16x32_bf16 v[4:7], v[172:175], a[112:115], v[4:7]
L_pg1:
  s_cbranch_execz L_pg5
  v_add_u32 v244, 139264, v243
  v_lshlrev_b32 v146, 16, v142
  v_mfma_f32_16x16x32_bf16 v[12:15], v[172:175], a[116:119], v[12:15]
  v_lshlrev_b32 v154, 16, v134
  v_and_b32 v147, 0xffff0000, v142
  v_mfma_f32_16x16x32_bf16 v[20:23], v[172:175], a[120:123], v[20:23]
  v_and_b32 v155, 0xffff0000, v134
  v_mul_f32 v158, v154, v146
  v_mfma_f32_16x16x32_bf16 v[28:31], v[172:175], a[124:127], v[28:31]
  s_waitcnt lgkmcnt(4)
  buffer_load_dwordx4 v202, s[36:39], s65 offen offset:0 lds
  v_mfma_f32_16x16x32_bf16 v[32:35], v[176:179], a[112:115], v[32:35]
  s_waitcnt vmcnt(14) lgkmcnt(0)
  s_barrier
  v_mfma_f32_16x16x32_bf16 v[40:43], v[176:179], a[116:119], v[40:43]
  s_add_u32 m0, s60, 98304
  ds_read_b128 a[128:131], v204 offset:0
  v_mfma_f32_16x16x32_bf16 v[48:51], v[176:179], a[120:123], v[48:51]
  ds_read_b64_tr_b16 v[160:161], v206 offset:0
  v_lshlrev_b32 v148, 16, v143
  v_mfma_f32_16x16x32_bf16 v[56:59], v[176:179], a[124:127], v[56:59]
  ds_read_b64_tr_b16 v[162:163], v206 offset:512
  v_fmac_f32 v158, v155, v147
  v_mfma_f32_16x16x32_bf16 v[36:39], v[180:183], a[112:115], v[36:39]
  buffer_load_dwordx4 v202, s[40:43], s65 offen offset:0 lds
  s_add_u32 m0, s11, 81920
  v_mfma_f32_16x16x32_bf16 v[44:47], v[180:183], a[116:119], v[44:47]
  ds_read_b128 a[132:135], v204 offset:2048
  v_lshlrev_b32 v154, 16, v135
  v_mfma_f32_16x16x32_bf16 v[52:55], v[180:183], a[120:123], v[52:55]
  ds_read_b128 a[136:139], v204 offset:4096
  v_and_b32 v149, 0xffff0000, v143
  v_mfma_f32_16x16x32_bf16 v[60:63], v[180:183], a[124:127], v[60:63]
  v_and_b32 v155, 0xffff0000, v135
  v_fmac_f32 v158, v154, v148
  v_mfma_f32_16x16x32_bf16 v[64:67], v[184:187], a[112:115], v[64:67]
  buffer_load_dwordx4 v198, s[28:31], s63 offen offset:0 lds
  ds_read_b128 a[140:143], v204 offset:6144
  v_mfma_f32_16x16x32_bf16 v[72:75], v[184:187], a[116:119], v[72:75]
  v_lshlrev_b32 v150, 16, v144
  v_fmac_f32 v158, v155, v149
  v_mfma_f32_16x16x32_bf16 v[80:83], v[184:187], a[120:123], v[80:83]
  ds_read_b64_tr_b16 v[164:165], v207 offset:0
  v_lshlrev_b32 v154, 16, v136
  v_mfma_f32_16x16x32_bf16 v[88:91], v[184:187], a[124:127], v[88:91]
  ds_read_b64_tr_b16 v[166:167], v207 offset:512
  v_lshlrev_b32 v156, 16, v138
  v_mfma_f32_16x16x32_bf16 v[68:71], v[188:191], a[112:115], v[68:71]
  ds_read_b64_tr_b16 v[168:169], v206 offset:8192
  v_and_b32 v151, 0xffff0000, v144
  v_mfma_f32_16x16x32_bf16 v[76:79], v[188:191], a[116:119], v[76:79]
  buffer_load_dwordx4 v199, s[28:31], s63 offen offset:1024 lds
  s_add_u32 m0, s10, 81920
  v_mfma_f32_16x16x32_bf16 v[84:87], v[188:191], a[120:123], v[84:87]
  ds_read_b64_tr_b16 v[170:171], v206 offset:8704
  ds_read_b64_tr_b16 v[172:173], v207 offset:8192
  v_mfma_f32_16x16x32_bf16 v[92:95], v[188:191], a[124:127], v[92:95]
  s_waitcnt lgkmcnt(7)
  ds_read_b64_tr_b16 v[174:175], v207 offset:8704
  v_mfma_f32_16x16x32_bf16 v[0:3], v[160:163], a[128:131], v[0:3]
  ds_read_b64_tr_b16 v[176:177], v206 offset:16384
  s_lshl_b32 s63, s62, 7
  v_mfma_f32_16x16x32_bf16 v[8:11], v[160:163], a[132:135], v[8:11]
  s_waitcnt lgkmcnt(8)
  ds_read_b64_tr_b16 v[178:179], v206 offset:16896
  v_mfma_f32_16x16x32_bf16 v[16:19], v[160:163], a[136:139], v[16:19]
  s_waitcnt lgkmcnt(8)
  buffer_load_dwordx4 v201, s[32:35], s64 offen offset:0 lds
  v_mfma_f32_16x16x32_bf16 v[24:27], v[160:163], a[140:143], v[24:27]
  s_waitcnt lgkmcnt(6)
  s_add_u32 m0, s10, 90112
  v_mfma_f32_16x16x32_bf16 v[4:7], v[164:167], a[128:131], v[4:7]
  ds_read_b64_tr_b16 v[180:181], v207 offset:16384
  ds_read_b64_tr_b16 v[182:183], v207 offset:16896
  v_mfma_f32_16x16x32_bf16 v[12:15], v[164:167], a[132:135], v[12:15]
  ds_read_b128 a[144:147], v205 offset:0
  s_mul_i32 s64, s62, 196608
  v_mfma_f32_16x16x32_bf16 v[20:23], v[164:167], a[136:139], v[20:23]
  v_and_b32 v155, 0xffff0000, v136
  v_fmac_f32 v158, v154, v150
  v_mfma_f32_16x16x32_bf16 v[28:31], v[164:167], a[140:143], v[28:31]
  s_waitcnt lgkmcnt(7)
  buffer_load_dwordx4 v203, s[36:39], s65 offen offset:0 lds
  v_mfma_f32_16x16x32_bf16 v[32:35], v[168:171], a[128:131], v[32:35]
  s_add_u32 m0, s10, 98304
  ds_read_b64_tr_b16 v[184:185], v206 offset:4096
  v_mfma_f32_16x16x32_bf16 v[40:43], v[168:171], a[132:135], v[40:43]
  ds_read_b64_tr_b16 v[186:187], v206 offset:4608
  ds_read_b128 a[148:151], v205 offset:2048
  v_mfma_f32_16x16x32_bf16 v[48:51], v[168:171], a[136:139], v[48:51]
  global_load_dword v104, v100, s[4:5]
  global_load_dword v105, v101, s[6:7]
  v_mfma_f32_16x16x32_bf16 v[56:59], v[168:171], a[140:143], v[56:59]
  s_waitcnt lgkmcnt(6)
  ds_read_b128 a[152:155], v205 offset:4096
  v_mfma_f32_16x16x32_bf16 v[36:39], v[172:175], a[128:131], v[36:39]
  buffer_load_dwordx4 v203, s[40:43], s65 offen offset:0 lds
  s_add_u32 m0, s59, 122880
  v_mfma_f32_16x16x32_bf16 v[44:47], v[172:175], a[132:135], v[44:47]
  ds_read_b128 a[156:159], v205 offset:6144
  s_mul_i32 s65, s62, 229376
  v_mfma_f32_16x16x32_bf16 v[52:55], v[172:175], a[136:139], v[52:55]
  s_xor_b32 s62, s58, 0
  v_and_b32 v157, 0xffff0000, v138
  v_mfma_f32_16x16x32_bf16 v[60:63], v[172:175], a[140:143], v[60:63]
  ds_read_b64_tr_b16 v[188:189], v207 offset:4096
  v_mul_f32 v159, v156, v146
  v_mfma_f32_16x16x32_bf16 v[64:67], v[176:179], a[128:131], v[64:67]
  buffer_load_dwordx4 v196, s[28:31], s63 offen offset:0 lds
  ds_read_b64_tr_b16 v[190:191], v207 offset:4608
  v_mfma_f32_16x16x32_bf16 v[72:75], v[176:179], a[132:135], v[72:75]
  ds_read_b64_tr_b16 v[160:161], v206 offset:12288
  v_fmac_f32 v158, v155, v151
  v_mfma_f32_16x16x32_bf16 v[80:83], v[176:179], a[136:139], v[80:83]
  ds_read_b64_tr_b16 v[162:163], v206 offset:12800
  v_fmac_f32 v159, v157, v147
  v_mfma_f32_16x16x32_bf16 v[88:91], v[176:179], a[140:143], v[88:91]
  s_waitcnt lgkmcnt(6)
  ds_read_b64_tr_b16 v[164:165], v207 offset:12288
  v_mfma_f32_16x16x32_bf16 v[68:71], v[180:183], a[128:131], v[68:71]
  ds_read_b64_tr_b16 v[166:167], v207 offset:12800
  v_lshlrev_b32 v154, 16, v137
  v_mfma_f32_16x16x32_bf16 v[76:79], v[180:183], a[132:135], v[76:79]
  buffer_load_dwordx4 v197, s[28:31], s63 offen offset:1024 lds
  s_add_u32 m0, s60, 122880
  v_mfma_f32_16x16x32_bf16 v[84:87], v[180:183], a[136:139], v[84:87]
  ds_read_b64_tr_b16 v[168:169], v206 offset:20480
  ds_read_b64_tr_b16 v[170:171], v206 offset:20992
  v_mfma_f32_16x16x32_bf16 v[92:95], v[180:183], a[140:143], v[92:95]
  ds_read_b64_tr_b16 v[172:173], v207 offset:20480
  v_and_b32 v155, 0xffff0000, v137
  v_mfma_f32_16x16x32_bf16 v[0:3], v[184:187], a[144:147], v[0:3]
  ds_read_b64_tr_b16 v[174:175], v207 offset:20992
  v_lshlrev_b32 v156, 16, v139
  v_mfma_f32_16x16x32_bf16 v[8:11], v[184:187], a[148:151], v[8:11]
  s_waitcnt lgkmcnt(9)
  v_and_b32 v157, 0xffff0000, v139
  v_mfma_f32_16x16x32_bf16 v[16:19], v[184:187], a[152:155], v[16:19]
  buffer_load_dwordx4 v200, s[32:35], s64 offen offset:0 lds
  s_add_u32 m0, s60, 131072
  v_mfma_f32_16x16x32_bf16 v[24:27], v[184:187], a[156:159], v[24:27]
  s_waitcnt lgkmcnt(7)
  v_fmac_f32 v159, v156, v148
  v_mfma_f32_16x16x32_bf16 v[4:7], v[188:191], a[144:147], v[4:7]
  v_lshlrev_b32 v152, 16, v145
  v_and_b32 v153, 0xffff0000, v145
  v_mfma_f32_16x16x32_bf16 v[12:15], v[188:191], a[148:151], v[12:15]
  v_fmac_f32 v159, v157, v149
  v_lshlrev_b32 v156, 16, v140
  v_mfma_f32_16x16x32_bf16 v[20:23], v[188:191], a[152:155], v[20:23]
  v_and_b32 v157, 0xffff0000, v140
  v_fmac_f32 v159, v156, v150
  v_mfma_f32_16x16x32_bf16 v[28:31], v[188:191], a[156:159], v[28:31]
  s_waitcnt lgkmcnt(4)
  buffer_load_dwordx4 v202, s[36:39], s65 offen offset:0 lds
  v_mfma_f32_16x16x32_bf16 v[32:35], v[160:163], a[144:147], v[32:35]
  s_waitcnt vmcnt(16) lgkmcnt(0)
  s_barrier
  v_mfma_f32_16x16x32_bf16 v[40:43], v[160:163], a[148:151], v[40:43]
  s_add_u32 m0, s60, 139264
  ds_read_b128 a[160:163], v204 offset:40960
  v_mfma_f32_16x16x32_bf16 v[48:51], v[160:163], a[152:155], v[48:51]
  ds_read_b64_tr_b16 v[176:177], v206 offset:40960
  v_fmac_f32 v159, v157, v151
  v_mfma_f32_16x16x32_bf16 v[56:59], v[160:163], a[156:159], v[56:59]
  ds_read_b64_tr_b16 v[178:179], v206 offset:41472
  v_lshlrev_b32 v156, 16, v141
  v_mfma_f32_16x16x32_bf16 v[36:39], v[164:167], a[144:147], v[36:39]
  buffer_load_dwordx4 v202, s[40:43], s65 offen offset:0 lds
  ds_read_b128 a[164:167], v204 offset:43008
  v_mfma_f32_16x16x32_bf16 v[44:47], v[164:167], a[148:151], v[44:47]
  s_add_u32 m0, s11, 122880
  v_fmac_f32 v158, v154, v152
  v_mfma_f32_16x16x32_bf16 v[52:55], v[164:167], a[152:155], v[52:55]
  ds_read_b128 a[168:171], v204 offset:45056
  v_and_b32 v157, 0xffff0000, v141
  v_mfma_f32_16x16x32_bf16 v[60:63], v[164:167], a[156:159], v[60:63]
  v_fmac_f32 v159, v156, v152
  v_fmac_f32 v158, v155, v153
  v_mfma_f32_16x16x32_bf16 v[64:67], v[168:171], a[144:147], v[64:67]
  ds_read_b128 a[172:175], v204 offset:47104
  buffer_load_dwordx4 v198, s[28:31], s63 offen offset:0 lds
  v_mfma_f32_16x16x32_bf16 v[72:75], v[168:171], a[148:151], v[72:75]
  v_add_u32 v204, 0x14000, v204
  v_fmac_f32 v159, v157, v153
  v_mfma_f32_16x16x32_bf16 v[80:83], v[168:171], a[152:155], v[80:83]
  ds_read_b64_tr_b16 v[180:181], v207 offset:40960
  v_permlane32_swap_b32 v158, v159
  v_mfma_f32_16x16x32_bf16 v[88:91], v[168:171], a[156:159], v[88:91]
  ds_read_b64_tr_b16 v[182:183], v207 offset:41472
  v_add_f32 v158, v158, v159
  v_mfma_f32_16x16x32_bf16 v[68:71], v[172:175], a[144:147], v[68:71]
  ds_read_b64_tr_b16 v[184:185], v206 offset:49152
  v_add_f32_dpp v158, v158, v158 row_shr:1 row_mask:0xf bank_mask:0xf bound_ctrl:1
  v_mfma_f32_16x16x32_bf16 v[76:79], v[172:175], a[148:151], v[76:79]
  ds_read_b64_tr_b16 v[186:187], v206 offset:49664
  buffer_load_dwordx4 v199, s[28:31], s63 offen offset:1024 lds
  v_mfma_f32_16x16x32_bf16 v[84:87], v[172:175], a[152:155], v[84:87]
  ds_read_b64_tr_b16 v[188:189], v207 offset:49152
  s_add_u32 m0, s10, 122880
  v_mfma_f32_16x16x32_bf16 v[92:95], v[172:175], a[156:159], v[92:95]
  s_waitcnt lgkmcnt(7)
  ds_read_b64_tr_b16 v[190:191], v207 offset:49664
  v_mfma_f32_16x16x32_bf16 v[0:3], v[176:179], a[160:163], v[0:3]
  ds_read_b64_tr_b16 v[160:161], v206 offset:57344
  v_add_f32_dpp v158, v158, v158 row_shr:2 row_mask:0xf bank_mask:0xf bound_ctrl:1
  v_mfma_f32_16x16x32_bf16 v[8:11], v[176:179], a[164:167], v[8:11]
  s_waitcnt lgkmcnt(8)
  ds_read_b64_tr_b16 v[162:163], v206 offset:57856
  v_mfma_f32_16x16x32_bf16 v[16:19], v[176:179], a[168:171], v[16:19]
  s_waitcnt lgkmcnt(8)
  ds_read_b64_tr_b16 v[164:165], v207 offset:57344
  v_mfma_f32_16x16x32_bf16 v[24:27], v[176:179], a[172:175], v[24:27]
  s_waitcnt lgkmcnt(7)
  ds_read_b64_tr_b16 v[166:167], v207 offset:57856
  v_mfma_f32_16x16x32_bf16 v[4:7], v[180:183], a[160:163], v[4:7]
  ds_read_b128 a[176:179], v205 offset:40960
  buffer_load_dwordx4 v201, s[32:35], s64 offen offset:0 lds
  v_mfma_f32_16x16x32_bf16 v[12:15], v[180:183], a[164:167], v[12:15]
  s_add_u32 m0, s10, 131072
  v_add_f32_dpp v158, v158, v158 row_shr:4 row_mask:0xf bank_mask:0xf bound_ctrl:1
  v_mfma_f32_16x16x32_bf16 v[20:23], v[180:183], a[168:171], v[20:23]
  ds_read_b64_tr_b16 v[168:169], v206 offset:45056
  v_add_f32_dpp v158, v158, v158 row_shr:8 row_mask:0xf bank_mask:0xf bound_ctrl:1
  v_mfma_f32_16x16x32_bf16 v[28:31], v[180:183], a[172:175], v[28:31]
  s_waitcnt lgkmcnt(8)
  ds_read_b64_tr_b16 v[170:171], v206 offset:45568
  v_mfma_f32_16x16x32_bf16 v[32:35], v[184:187], a[160:163], v[32:35]
  ds_read_b128 a[180:183], v205 offset:43008
  buffer_load_dwordx4 v203, s[36:39], s65 offen offset:0 lds
  v_mfma_f32_16x16x32_bf16 v[40:43], v[184:187], a[164:167], v[40:43]
  s_add_u32 m0, s10, 139264
  v_add_f32_dpp v158, v158, v158 row_bcast:15 row_mask:0xa bank_mask:0xf
  v_mfma_f32_16x16x32_bf16 v[48:51], v[184:187], a[168:171], v[48:51]
  ds_read_b128 a[184:187], v205 offset:45056
  v_mul_f32 v158, 0xbfb8aa3b, v158
  v_mfma_f32_16x16x32_bf16 v[56:59], v[184:187], a[172:175], v[56:59]
  s_waitcnt lgkmcnt(7)
  s_add_u32 s4, s67, 0
  v_mfma_f32_16x16x32_bf16 v[36:39], v[188:191], a[160:163], v[36:39]
  ds_read_b128 a[188:191], v205 offset:47104
  v_add_u32 v205, 0x14000, v205
  v_mfma_f32_16x16x32_bf16 v[44:47], v[188:191], a[164:167], v[44:47]
  buffer_load_dwordx4 v203, s[40:43], s65 offen offset:0 lds
  s_add_u32 m0, s60, 0xffffc000
  v_mfma_f32_16x16x32_bf16 v[52:55], v[188:191], a[168:171], v[52:55]
  ds_read_b64_tr_b16 v[172:173], v207 offset:45056
  s_mul_i32 s65, s62, 229376
  v_mfma_f32_16x16x32_bf16 v[60:63], v[188:191], a[172:175], v[60:63]
  ds_read_b64_tr_b16 v[174:175], v207 offset:45568
  s_xor_b32 s62, s58, 1
  v_mfma_f32_16x16x32_bf16 v[64:67], v[160:163], a[160:163], v[64:67]
  ds_read_b64_tr_b16 v[176:177], v206 offset:53248
  buffer_load_dwordx4 v202, s[44:47], s65 offen lds
  v_mfma_f32_16x16x32_bf16 v[72:75], v[160:163], a[164:167], v[72:75]
  ds_read_b64_tr_b16 v[178:179], v206 offset:53760
  s_add_u32 m0, s60, 0xffffe000
  v_mfma_f32_16x16x32_bf16 v[80:83], v[160:163], a[168:171], v[80:83]
  ds_read_b64_tr_b16 v[180:181], v207 offset:53248
  s_add_u32 s5, s67, 65536
  v_mfma_f32_16x16x32_bf16 v[88:91], v[160:163], a[172:175], v[88:91]
  s_waitcnt lgkmcnt(7)
  ds_read_b64_tr_b16 v[182:183], v207 offset:53760
  v_mfma_f32_16x16x32_bf16 v[68:71], v[164:167], a[160:163], v[68:71]
  ds_read_b64_tr_b16 v[184:185], v206 offset:61440
  s_add_u32 s6, s67, 1024
  v_mfma_f32_16x16x32_bf16 v[76:79], v[164:167], a[164:167], v[76:79]
  ds_read_b64_tr_b16 v[186:187], v206 offset:61952
  v_add_u32 v206, 0x14000, v206
  v_mfma_f32_16x16x32_bf16 v[84:87], v[164:167], a[168:171], v[84:87]
  ds_read_b64_tr_b16 v[188:189], v207 offset:61440
  buffer_load_dwordx4 v202, s[48:51], s65 offen lds
  v_mfma_f32_16x16x32_bf16 v[92:95], v[164:167], a[172:175], v[92:95]
  ds_read_b64_tr_b16 v[190:191], v207 offset:61952
  v_add_u32 v207, 0x14000, v207
  v_mfma_f32_16x16x32_bf16 v[0:3], v[168:171], a[176:179], v[0:3]
  s_add_u32 m0, s10, 0xffffc000
  s_add_u32 s7, s67, 66560
  v_mfma_f32_16x16x32_bf16 v[8:11], v[168:171], a[180:183], v[8:11]
  s_waitcnt lgkmcnt(8)
  v_exp_f32 v158, v158
  v_mfma_f32_16x16x32_bf16 v[16:19], v[168:171], a[184:187], v[16:19]
  buffer_load_dwordx4 v203, s[44:47], s65 offen lds
  s_add_u32 m0, s10, 0xffffe000
  v_mfma_f32_16x16x32_bf16 v[24:27], v[168:171], a[188:191], v[24:27]
  v_add_f32 v158, 1.0, v158
  v_mov_b32 v250, 0
  v_mfma_f32_16x16x32_bf16 v[4:7], v[172:175], a[176:179], v[4:7]
  global_load_dwordx2 v[216:217], v250, s[22:23] sc1
  s_lshl_b32 s59, s26, 12
  v_mfma_f32_16x16x32_bf16 v[12:15], v[172:175], a[180:183], v[12:15]
  v_rcp_f32 v253, v158
  v_mfma_f32_16x16x32_bf16 v[20:23], v[172:175], a[184:187], v[20:23]
  s_waitcnt vmcnt(14) lgkmcnt(0)
  s_barrier
  v_mfma_f32_16x16x32_bf16 v[28:31], v[172:175], a[188:191], v[28:31]
  ds_read_b128 a[192:195], v204 offset:0
  buffer_load_dwordx4 v203, s[48:51], s65 offen lds
  v_mfma_f32_16x16x32_bf16 v[32:35], v[176:179], a[176:179], v[32:35]
  ds_read_b64_tr_b16 v[160:161], v206 offset:0
  s_add_u32 m0, s60, 0x0
  v_mfma_f32_16x16x32_bf16 v[40:43], v[176:179], a[180:183], v[40:43]
  ds_read_b64_tr_b16 v[162:163], v206 offset:512
  s_mul_i32 s65, s62, 229376
  v_mfma_f32_16x16x32_bf16 v[48:51], v[176:179], a[184:187], v[48:51]
  ds_read_b128 a[196:199], v204 offset:2048
  s_xor_b32 s62, s58, 2
  v_mfma_f32_16x16x32_bf16 v[56:59], v[176:179], a[188:191], v[56:59]
  s_add_u32 s63, s69, 147456
  v_mfma_f32_16x16x32_bf16 v[36:39], v[180:183], a[176:179], v[36:39]
  ds_read_b128 a[200:203], v204 offset:4096
  buffer_load_dwordx4 v202, s[44:47], s65 offen lds
  v_mfma_f32_16x16x32_bf16 v[44:47], v[180:183], a[180:183], v[44:47]
  s_add_u32 m0, s60, 0x2000
  v_mfma_f32_16x16x32_bf16 v[52:55], v[180:183], a[184:187], v[52:55]
  ds_read_b128 a[204:207], v204 offset:6144
  v_mfma_f32_16x16x32_bf16 v[60:63], v[180:183], a[188:191], v[60:63]
  v_mfma_f32_16x16x32_bf16 v[64:67], v[184:187], a[176:179], v[64:67]
  ds_read_b64_tr_b16 v[164:165], v207 offset:0
  v_mfma_f32_16x16x32_bf16 v[72:75], v[184:187], a[180:183], v[72:75]
  ds_read_b64_tr_b16 v[166:167], v207 offset:512
  buffer_load_dwordx4 v202, s[48:51], s65 offen lds
  v_mfma_f32_16x16x32_bf16 v[80:83], v[184:187], a[184:187], v[80:83]
  ds_read_b64_tr_b16 v[168:169], v206 offset:8192
  s_add_u32 m0, s10, 0x0
  v_mfma_f32_16x16x32_bf16 v[88:91], v[184:187], a[188:191], v[88:91]
  ds_read_b64_tr_b16 v[170:171], v206 offset:8704
  v_mfma_f32_16x16x32_bf16 v[68:71], v[188:191], a[176:179], v[68:71]
  ds_read_b64_tr_b16 v[172:173], v207 offset:8192
  v_mfma_f32_16x16x32_bf16 v[76:79], v[188:191], a[180:183], v[76:79]
  ds_read_b64_tr_b16 v[174:175], v207 offset:8704
  buffer_load_dwordx4 v203, s[44:47], s65 offen lds
  v_mfma_f32_16x16x32_bf16 v[84:87], v[188:191], a[184:187], v[84:87]
  ds_read_b64_tr_b16 v[176:177], v206 offset:16384
  s_add_u32 m0, s10, 0x2000
  v_mfma_f32_16x16x32_bf16 v[92:95], v[188:191], a[188:191], v[92:95]
  s_waitcnt lgkmcnt(8)
  ds_read_b64_tr_b16 v[178:179], v206 offset:16896
  v_mfma_f32_16x16x32_bf16 v[0:3], v[160:163], a[192:195], v[0:3]
  ds_read_b64_tr_b16 v[180:181], v207 offset:16384
  v_mfma_f32_16x16x32_bf16 v[8:11], v[160:163], a[196:199], v[8:11]
  ds_read_b64_tr_b16 v[182:183], v207 offset:16896
  v_mfma_f32_16x16x32_bf16 v[16:19], v[160:163], a[200:203], v[16:19]
  s_waitcnt lgkmcnt(9)
  ds_read_b128 a[208:211], v205 offset:0
  v_mfma_f32_16x16x32_bf16 v[24:27], v[160:163], a[204:207], v[24:27]
  s_waitcnt lgkmcnt(9)
  buffer_load_dwordx4 v203, s[48:51], s65 offen lds
  v_mfma_f32_16x16x32_bf16 v[4:7], v[164:167], a[192:195], v[4:7]
  ds_read_b64_tr_b16 v[184:185], v206 offset:4096
  s_add_u32 m0, s60, 0x6000
  v_mfma_f32_16x16x32_bf16 v[12:15], v[164:167], a[196:199], v[12:15]
  ds_read_b64_tr_b16 v[186:187], v206 offset:4608
  s_mul_i32 s65, s62, 229376
  v_mfma_f32_16x16x32_bf16 v[20:23], v[164:167], a[200:203], v[20:23]
  ds_read_b128 a[212:215], v205 offset:2048
  s_xor_b32 s62, s58, 3
  v_mfma_f32_16x16x32_bf16 v[28:31], v[164:167], a[204:207], v[28:31]
  s_waitcnt lgkmcnt(8)
  buffer_load_dwordx4 v202, s[44:47], s65 offen lds
  v_mfma_f32_16x16x32_bf16 v[32:35], v[168:171], a[192:195], v[32:35]
  ds_read_b128 a[216:219], v205 offset:4096
  s_add_u32 m0, s60, 0x8000
  v_mfma_f32_16x16x32_bf16 v[40:43], v[168:171], a[196:199], v[40:43]
  v_mfma_f32_16x16x32_bf16 v[48:51], v[168:171], a[200:203], v[48:51]
  ds_read_b128 a[220:223], v205 offset:6144
  v_mfma_f32_16x16x32_bf16 v[56:59], v[168:171], a[204:207], v[56:59]
  v_mfma_f32_16x16x32_bf16 v[36:39], v[172:175], a[192:195], v[36:39]
  ds_read_b64_tr_b16 v[188:189], v207 offset:4096
  buffer_load_dwordx4 v202, s[48:51], s65 offen lds
  v_mfma_f32_16x16x32_bf16 v[44:47], v[172:175], a[196:199], v[44:47]
  ds_read_b64_tr_b16 v[190:191], v207 offset:4608
  s_add_u32 m0, s10, 0x6000
  v_mfma_f32_16x16x32_bf16 v[52:55], v[172:175], a[200:203], v[52:55]
  ds_read_b64_tr_b16 v[160:161], v206 offset:12288
  v_mfma_f32_16x16x32_bf16 v[60:63], v[172:175], a[204:207], v[60:63]
  s_waitcnt lgkmcnt(6)
  ds_read_b64_tr_b16 v[162:163], v206 offset:12800
  v_mfma_f32_16x16x32_bf16 v[64:67], v[176:179], a[192:195], v[64:67]
  ds_read_b64_tr_b16 v[164:165], v207 offset:12288
  v_mfma_f32_16x16x32_bf16 v[72:75], v[176:179], a[196:199], v[72:75]
  ds_read_b64_tr_b16 v[166:167], v207 offset:12800
  buffer_load_dwordx4 v203, s[44:47], s65 offen lds
  v_mfma_f32_16x16x32_bf16 v[80:83], v[176:179], a[200:203], v[80:83]
  ds_read_b64_tr_b16 v[168:169], v206 offset:20480
  s_add_u32 m0, s10, 0x8000
  v_mfma_f32_16x16x32_bf16 v[88:91], v[176:179], a[204:207], v[88:91]
  ds_read_b64_tr_b16 v[170:171], v206 offset:20992
  v_mfma_f32_16x16x32_bf16 v[68:71], v[180:183], a[192:195], v[68:71]
  ds_read_b64_tr_b16 v[172:173], v207 offset:20480
  v_mfma_f32_16x16x32_bf16 v[76:79], v[180:183], a[196:199], v[76:79]
  ds_read_b64_tr_b16 v[174:175], v207 offset:20992
  buffer_load_dwordx4 v203, s[48:51], s65 offen lds
  v_mfma_f32_16x16x32_bf16 v[84:87], v[180:183], a[200:203], v[84:87]
  s_add_u32 m0, s60, 0xa000
  s_mul_i32 s65, s62, 229376
  v_mfma_f32_16x16x32_bf16 v[92:95], v[180:183], a[204:207], v[92:95]
  s_xor_b32 s62, s58, 4
  v_mfma_f32_16x16x32_bf16 v[0:3], v[184:187], a[208:211], v[0:3]
  s_waitcnt lgkmcnt(7)
  v_mfma_f32_16x16x32_bf16 v[8:11], v[184:187], a[212:215], v[8:11]
  v_mfma_f32_16x16x32_bf16 v[16:19], v[184:187], a[216:219], v[16:19]
  buffer_load_dwordx4 v202, s[44:47], s65 offen lds
  s_add_u32 m0, s60, 0xc000
  v_mfma_f32_16x16x32_bf16 v[24:27], v[184:187], a[220:223], v[24:27]
  v_mfma_f32_16x16x32_bf16 v[4:7], v[188:191], a[208:211], v[4:7]
  v_mfma_f32_16x16x32_bf16 v[12:15], v[188:191], a[212:215], v[12:15]
  s_waitcnt vmcnt(14) lgkmcnt(0)
  s_barrier
  v_mfma_f32_16x16x32_bf16 v[20:23], v[188:191], a[216:219], v[20:23]
  ds_read_b128 a[224:227], v204 offset:40960
  v_mfma_f32_16x16x32_bf16 v[28:31], v[188:191], a[220:223], v[28:31]
  ds_read_b64_tr_b16 v[176:177], v206 offset:40960
  buffer_load_dwordx4 v202, s[48:51], s65 offen lds
  v_mfma_f32_16x16x32_bf16 v[32:35], v[160:163], a[208:211], v[32:35]
  ds_read_b64_tr_b16 v[178:179], v206 offset:41472
  s_add_u32 m0, s10, 0xa000
  v_mfma_f32_16x16x32_bf16 v[40:43], v[160:163], a[212:215], v[40:43]
  ds_read_b128 a[228:231], v204 offset:43008
  v_mfma_f32_16x16x32_bf16 v[48:51], v[160:163], a[216:219], v[48:51]
  v_mfma_f32_16x16x32_bf16 v[56:59], v[160:163], a[220:223], v[56:59]
  ds_read_b128 a[232:235], v204 offset:45056
  v_mfma_f32_16x16x32_bf16 v[36:39], v[164:167], a[208:211], v[36:39]
  buffer_load_dwordx4 v203, s[44:47], s65 offen lds
  s_add_u32 m0, s10, 0xc000
  v_mfma_f32_16x16x32_bf16 v[44:47], v[164:167], a[212:215], v[44:47]
  ds_read_b128 a[236:239], v204 offset:47104
  v_mfma_f32_16x16x32_bf16 v[52:55], v[164:167], a[216:219], v[52:55]
  v_mfma_f32_16x16x32_bf16 v[60:63], v[164:167], a[220:223], v[60:63]
  ds_read_b64_tr_b16 v[180:181], v207 offset:40960
  v_mfma_f32_16x16x32_bf16 v[64:67], v[168:171], a[208:211], v[64:67]
  ds_read_b64_tr_b16 v[182:183], v207 offset:41472
  v_mfma_f32_16x16x32_bf16 v[72:75], v[168:171], a[212:215], v[72:75]
  ds_read_b64_tr_b16 v[184:185], v206 offset:49152
  buffer_load_dwordx4 v203, s[48:51], s65 offen lds
  v_mfma_f32_16x16x32_bf16 v[80:83], v[168:171], a[216:219], v[80:83]
  ds_read_b64_tr_b16 v[186:187], v206 offset:49664
  s_add_u32 m0, s60, 0x10000
  v_mfma_f32_16x16x32_bf16 v[88:91], v[168:171], a[220:223], v[88:91]
  ds_read_b64_tr_b16 v[188:189], v207 offset:49152
  s_mul_i32 s65, s62, 229376
  v_mfma_f32_16x16x32_bf16 v[68:71], v[172:175], a[208:211], v[68:71]
  ds_read_b64_tr_b16 v[190:191], v207 offset:49664
  s_xor_b32 s62, s58, 5
  v_mfma_f32_16x16x32_bf16 v[76:79], v[172:175], a[212:215], v[76:79]
  ds_read_b64_tr_b16 v[160:161], v206 offset:57344
  buffer_load_dwordx4 v202, s[44:47], s65 offen lds
  v_mfma_f32_16x16x32_bf16 v[84:87], v[172:175], a[216:219], v[84:87]
  ds_read_b64_tr_b16 v[162:163], v206 offset:57856
  s_add_u32 m0, s60, 0x12000
  v_mfma_f32_16x16x32_bf16 v[92:95], v[172:175], a[220:223], v[92:95]
  s_waitcnt lgkmcnt(8)
  ds_read_b64_tr_b16 v[164:165], v207 offset:57344
  v_mfma_f32_16x16x32_bf16 v[0:3], v[176:179], a[224:227], v[0:3]
  ds_read_b64_tr_b16 v[166:167], v207 offset:57856
  v_mfma_f32_16x16x32_bf16 v[8:11], v[176:179], a[228:231], v[8:11]
  ds_read_b128 a[240:243], v205 offset:40960
  v_mfma_f32_16x16x32_bf16 v[16:19], v[176:179], a[232:235], v[16:19]
  buffer_load_dwordx4 v202, s[48:51], s65 offen lds
  s_add_u32 m0, s10, 0x10000
  v_mfma_f32_16x16x32_bf16 v[24:27], v[176:179], a[236:239], v[24:27]
  s_waitcnt lgkmcnt(8)
  ds_read_b64_tr_b16 v[168:169], v206 offset:45056
  v_mfma_f32_16x16x32_bf16 v[4:7], v[180:183], a[224:227], v[4:7]
  ds_read_b64_tr_b16 v[170:171], v206 offset:45568
  v_mfma_f32_16x16x32_bf16 v[12:15], v[180:183], a[228:231], v[12:15]
  ds_read_b128 a[244:247], v205 offset:43008
  v_mfma_f32_16x16x32_bf16 v[20:23], v[180:183], a[232:235], v[20:23]
  v_mfma_f32_16x16x32_bf16 v[28:31], v[180:183], a[236:239], v[28:31]
  s_waitcnt lgkmcnt(7)
  ds_read_b128 a[248:251], v205 offset:45056
  v_mfma_f32_16x16x32_bf16 v[32:35], v[184:187], a[224:227], v[32:35]
  buffer_load_dwordx4 v203, s[44:47], s65 offen lds
  s_add_u32 m0, s10, 0x12000
  v_mfma_f32_16x16x32_bf16 v[40:43], v[184:187], a[228:231], v[40:43]
  ds_read_b128 a[252:255], v205 offset:47104
  v_mfma_f32_16x16x32_bf16 v[48:51], v[184:187], a[232:235], v[48:51]
  v_mfma_f32_16x16x32_bf16 v[56:59], v[184:187], a[236:239], v[56:59]
  ds_read_b64_tr_b16 v[172:173], v207 offset:45056
  v_mfma_f32_16x16x32_bf16 v[36:39], v[188:191], a[224:227], v[36:39]
  ds_read_b64_tr_b16 v[174:175], v207 offset:45568
  buffer_load_dwordx4 v203, s[48:51], s65 offen lds
  v_mfma_f32_16x16x32_bf16 v[44:47], v[188:191], a[228:231], v[44:47]
  s_add_u32 m0, s60, 0x14000
  s_mul_i32 s65, s62, 229376
  v_mfma_f32_16x16x32_bf16 v[52:55], v[188:191], a[232:235], v[52:55]
  ds_read_b64_tr_b16 v[176:177], v206 offset:53248
  ds_read_b64_tr_b16 v[178:179], v206 offset:53760
  v_mfma_f32_16x16x32_bf16 v[60:63], v[188:191], a[236:239], v[60:63]
  s_waitcnt lgkmcnt(6)
  ds_read_b64_tr_b16 v[180:181], v207 offset:53248
  v_mfma_f32_16x16x32_bf16 v[64:67], v[160:163], a[224:227], v[64:67]
  ds_read_b64_tr_b16 v[182:183], v207 offset:53760
  s_xor_b32 s62, s58, 6
  v_mfma_f32_16x16x32_bf16 v[72:75], v[160:163], a[228:231], v[72:75]
  buffer_load_dwordx4 v202, s[44:47], s65 offen lds
  s_add_u32 m0, s60, 0x16000
  v_mfma_f32_16x16x32_bf16 v[80:83], v[160:163], a[232:235], v[80:83]
  ds_read_b64_tr_b16 v[184:185], v206 offset:61440
  ds_read_b64_tr_b16 v[186:187], v206 offset:61952
  v_mfma_f32_16x16x32_bf16 v[88:91], v[160:163], a[236:239], v[88:91]
  ds_read_b64_tr_b16 v[188:189], v207 offset:61440
  v_add_u32 v206, 0xfffe8000, v206
  v_mfma_f32_16x16x32_bf16 v[68:71], v[164:167], a[224:227], v[68:71]
  ds_read_b64_tr_b16 v[190:191], v207 offset:61952
  v_add_u32 v207, 0xfffe8000, v207
  v_mfma_f32_16x16x32_bf16 v[76:79], v[164:167], a[228:231], v[76:79]
  buffer_load_dwordx4 v202, s[48:51], s65 offen lds
  s_add_u32 m0, s10, 0x14000
  v_mfma_f32_16x16x32_bf16 v[84:87], v[164:167], a[232:235], v[84:87]
  v_mfma_f32_16x16x32_bf16 v[92:95], v[164:167], a[236:239], v[92:95]
  v_mfma_f32_16x16x32_bf16 v[0:3], v[168:171], a[240:243], v[0:3]
  v_mfma_f32_16x16x32_bf16 v[8:11], v[168:171], a[244:247], v[8:11]
  s_waitcnt lgkmcnt(5)
  v_mfma_f32_16x16x32_bf16 v[16:19], v[168:171], a[248:251], v[16:19]
  buffer_load_dwordx4 v203, s[44:47], s65 offen lds
  s_add_u32 m0, s10, 0x16000
  v_mfma_f32_16x16x32_bf16 v[24:27], v[168:171], a[252:255], v[24:27]
  v_mfma_f32_16x16x32_bf16 v[4:7], v[172:175], a[240:243], v[4:7]
  s_waitcnt vmcnt(15) lgkmcnt(0)
  s_barrier
  v_mfma_f32_16x16x32_bf16 v[12:15], v[172:175], a[244:247], v[12:15]
  ds_read_b64_tr_b16 v[160:161], v206 offset:0
  ds_read_b64_tr_b16 v[162:163], v206 offset:512
  v_mfma_f32_16x16x32_bf16 v[20:23], v[172:175], a[248:251], v[20:23]
  ds_read_b64_tr_b16 v[164:165], v207 offset:0
  v_mul_f32 v0, s66, v0
  v_mfma_f32_16x16x32_bf16 v[28:31], v[172:175], a[252:255], v[28:31]
  buffer_load_dwordx4 v203, s[48:51], s65 offen lds
  s_add_u32 m0, s60, 0x1a000
  v_mfma_f32_16x16x32_bf16 v[32:35], v[176:179], a[240:243], v[32:35]
  s_mul_i32 s65, s62, 229376
  ds_read_b64_tr_b16 v[166:167], v207 offset:512
  v_mfma_f32_16x16x32_bf16 v[40:43], v[176:179], a[244:247], v[40:43]
  s_xor_b32 s62, s58, 7
  ds_read_b64_tr_b16 v[168:169], v206 offset:8192
  v_mfma_f32_16x16x32_bf16 v[48:51], v[176:179], a[248:251], v[48:51]
  ds_read_b64_tr_b16 v[170:171], v206 offset:8704
  ds_read_b64_tr_b16 v[172:173], v207 offset:8192
  v_mfma_f32_16x16x32_bf16 v[56:59], v[176:179], a[252:255], v[56:59]
  ds_read_b64_tr_b16 v[174:175], v207 offset:8704
  v_mul_f32 v1, s66, v1
  v_mfma_f32_16x16x32_bf16 v[36:39], v[180:183], a[240:243], v[36:39]
  ds_read_b64_tr_b16 v[176:177], v206 offset:4096
  v_mul_f32 v2, s66, v2
  v_mfma_f32_16x16x32_bf16 v[44:47], v[180:183], a[244:247], v[44:47]
  ds_read_b64_tr_b16 v[178:179], v206 offset:4608
  v_mul_f32 v3, s66, v3
  v_mfma_f32_16x16x32_bf16 v[52:55], v[180:183], a[248:251], v[52:55]
  v_cvt_pk_bf16_f32 v0, v0, v1
  v_mul_f32 v4, s66, v4
  v_mfma_f32_16x16x32_bf16 v[60:63], v[180:183], a[252:255], v[60:63]
  ds_read_b64_tr_b16 v[180:181], v207 offset:4096
  ds_read_b64_tr_b16 v[182:183], v207 offset:4608
  v_mfma_f32_16x16x32_bf16 v[64:67], v[184:187], a[240:243], v[64:67]
  v_mul_f32 v5, s66, v5
  v_mul_f32 v8, s66, v8
  v_mfma_f32_16x16x32_bf16 v[72:75], v[184:187], a[244:247], v[72:75]
L_pg2:
  s_cbranch_execz L_pg6
  buffer_load_dwordx4 v202, s[44:47], s65 offen lds
  s_add_u32 m0, s60, 0x1c000
  v_mfma_f32_16x16x32_bf16 v[80:83], v[184:187], a[248:251], v[80:83]
  v_mul_f32 v9, s66, v9
  v_mul_f32 v10, s66, v10
  v_mfma_f32_16x16x32_bf16 v[88:91], v[184:187], a[252:255], v[88:91]
  ds_read_b64_tr_b16 v[184:185], v206 offset:12288
  ds_read_b64_tr_b16 v[186:187], v206 offset:12800
  v_mfma_f32_16x16x32_bf16 v[68:71], v[188:191], a[240:243], v[68:71]
  buffer_load_dwordx4 v202, s[48:51], s65 offen lds
  s_add_u32 m0, s10, 0x1a000
  v_mfma_f32_16x16x32_bf16 v[76:79], v[188:191], a[244:247], v[76:79]
  v_mul_f32 v11, s66, v11
  v_cvt_pk_bf16_f32 v1, v2, v3
  v_mfma_f32_16x16x32_bf16 v[84:87], v[188:191], a[248:251], v[84:87]
  v_mul_f32 v6, s66, v6
  v_mul_f32 v7, s66, v7
  v_mfma_f32_16x16x32_bf16 v[92:95], v[188:191], a[252:255], v[92:95]
  s_waitcnt lgkmcnt(4)
  buffer_load_dwordx4 v203, s[44:47], s65 offen lds
  v_mfma_f32_16x16x32_bf16 v[96:99], v[160:163], a[0:3], 0
  s_add_u32 m0, s10, 0x1c000
  ds_read_b64_tr_b16 v[188:189], v207 offset:12288
  v_mfma_f32_16x16x32_bf16 v[104:107], v[160:163], a[4:7], 0
  buffer_load_dwordx4 v203, s[48:51], s65 offen lds
  s_add_u32 m0, s60, 0x1e000
  v_mfma_f32_16x16x32_bf16 v[112:115], v[160:163], a[8:11], 0
  s_mul_i32 s65, s62, 229376
  ds_read_b64_tr_b16 v[190:191], v207 offset:12800
  v_mfma_f32_16x16x32_bf16 v[120:123], v[160:163], a[12:15], 0
  ds_read_b64_tr_b16 v[160:161], v206 offset:16384
  ds_read_b64_tr_b16 v[162:163], v206 offset:16896
  v_mfma_f32_16x16x32_bf16 v[100:103], v[164:167], a[0:3], 0
  buffer_load_dwordx4 v202, s[44:47], s65 offen lds
  s_add_u32 m0, s60, 0x20000
  v_mfma_f32_16x16x32_bf16 v[108:111], v[164:167], a[4:7], 0
  v_cvt_pk_bf16_f32 v4, v4, v5
  v_mul_f32 v16, s66, v16
  v_mfma_f32_16x16x32_bf16 v[116:119], v[164:167], a[8:11], 0
  v_mul_f32 v17, s66, v17
  v_cvt_pk_bf16_f32 v2, v8, v9
  v_mfma_f32_16x16x32_bf16 v[124:127], v[164:167], a[12:15], 0
  buffer_load_dwordx4 v202, s[48:51], s65 offen lds
  s_add_u32 m0, s10, 0x1e000
  v_mfma_f32_16x16x32_bf16 v[128:131], v[168:171], a[0:3], 0
  ds_read_b64_tr_b16 v[164:165], v207 offset:16384
  ds_read_b64_tr_b16 v[166:167], v207 offset:16896
  v_mfma_f32_16x16x32_bf16 v[136:139], v[168:171], a[4:7], 0
  buffer_load_dwordx4 v203, s[44:47], s65 offen lds
  s_add_u32 m0, s10, 0x20000
  v_mfma_f32_16x16x32_bf16 v[144:147], v[168:171], a[8:11], 0
  v_cvt_pk_bf16_f32 v3, v10, v11
  v_mul_f32 v12, s66, v12
  v_mfma_f32_16x16x32_bf16 v[152:155], v[168:171], a[12:15], 0
  ds_read_b64_tr_b16 v[168:169], v206 offset:24576
  ds_read_b64_tr_b16 v[170:171], v206 offset:25088
  v_mfma_f32_16x16x32_bf16 v[132:135], v[172:175], a[0:3], 0
  buffer_load_dwordx4 v203, s[48:51], s65 offen lds
  buffer_store_dword v253, v212, s[52:55], s71 offen sc1
  v_mfma_f32_16x16x32_bf16 v[140:143], v[172:175], a[4:7], 0
  v_mul_f32 v13, s66, v13
  v_mul_f32 v14, s66, v14
  v_mfma_f32_16x16x32_bf16 v[148:151], v[172:175], a[8:11], 0
  v_mul_f32 v15, s66, v15
  v_cvt_pk_bf16_f32 v5, v6, v7
  v_mfma_f32_16x16x32_bf16 v[156:159], v[172:175], a[12:15], 0
  ds_read_b64_tr_b16 v[172:173], v207 offset:24576
  ds_read_b64_tr_b16 v[174:175], v207 offset:25088
  v_mfma_f32_16x16x32_bf16 v[96:99], v[176:179], a[16:19], v[96:99]
  v_mul_f32 v18, s66, v18
  v_mul_f32 v19, s66, v19
  v_mfma_f32_16x16x32_bf16 v[104:107], v[176:179], a[20:23], v[104:107]
  v_cvt_pk_bf16_f32 v16, v16, v17
  v_mul_f32 v20, s66, v20
  v_mfma_f32_16x16x32_bf16 v[112:115], v[176:179], a[24:27], v[112:115]
  v_mul_f32 v21, s66, v21
  v_permlane16_swap_b32 v0, v2
  v_mfma_f32_16x16x32_bf16 v[120:123], v[176:179], a[28:31], v[120:123]
  s_waitcnt lgkmcnt(4)
  ds_read_b64_tr_b16 v[176:177], v206 offset:20480
  v_mfma_f32_16x16x32_bf16 v[100:103], v[180:183], a[16:19], v[100:103]
  ds_read_b64_tr_b16 v[178:179], v206 offset:20992
  v_permlane16_swap_b32 v1, v3
  v_mfma_f32_16x16x32_bf16 v[108:111], v[180:183], a[20:23], v[108:111]
  buffer_store_dwordx4 v[0:3], v211, s[52:55], s4 offen sc1
  v_cvt_pk_bf16_f32 v6, v12, v13
  v_mfma_f32_16x16x32_bf16 v[116:119], v[180:183], a[24:27], v[116:119]
  v_cvt_pk_bf16_f32 v7, v14, v15
  v_mul_f32 v24, s66, v24
  v_mfma_f32_16x16x32_bf16 v[124:127], v[180:183], a[28:31], v[124:127]
  ds_read_b64_tr_b16 v[180:181], v207 offset:20480
  ds_read_b64_tr_b16 v[182:183], v207 offset:20992
  v_mfma_f32_16x16x32_bf16 v[128:131], v[184:187], a[16:19], v[128:131]
  v_mul_f32 v25, s66, v25
  v_mul_f32 v26, s66, v26
  v_mfma_f32_16x16x32_bf16 v[136:139], v[184:187], a[20:23], v[136:139]
  v_mul_f32 v27, s66, v27
  v_cvt_pk_bf16_f32 v17, v18, v19
  v_mfma_f32_16x16x32_bf16 v[144:147], v[184:187], a[24:27], v[144:147]
  v_mul_f32 v22, s66, v22
  v_mul_f32 v23, s66, v23
  v_mfma_f32_16x16x32_bf16 v[152:155], v[184:187], a[28:31], v[152:155]
  ds_read_b64_tr_b16 v[184:185], v206 offset:28672
  ds_read_b64_tr_b16 v[186:187], v206 offset:29184
  v_mfma_f32_16x16x32_bf16 v[132:135], v[188:191], a[16:19], v[132:135]
  v_add_u32 v206, 0xa000, v206
  v_cvt_pk_bf16_f32 v20, v20, v21
  v_mfma_f32_16x16x32_bf16 v[140:143], v[188:191], a[20:23], v[140:143]
  v_permlane16_swap_b32 v4, v6
  v_permlane16_swap_b32 v5, v7
  v_mfma_f32_16x16x32_bf16 v[148:151], v[188:191], a[24:27], v[148:151]
  v_cvt_pk_bf16_f32 v18, v24, v25
  v_cvt_pk_bf16_f32 v19, v26, v27
  v_mfma_f32_16x16x32_bf16 v[156:159], v[188:191], a[28:31], v[156:159]
  buffer_store_dwordx4 v[4:7], v211, s[52:55], s5 offen sc1
  ds_read_b64_tr_b16 v[188:189], v207 offset:28672
  v_mfma_f32_16x16x32_bf16 v[96:99], v[160:163], a[32:35], v[96:99]
  ds_read_b64_tr_b16 v[190:191], v207 offset:29184
  v_add_u32 v207, 0xa000, v207
  v_mfma_f32_16x16x32_bf16 v[104:107], v[160:163], a[36:39], v[104:107]
  v_mul_f32 v28, s66, v28
  v_mul_f32 v29, s66, v29
  v_mfma_f32_16x16x32_bf16 v[112:115], v[160:163], a[40:43], v[112:115]
  v_mul_f32 v30, s66, v30
  v_mul_f32 v31, s66, v31
  v_mfma_f32_16x16x32_bf16 v[120:123], v[160:163], a[44:47], v[120:123]
  v_cvt_pk_bf16_f32 v21, v22, v23
  v_permlane16_swap_b32 v16, v18
  v_mfma_f32_16x16x32_bf16 v[100:103], v[164:167], a[32:35], v[100:103]
  v_permlane16_swap_b32 v17, v19
  v_cvt_pk_bf16_f32 v22, v28, v29
  v_mfma_f32_16x16x32_bf16 v[108:111], v[164:167], a[36:39], v[108:111]
  v_cvt_pk_bf16_f32 v23, v30, v31
  v_permlane16_swap_b32 v20, v22
  v_mfma_f32_16x16x32_bf16 v[116:119], v[164:167], a[40:43], v[116:119]
  v_permlane16_swap_b32 v21, v23
  v_mul_f32 v64, v32, v64
  v_mfma_f32_16x16x32_bf16 v[124:127], v[164:167], a[44:47], v[124:127]
  s_waitcnt lgkmcnt(2)
  v_min_u32 v251, v216, v217
  v_cmp_eq_u32 vcc, 0, v251
  s_nop 0
  s_cbranch_vccnz L_slow_nA
L_back_nA:
  v_mfma_f32_16x16x32_bf16 v[128:131], v[168:171], a[32:35], v[128:131]
  v_mul_f32 v65, v33, v65
  v_mul_f32 v66, v34, v66
  v_mfma_f32_16x16x32_bf16 v[136:139], v[168:171], a[36:39], v[136:139]
  buffer_store_dwordx4 v[16:19], v211, s[52:55], s6 offen sc1
  v_mul_f32 v67, v35, v67
  v_mfma_f32_16x16x32_bf16 v[144:147], v[168:171], a[40:43], v[144:147]
  v_mul_f32 v68, v36, v68
  v_mul_f32 v69, v37, v69
  v_mfma_f32_16x16x32_bf16 v[152:155], v[168:171], a[44:47], v[152:155]
  v_mul_f32 v70, v38, v70
  v_mul_f32 v71, v39, v71
  v_mfma_f32_16x16x32_bf16 v[132:135], v[172:175], a[32:35], v[132:135]
  v_mul_f32 v32, 0xbfb8aa3b, v32
  v_mul_f32 v33, 0xbfb8aa3b, v33
  v_mfma_f32_16x16x32_bf16 v[140:143], v[172:175], a[36:39], v[140:143]
  v_mul_f32 v34, 0xbfb8aa3b, v34
  v_mul_f32 v35, 0xbfb8aa3b, v35
  v_mfma_f32_16x16x32_bf16 v[148:151], v[172:175], a[40:43], v[148:151]
  v_mul_f32 v36, 0xbfb8aa3b, v36
  v_mul_f32 v37, 0xbfb8aa3b, v37
  v_mfma_f32_16x16x32_bf16 v[156:159], v[172:175], a[44:47], v[156:159]
  v_mul_f32 v38, 0xbfb8aa3b, v38
  v_mul_f32 v39, 0xbfb8aa3b, v39
  v_mfma_f32_16x16x32_bf16 v[96:99], v[176:179], a[48:51], v[96:99]
  v_exp_f32 v32, v32
  v_mfma_f32_16x16x32_bf16 v[104:107], v[176:179], a[52:55], v[104:107]
  v_exp_f32 v33, v33
  v_mfma_f32_16x16x32_bf16 v[112:115], v[176:179], a[56:59], v[112:115]
  s_waitcnt vmcnt(12) lgkmcnt(0)
  s_barrier
  v_mfma_f32_16x16x32_bf16 v[120:123], v[176:179], a[60:63], v[120:123]
  buffer_store_dwordx4 v[20:23], v211, s[52:55], s7 offen sc1
  ds_read_b64_tr_b16 v[160:161], v206 offset:0
  v_mfma_f32_16x16x32_bf16 v[100:103], v[180:183], a[48:51], v[100:103]
  ds_read_b64_tr_b16 v[162:163], v206 offset:512
  ds_read_b64_tr_b16 v[164:165], v207 offset:0
  v_mfma_f32_16x16x32_bf16 v[108:111], v[180:183], a[52:55], v[108:111]
  ds_read_b64_tr_b16 v[166:167], v207 offset:512
  v_add_f32 v32, 1.0, v32
  v_mfma_f32_16x16x32_bf16 v[116:119], v[180:183], a[56:59], v[116:119]
  ds_read_b64_tr_b16 v[168:169], v206 offset:8192
  v_add_f32 v33, 1.0, v33
  v_mfma_f32_16x16x32_bf16 v[124:127], v[180:183], a[60:63], v[124:127]
  ds_read_b64_tr_b16 v[170:171], v206 offset:8704
  s_add_u32 s62, s69, 0
  v_mfma_f32_16x16x32_bf16 v[128:131], v[184:187], a[48:51], v[128:131]
  ds_read_b64_tr_b16 v[172:173], v207 offset:8192
  v_mul_f32 v72, v40, v72
  v_mfma_f32_16x16x32_bf16 v[136:139], v[184:187], a[52:55], v[136:139]
  ds_read_b64_tr_b16 v[174:175], v207 offset:8704
  v_mul_f32 v73, v41, v73
  v_mfma_f32_16x16x32_bf16 v[144:147], v[184:187], a[56:59], v[144:147]
  ds_read_b64_tr_b16 v[176:177], v206 offset:4096
  v_mul_f32 v74, v42, v74
  v_mfma_f32_16x16x32_bf16 v[152:155], v[184:187], a[60:63], v[152:155]
  ds_read_b64_tr_b16 v[178:179], v206 offset:4608
  v_mul_f32 v75, v43, v75
  v_mfma_f32_16x16x32_bf16 v[132:135], v[188:191], a[48:51], v[132:135]
  ds_read_b64_tr_b16 v[180:181], v207 offset:4096
  v_mul_f32 v76, v44, v76
  v_mfma_f32_16x16x32_bf16 v[140:143], v[188:191], a[52:55], v[140:143]
  ds_read_b64_tr_b16 v[182:183], v207 offset:4608
  v_mul_f32 v77, v45, v77
  v_mfma_f32_16x16x32_bf16 v[148:151], v[188:191], a[56:59], v[148:151]
  ds_read_b64_tr_b16 v[184:185], v206 offset:12288
  v_mul_f32 v78, v46, v78
  v_mfma_f32_16x16x32_bf16 v[156:159], v[188:191], a[60:63], v[156:159]
  s_waitcnt lgkmcnt(9)
  ds_read_b64_tr_b16 v[186:187], v206 offset:12800
  v_mfma_f32_16x16x32_bf16 v[96:99], v[160:163], a[64:67], v[96:99]
  ds_read_b64_tr_b16 v[188:189], v207 offset:12288
  v_mul_f32 v79, v47, v79
  v_mfma_f32_16x16x32_bf16 v[104:107], v[160:163], a[68:71], v[104:107]
  ds_read_b64_tr_b16 v[190:191], v207 offset:12800
  v_mul_f32 v40, 0xbfb8aa3b, v40
  v_mfma_f32_16x16x32_bf16 v[112:115], v[160:163], a[72:75], v[112:115]
  v_exp_f32 v34, v34
  v_mfma_f32_16x16x32_bf16 v[120:123], v[160:163], a[76:79], v[120:123]
  ds_read_b64_tr_b16 v[160:161], v206 offset:16384
  ds_read_b64_tr_b16 v[162:163], v206 offset:16896
  v_mfma_f32_16x16x32_bf16 v[100:103], v[164:167], a[64:67], v[100:103]
  v_exp_f32 v35, v35
  v_mfma_f32_16x16x32_bf16 v[108:111], v[164:167], a[68:71], v[108:111]
  v_exp_f32 v36, v36
  v_mfma_f32_16x16x32_bf16 v[116:119], v[164:167], a[72:75], v[116:119]
  v_exp_f32 v37, v37
  v_mfma_f32_16x16x32_bf16 v[124:127], v[164:167], a[76:79], v[124:127]
  s_waitcnt lgkmcnt(6)
  ds_read_b64_tr_b16 v[164:165], v207 offset:16384
  v_mfma_f32_16x16x32_bf16 v[128:131], v[168:171], a[64:67], v[128:131]
  ds_read_b64_tr_b16 v[166:167], v207 offset:16896
  v_add_f32 v34, 1.0, v34
  v_mfma_f32_16x16x32_bf16 v[136:139], v[168:171], a[68:71], v[136:139]
  v_exp_f32 v38, v38
  v_mfma_f32_16x16x32_bf16 v[144:147], v[168:171], a[72:75], v[144:147]
  v_exp_f32 v39, v39
  v_mfma_f32_16x16x32_bf16 v[152:155], v[168:171], a[76:79], v[152:155]
  ds_read_b64_tr_b16 v[168:169], v206 offset:24576
  ds_read_b64_tr_b16 v[170:171], v206 offset:25088
  v_mfma_f32_16x16x32_bf16 v[132:135], v[172:175], a[64:67], v[132:135]
  v_add_f32 v35, 1.0, v35
  v_add_f32 v36, 1.0, v36
  v_mfma_f32_16x16x32_bf16 v[140:143], v[172:175], a[68:71], v[140:143]
  v_add_f32 v37, 1.0, v37
  v_add_f32 v38, 1.0, v38
  v_mfma_f32_16x16x32_bf16 v[148:151], v[172:175], a[72:75], v[148:151]
  v_add_f32 v39, 1.0, v39
  v_mul_f32 v41, 0xbfb8aa3b, v41
  v_mfma_f32_16x16x32_bf16 v[156:159], v[172:175], a[76:79], v[156:159]
  ds_read_b64_tr_b16 v[172:173], v207 offset:24576
  ds_read_b64_tr_b16 v[174:175], v207 offset:25088
  v_mfma_f32_16x16x32_bf16 v[96:99], v[176:179], a[80:83], v[96:99]
  v_rcp_f32 v32, v32
  v_mfma_f32_16x16x32_bf16 v[104:107], v[176:179], a[84:87], v[104:107]
  v_rcp_f32 v33, v33
  v_mfma_f32_16x16x32_bf16 v[112:115], v[176:179], a[88:91], v[112:115]
  v_rcp_f32 v34, v34
  v_mfma_f32_16x16x32_bf16 v[120:123], v[176:179], a[92:95], v[120:123]
  ds_read_b64_tr_b16 v[176:177], v206 offset:20480
  ds_read_b64_tr_b16 v[178:179], v206 offset:20992
  v_mfma_f32_16x16x32_bf16 v[100:103], v[180:183], a[80:83], v[100:103]
  s_add_u32 m0, s8, 0
  v_mul_f32 v64, v64, v32
  v_mfma_f32_16x16x32_bf16 v[108:111], v[180:183], a[84:87], v[108:111]
  buffer_load_dwordx4 v232, s[88:91], s16 offen offset:0  lds
  v_mul_f32 v65, v65, v33
  v_mfma_f32_16x16x32_bf16 v[116:119], v[180:183], a[88:91], v[116:119]
  v_rcp_f32 v35, v35
  v_mfma_f32_16x16x32_bf16 v[124:127], v[180:183], a[92:95], v[124:127]
  s_waitcnt lgkmcnt(4)
  ds_read_b64_tr_b16 v[180:181], v207 offset:20480
  v_mfma_f32_16x16x32_bf16 v[128:131], v[184:187], a[80:83], v[128:131]
  ds_read_b64_tr_b16 v[182:183], v207 offset:20992
  v_mul_f32 v66, v66, v34
  v_mfma_f32_16x16x32_bf16 v[136:139], v[184:187], a[84:87], v[136:139]
  v_rcp_f32 v36, v36
  v_mfma_f32_16x16x32_bf16 v[144:147], v[184:187], a[88:91], v[144:147]
  v_rcp_f32 v37, v37
  v_mfma_f32_16x16x32_bf16 v[152:155], v[184:187], a[92:95], v[152:155]
  ds_read_b64_tr_b16 v[184:185], v206 offset:28672
  ds_read_b64_tr_b16 v[186:187], v206 offset:29184
  v_mfma_f32_16x16x32_bf16 v[132:135], v[188:191], a[80:83], v[132:135]
  v_add_u32 v206, 0xa000, v206
  v_mul_f32 v67, v67, v35
  v_mfma_f32_16x16x32_bf16 v[140:143], v[188:191], a[84:87], v[140:143]
  buffer_load_dwordx4 v233, s[88:91], s16 offen offset:1024  lds
  v_mul_f32 v68, v68, v36
  v_mfma_f32_16x16x32_bf16 v[148:151], v[188:191], a[88:91], v[148:151]
  v_rcp_f32 v38, v38
  v_mfma_f32_16x16x32_bf16 v[156:159], v[188:191], a[92:95], v[156:159]
  ds_read_b64_tr_b16 v[188:189], v207 offset:28672
  ds_read_b64_tr_b16 v[190:191], v207 offset:29184
  v_mfma_f32_16x16x32_bf16 v[96:99], v[160:163], a[96:99], v[96:99]
  v_add_u32 v207, 0xa000, v207
  v_mul_f32 v69, v69, v37
  v_mfma_f32_16x16x32_bf16 v[104:107], v[160:163], a[100:103], v[104:107]
  v_rcp_f32 v39, v39
  v_mfma_f32_16x16x32_bf16 v[112:115], v[160:163], a[104:107], v[112:115]
  v_mul_f32 v70, v70, v38
  v_mul_f32 v71, v71, v39
  v_mfma_f32_16x16x32_bf16 v[120:123], v[160:163], a[108:111], v[120:123]
  ds_read_b64_tr_b16 v[160:161], v206 offset:0
  ds_read_b64_tr_b16 v[162:163], v206 offset:512
  v_mfma_f32_16x16x32_bf16 v[100:103], v[164:167], a[96:99], v[100:103]
  buffer_load_dwordx4 v234, s[88:91], s16 offen offset:2048  lds
  v_cvt_pk_bf16_f32 v32, v64, v65
  v_mfma_f32_16x16x32_bf16 v[108:111], v[164:167], a[100:103], v[108:111]
  v_cvt_pk_bf16_f32 v33, v66, v67
  v_cvt_pk_bf16_f32 v34, v68, v69
  v_mfma_f32_16x16x32_bf16 v[116:119], v[164:167], a[104:107], v[116:119]
  v_cvt_pk_bf16_f32 v35, v70, v71
  v_mul_f32 v42, 0xbfb8aa3b, v42
  v_mfma_f32_16x16x32_bf16 v[124:127], v[164:167], a[108:111], v[124:127]
  ds_read_b64_tr_b16 v[164:165], v207 offset:0
  ds_read_b64_tr_b16 v[166:167], v207 offset:512
  v_mfma_f32_16x16x32_bf16 v[128:131], v[168:171], a[96:99], v[128:131]
  buffer_store_dwordx4 v[32:35], v211, s[52:55], s62 offen offset:0 sc1
  v_mul_f32 v43, 0xbfb8aa3b, v43
  v_mfma_f32_16x16x32_bf16 v[136:139], v[168:171], a[100:103], v[136:139]
  v_mul_f32 v44, 0xbfb8aa3b, v44
  v_mul_f32 v45, 0xbfb8aa3b, v45
  v_mfma_f32_16x16x32_bf16 v[144:147], v[168:171], a[104:107], v[144:147]
  v_mul_f32 v46, 0xbfb8aa3b, v46
  v_mul_f32 v47, 0xbfb8aa3b, v47
  v_mfma_f32_16x16x32_bf16 v[152:155], v[168:171], a[108:111], v[152:155]
  s_waitcnt lgkmcnt(4)
  ds_read_b64_tr_b16 v[168:169], v206 offset:8192
  v_mfma_f32_16x16x32_bf16 v[132:135], v[172:175], a[96:99], v[132:135]
  ds_read_b64_tr_b16 v[170:171], v206 offset:8704
  buffer_load_dwordx4 v235, s[88:91], s16 offen offset:3072  lds
  v_mfma_f32_16x16x32_bf16 v[140:143], v[172:175], a[100:103], v[140:143]
  s_add_u32 s16, s14, 65536
  v_mul_f32 v80, v48, v80
  v_mfma_f32_16x16x32_bf16 v[148:151], v[172:175], a[104:107], v[148:151]
  v_exp_f32 v40, v40
  v_mfma_f32_16x16x32_bf16 v[156:159], v[172:175], a[108:111], v[156:159]
  ds_read_b64_tr_b16 v[172:173], v207 offset:8192
  ds_read_b64_tr_b16 v[174:175], v207 offset:8704
  v_mfma_f32_16x16x32_bf16 v[96:99], v[176:179], a[112:115], v[96:99]
  v_exp_f32 v41, v41
  v_mfma_f32_16x16x32_bf16 v[104:107], v[176:179], a[116:119], v[104:107]
  v_exp_f32 v42, v42
  v_mfma_f32_16x16x32_bf16 v[112:115], v[176:179], a[120:123], v[112:115]
  s_waitcnt vmcnt(10)
  s_barrier
  v_mfma_f32_16x16x32_bf16 v[120:123], v[176:179], a[124:127], v[120:123]
  s_waitcnt vmcnt(5)
  buffer_store_dwordx2 v[216:217], v252, s[52:55], s61 offen sc1
  v_mfma_f32_16x16x32_bf16 v[100:103], v[180:183], a[112:115], v[100:103]
  ds_read_b64_tr_b16 v[176:177], v206 offset:4096
  ds_read_b64_tr_b16 v[178:179], v206 offset:4608
  v_mfma_f32_16x16x32_bf16 v[108:111], v[180:183], a[116:119], v[108:111]
  s_add_u32 m0, s8, 81920
  v_add_f32 v40, 1.0, v40
  v_mfma_f32_16x16x32_bf16 v[116:119], v[180:183], a[120:123], v[116:119]
  buffer_load_dwordx4 v232, s[88:91], s16 offen offset:0  lds
  v_add_f32 v41, 1.0, v41
  v_mfma_f32_16x16x32_bf16 v[124:127], v[180:183], a[124:127], v[124:127]
  ds_read_b64_tr_b16 v[180:181], v207 offset:4096
  ds_read_b64_tr_b16 v[182:183], v207 offset:4608
  v_mfma_f32_16x16x32_bf16 v[128:131], v[184:187], a[112:115], v[128:131]
  v_exp_f32 v43, v43
  v_mfma_f32_16x16x32_bf16 v[136:139], v[184:187], a[116:119], v[136:139]
  v_exp_f32 v44, v44
  v_mfma_f32_16x16x32_bf16 v[144:147], v[184:187], a[120:123], v[144:147]
  v_exp_f32 v45, v45
  v_mfma_f32_16x16x32_bf16 v[152:155], v[184:187], a[124:127], v[152:155]
  ds_read_b64_tr_b16 v[184:185], v206 offset:12288
  ds_read_b64_tr_b16 v[186:187], v206 offset:12800
  v_mfma_f32_16x16x32_bf16 v[132:135], v[188:191], a[112:115], v[132:135]
  v_exp_f32 v46, v46
  v_mfma_f32_16x16x32_bf16 v[140:143], v[188:191], a[116:119], v[140:143]
  buffer_load_dwordx4 v233, s[88:91], s16 offen offset:1024  lds
  v_add_f32 v42, 1.0, v42
  v_mfma_f32_16x16x32_bf16 v[148:151], v[188:191], a[120:123], v[148:151]
  v_exp_f32 v47, v47
  v_mfma_f32_16x16x32_bf16 v[156:159], v[188:191], a[124:127], v[156:159]
  s_waitcnt lgkmcnt(4)
  ds_read_b64_tr_b16 v[188:189], v207 offset:12288
  v_mfma_f32_16x16x32_bf16 v[96:99], v[160:163], a[128:131], v[96:99]
  ds_read_b64_tr_b16 v[190:191], v207 offset:12800
  v_add_f32 v43, 1.0, v43
  v_mfma_f32_16x16x32_bf16 v[104:107], v[160:163], a[132:135], v[104:107]
  v_add_f32 v44, 1.0, v44
  v_add_f32 v45, 1.0, v45
  v_mfma_f32_16x16x32_bf16 v[112:115], v[160:163], a[136:139], v[112:115]
  v_add_f32 v46, 1.0, v46
  v_add_f32 v47, 1.0, v47
  v_mfma_f32_16x16x32_bf16 v[120:123], v[160:163], a[140:143], v[120:123]
  ds_read_b64_tr_b16 v[160:161], v206 offset:16384
  ds_read_b64_tr_b16 v[162:163], v206 offset:16896
  v_mfma_f32_16x16x32_bf16 v[100:103], v[164:167], a[128:131], v[100:103]
  buffer_load_dwordx4 v234, s[88:91], s16 offen offset:2048  lds
  v_mul_f32 v81, v49, v81
  v_mfma_f32_16x16x32_bf16 v[108:111], v[164:167], a[132:135], v[108:111]
  v_rcp_f32 v40, v40
  v_mfma_f32_16x16x32_bf16 v[116:119], v[164:167], a[136:139], v[116:119]
  v_rcp_f32 v41, v41
  v_mfma_f32_16x16x32_bf16 v[124:127], v[164:167], a[140:143], v[124:127]
  ds_read_b64_tr_b16 v[164:165], v207 offset:16384
  ds_read_b64_tr_b16 v[166:167], v207 offset:16896
  v_mfma_f32_16x16x32_bf16 v[128:131], v[168:171], a[128:131], v[128:131]
  v_rcp_f32 v42, v42
  v_mfma_f32_16x16x32_bf16 v[136:139], v[168:171], a[132:135], v[136:139]
  v_rcp_f32 v43, v43
  v_mfma_f32_16x16x32_bf16 v[144:147], v[168:171], a[136:139], v[144:147]
  v_rcp_f32 v44, v44
  v_mfma_f32_16x16x32_bf16 v[152:155], v[168:171], a[140:143], v[152:155]
  ds_read_b64_tr_b16 v[168:169], v206 offset:24576
  ds_read_b64_tr_b16 v[170:171], v206 offset:25088
  v_mfma_f32_16x16x32_bf16 v[132:135], v[172:175], a[128:131], v[132:135]
  buffer_load_dwordx4 v235, s[88:91], s16 offen offset:3072  lds
  s_add_u32 s16, s14, 131072
  v_mfma_f32_16x16x32_bf16 v[140:143], v[172:175], a[132:135], v[140:143]
  v_rcp_f32 v45, v45
  v_mfma_f32_16x16x32_bf16 v[148:151], v[172:175], a[136:139], v[148:151]
  v_rcp_f32 v46, v46
  v_mfma_f32_16x16x32_bf16 v[156:159], v[172:175], a[140:143], v[156:159]
  ds_read_b64_tr_b16 v[172:173], v207 offset:24576
  ds_read_b64_tr_b16 v[174:175], v207 offset:25088
  v_mfma_f32_16x16x32_bf16 v[96:99], v[176:179], a[144:147], v[96:99]
  v_rcp_f32 v47, v47
  v_mfma_f32_16x16x32_bf16 v[104:107], v[176:179], a[148:151], v[104:107]
  v_mul_f32 v72, v72, v40
  v_mul_f32 v73, v73, v41
  v_mfma_f32_16x16x32_bf16 v[112:115], v[176:179], a[152:155], v[112:115]
  v_mul_f32 v74, v74, v42
  v_mul_f32 v75, v75, v43
  v_mfma_f32_16x16x32_bf16 v[120:123], v[176:179], a[156:159], v[120:123]
  s_waitcnt lgkmcnt(4)
  ds_read_b64_tr_b16 v[176:177], v206 offset:20480
  v_mfma_f32_16x16x32_bf16 v[100:103], v[180:183], a[144:147], v[100:103]
  ds_read_b64_tr_b16 v[178:179], v206 offset:20992
  s_add_u32 m0, s59, 0
  v_mfma_f32_16x16x32_bf16 v[108:111], v[180:183], a[148:151], v[108:111]
  buffer_load_dwordx4 v232, s[88:91], s16 offen offset:0  lds
  v_mul_f32 v76, v76, v44
  v_mfma_f32_16x16x32_bf16 v[116:119], v[180:183], a[152:155], v[116:119]
  v_mul_f32 v77, v77, v45
  v_mul_f32 v78, v78, v46
  v_mfma_f32_16x16x32_bf16 v[124:127], v[180:183], a[156:159], v[124:127]
  ds_read_b64_tr_b16 v[180:181], v207 offset:20480
  ds_read_b64_tr_b16 v[182:183], v207 offset:20992
  v_mfma_f32_16x16x32_bf16 v[128:131], v[184:187], a[144:147], v[128:131]
  v_mul_f32 v79, v79, v47
  v_cvt_pk_bf16_f32 v40, v72, v73
  v_mfma_f32_16x16x32_bf16 v[136:139], v[184:187], a[148:151], v[136:139]
  v_cvt_pk_bf16_f32 v41, v74, v75
  v_cvt_pk_bf16_f32 v42, v76, v77
  v_mfma_f32_16x16x32_bf16 v[144:147], v[184:187], a[152:155], v[144:147]
  v_cvt_pk_bf16_f32 v43, v78, v79
  v_mul_f32 v82, v50, v82
  v_mfma_f32_16x16x32_bf16 v[152:155], v[184:187], a[156:159], v[152:155]
  ds_read_b64_tr_b16 v[184:185], v206 offset:28672
  ds_read_b64_tr_b16 v[186:187], v206 offset:29184
  v_mfma_f32_16x16x32_bf16 v[132:135], v[188:191], a[144:147], v[132:135]
  buffer_load_dwordx4 v233, s[88:91], s16 offen offset:1024  lds
  v_add_u32 v206, 0xa000, v206
  v_mfma_f32_16x16x32_bf16 v[140:143], v[188:191], a[148:151], v[140:143]
  buffer_store_dwordx4 v[40:43], v211, s[52:55], s62 offen offset:1024 sc1
  v_mul_f32 v83, v51, v83
  v_mfma_f32_16x16x32_bf16 v[148:151], v[188:191], a[152:155], v[148:151]
  v_mul_f32 v84, v52, v84
  v_mul_f32 v85, v53, v85
  v_mfma_f32_16x16x32_bf16 v[156:159], v[188:191], a[156:159], v[156:159]
  ds_read_b64_tr_b16 v[188:189], v207 offset:28672
  ds_read_b64_tr_b16 v[190:191], v207 offset:29184
  v_mfma_f32_16x16x32_bf16 v[96:99], v[160:163], a[160:163], v[96:99]
  v_add_u32 v207, 0xa000, v207
  v_mul_f32 v86, v54, v86
  v_mfma_f32_16x16x32_bf16 v[104:107], v[160:163], a[164:167], v[104:107]
  v_mul_f32 v87, v55, v87
  v_mul_f32 v48, 0xbfb8aa3b, v48
  v_mfma_f32_16x16x32_bf16 v[112:115], v[160:163], a[168:171], v[112:115]
  v_mul_f32 v49, 0xbfb8aa3b, v49
  v_mul_f32 v50, 0xbfb8aa3b, v50
  v_mfma_f32_16x16x32_bf16 v[120:123], v[160:163], a[172:175], v[120:123]
  ds_read_b64_tr_b16 v[160:161], v206 offset:0
  ds_read_b64_tr_b16 v[162:163], v206 offset:512
  v_mfma_f32_16x16x32_bf16 v[100:103], v[164:167], a[160:163], v[100:103]
  buffer_load_dwordx4 v234, s[88:91], s16 offen offset:2048  lds
  v_mul_f32 v51, 0xbfb8aa3b, v51
  v_mfma_f32_16x16x32_bf16 v[108:111], v[164:167], a[164:167], v[108:111]
  v_mul_f32 v52, 0xbfb8aa3b, v52
  v_mul_f32 v53, 0xbfb8aa3b, v53
  v_mfma_f32_16x16x32_bf16 v[116:119], v[164:167], a[168:171], v[116:119]
  v_mul_f32 v54, 0xbfb8aa3b, v54
  v_mul_f32 v55, 0xbfb8aa3b, v55
  v_mfma_f32_16x16x32_bf16 v[124:127], v[164:167], a[172:175], v[124:127]
  s_waitcnt lgkmcnt(4)
  ds_read_b64_tr_b16 v[164:165], v207 offset:0
  v_mfma_f32_16x16x32_bf16 v[128:131], v[168:171], a[160:163], v[128:131]
  ds_read_b64_tr_b16 v[166:167], v207 offset:512
  v_mul_f32 v88, v56, v88
  v_mfma_f32_16x16x32_bf16 v[136:139], v[168:171], a[164:167], v[136:139]
  v_exp_f32 v48, v48
  v_mfma_f32_16x16x32_bf16 v[144:147], v[168:171], a[168:171], v[144:147]
  v_exp_f32 v49, v49
  v_mfma_f32_16x16x32_bf16 v[152:155], v[168:171], a[172:175], v[152:155]
  ds_read_b64_tr_b16 v[168:169], v206 offset:8192
  ds_read_b64_tr_b16 v[170:171], v206 offset:8704
  v_mfma_f32_16x16x32_bf16 v[132:135], v[172:175], a[160:163], v[132:135]
  buffer_load_dwordx4 v235, s[88:91], s16 offen offset:3072  lds
  s_add_u32 s16, s15, 0
  v_mfma_f32_16x16x32_bf16 v[140:143], v[172:175], a[164:167], v[140:143]
  v_exp_f32 v50, v50
  v_mfma_f32_16x16x32_bf16 v[148:151], v[172:175], a[168:171], v[148:151]
  v_exp_f32 v51, v51
  v_mfma_f32_16x16x32_bf16 v[156:159], v[172:175], a[172:175], v[156:159]
  ds_read_b64_tr_b16 v[172:173], v207 offset:8192
  ds_read_b64_tr_b16 v[174:175], v207 offset:8704
  v_mfma_f32_16x16x32_bf16 v[96:99], v[176:179], a[176:179], v[96:99]
  v_exp_f32 v52, v52
  v_mfma_f32_16x16x32_bf16 v[104:107], v[176:179], a[180:183], v[104:107]
  v_exp_f32 v53, v53
  v_mfma_f32_16x16x32_bf16 v[112:115], v[176:179], a[184:187], v[112:115]
  s_waitcnt lgkmcnt(4)
  s_barrier
  v_mfma_f32_16x16x32_bf16 v[120:123], v[176:179], a[188:191], v[120:123]
  ds_read_b64_tr_b16 v[176:177], v206 offset:4096
  ds_read_b64_tr_b16 v[178:179], v206 offset:4608
  v_mfma_f32_16x16x32_bf16 v[100:103], v[180:183], a[176:179], v[100:103]
  s_add_u32 m0, s59, 16384
  v_add_f32 v48, 1.0, v48
  v_mfma_f32_16x16x32_bf16 v[108:111], v[180:183], a[180:183], v[108:111]
  buffer_load_dwordx4 v232, s[88:91], s16 offen offset:0  lds
  v_add_f32 v49, 1.0, v49
  v_mfma_f32_16x16x32_bf16 v[116:119], v[180:183], a[184:187], v[116:119]
  v_exp_f32 v54, v54
  v_mfma_f32_16x16x32_bf16 v[124:127], v[180:183], a[188:191], v[124:127]
  ds_read_b64_tr_b16 v[180:181], v207 offset:4096
  ds_read_b64_tr_b16 v[182:183], v207 offset:4608
  v_mfma_f32_16x16x32_bf16 v[128:131], v[184:187], a[176:179], v[128:131]
  v_exp_f32 v55, v55
  v_mfma_f32_16x16x32_bf16 v[136:139], v[184:187], a[180:183], v[136:139]
  v_add_f32 v50, 1.0, v50
  v_add_f32 v51, 1.0, v51
  v_mfma_f32_16x16x32_bf16 v[144:147], v[184:187], a[184:187], v[144:147]
  v_add_f32 v52, 1.0, v52
  v_add_f32 v53, 1.0, v53
  v_mfma_f32_16x16x32_bf16 v[152:155], v[184:187], a[188:191], v[152:155]
  ds_read_b64_tr_b16 v[184:185], v206 offset:12288
  ds_read_b64_tr_b16 v[186:187], v206 offset:12800
  v_mfma_f32_16x16x32_bf16 v[132:135], v[188:191], a[176:179], v[132:135]
  buffer_load_dwordx4 v233, s[88:91], s16 offen offset:1024  lds
  v_add_f32 v54, 1.0, v54
  v_mfma_f32_16x16x32_bf16 v[140:143], v[188:191], a[180:183], v[140:143]
  v_add_f32 v55, 1.0, v55
  v_mul_f32 v89, v57, v89
  v_mfma_f32_16x16x32_bf16 v[148:151], v[188:191], a[184:187], v[148:151]
  v_rcp_f32 v48, v48
  v_mfma_f32_16x16x32_bf16 v[156:159], v[188:191], a[188:191], v[156:159]
  ds_read_b64_tr_b16 v[188:189], v207 offset:12288
  ds_read_b64_tr_b16 v[190:191], v207 offset:12800
  v_mfma_f32_16x16x32_bf16 v[96:99], v[160:163], a[192:195], v[96:99]
  v_rcp_f32 v49, v49
  v_mfma_f32_16x16x32_bf16 v[104:107], v[160:163], a[196:199], v[104:107]
  v_rcp_f32 v50, v50
  v_mfma_f32_16x16x32_bf16 v[112:115], v[160:163], a[200:203], v[112:115]
  v_rcp_f32 v51, v51
  v_mfma_f32_16x16x32_bf16 v[120:123], v[160:163], a[204:207], v[120:123]
  buffer_load_dwordx4 v234, s[88:91], s16 offen offset:2048  lds
  ds_read_b64_tr_b16 v[160:161], v206 offset:16384
  v_mfma_f32_16x16x32_bf16 v[100:103], v[164:167], a[192:195], v[100:103]
  ds_read_b64_tr_b16 v[162:163], v206 offset:16896
  v_mul_f32 v80, v80, v48
  v_mfma_f32_16x16x32_bf16 v[108:111], v[164:167], a[196:199], v[108:111]
  v_rcp_f32 v52, v52
  v_mfma_f32_16x16x32_bf16 v[116:119], v[164:167], a[200:203], v[116:119]
  v_rcp_f32 v53, v53
  v_mfma_f32_16x16x32_bf16 v[124:127], v[164:167], a[204:207], v[124:127]
  s_waitcnt lgkmcnt(4)
  ds_read_b64_tr_b16 v[164:165], v207 offset:16384
  v_mfma_f32_16x16x32_bf16 v[128:131], v[168:171], a[192:195], v[128:131]
  ds_read_b64_tr_b16 v[166:167], v207 offset:16896
  v_mul_f32 v81, v81, v49
  v_mfma_f32_16x16x32_bf16 v[136:139], v[168:171], a[196:199], v[136:139]
  v_rcp_f32 v54, v54
  v_mfma_f32_16x16x32_bf16 v[144:147], v[168:171], a[200:203], v[144:147]
  buffer_load_dwordx4 v235, s[88:91], s16 offen offset:3072  lds
  v_mul_f32 v82, v82, v50
  v_mfma_f32_16x16x32_bf16 v[152:155], v[168:171], a[204:207], v[152:155]
  ds_read_b64_tr_b16 v[168:169], v206 offset:24576
  ds_read_b64_tr_b16 v[170:171], v206 offset:25088
  v_mfma_f32_16x16x32_bf16 v[132:135], v[172:175], a[192:195], v[132:135]
  v_rcp_f32 v55, v55
  v_mfma_f32_16x16x32_bf16 v[140:143], v[172:175], a[196:199], v[140:143]
  v_mul_f32 v83, v83, v51
  v_mul_f32 v84, v84, v52
  v_mfma_f32_16x16x32_bf16 v[148:151], v[172:175], a[200:203], v[148:151]
  v_mul_f32 v85, v85, v53
  v_mul_f32 v86, v86, v54
  v_mfma_f32_16x16x32_bf16 v[156:159], v[172:175], a[204:207], v[156:159]
  ds_read_b64_tr_b16 v[172:173], v207 offset:24576
  ds_read_b64_tr_b16 v[174:175], v207 offset:25088
  v_mfma_f32_16x16x32_bf16 v[96:99], v[176:179], a[208:211], v[96:99]
  v_mul_f32 v87, v87, v55
  v_cvt_pk_bf16_f32 v48, v80, v81
L_pg3:
  s_cbranch_execz L_pg7
  v_mfma_f32_16x16x32_bf16 v[104:107], v[176:179], a[212:215], v[104:107]
  v_cvt_pk_bf16_f32 v49, v82, v83
  v_cvt_pk_bf16_f32 v50, v84, v85
  v_mfma_f32_16x16x32_bf16 v[112:115], v[176:179], a[216:219], v[112:115]
  v_cvt_pk_bf16_f32 v51, v86, v87
  v_mul_f32 v90, v58, v90
  v_mfma_f32_16x16x32_bf16 v[120:123], v[176:179], a[220:223], v[120:123]
  buffer_store_dwordx4 v[48:51], v211, s[52:55], s63 offen offset:0 sc1
  v_mul_f32 v91, v59, v91
  v_mfma_f32_16x16x32_bf16 v[100:103], v[180:183], a[208:211], v[100:103]
  v_mul_f32 v92, v60, v92
  v_mul_f32 v93, v61, v93
  v_mfma_f32_16x16x32_bf16 v[108:111], v[180:183], a[212:215], v[108:111]
  v_mul_f32 v94, v62, v94
  v_mul_f32 v95, v63, v95
  v_mfma_f32_16x16x32_bf16 v[116:119], v[180:183], a[216:219], v[116:119]
  v_mul_f32 v56, 0xbfb8aa3b, v56
  v_mul_f32 v57, 0xbfb8aa3b, v57
  v_mfma_f32_16x16x32_bf16 v[124:127], v[180:183], a[220:223], v[124:127]
  v_mul_f32 v58, 0xbfb8aa3b, v58
  v_mul_f32 v59, 0xbfb8aa3b, v59
  v_mfma_f32_16x16x32_bf16 v[128:131], v[184:187], a[208:211], v[128:131]
  v_mul_f32 v60, 0xbfb8aa3b, v60
  v_mul_f32 v61, 0xbfb8aa3b, v61
  v_mfma_f32_16x16x32_bf16 v[136:139], v[184:187], a[212:215], v[136:139]
  v_mul_f32 v62, 0xbfb8aa3b, v62
  v_mul_f32 v63, 0xbfb8aa3b, v63
  v_mfma_f32_16x16x32_bf16 v[144:147], v[184:187], a[216:219], v[144:147]
  v_exp_f32 v56, v56
  v_mfma_f32_16x16x32_bf16 v[152:155], v[184:187], a[220:223], v[152:155]
  s_waitcnt lgkmcnt(0)
  v_add_f32 v56, 1.0, v56
  v_mfma_f32_16x16x32_bf16 v[132:135], v[188:191], a[208:211], v[132:135]
  v_exp_f32 v57, v57
  v_mfma_f32_16x16x32_bf16 v[140:143], v[188:191], a[212:215], v[140:143]
  v_exp_f32 v58, v58
  v_mfma_f32_16x16x32_bf16 v[148:151], v[188:191], a[216:219], v[148:151]
  v_exp_f32 v59, v59
  v_mfma_f32_16x16x32_bf16 v[156:159], v[188:191], a[220:223], v[156:159]
  v_exp_f32 v60, v60
  v_exp_f32 v61, v61
  v_exp_f32 v62, v62
  v_exp_f32 v63, v63
  v_add_f32 v57, 1.0, v57
  v_add_f32 v58, 1.0, v58
  v_add_f32 v59, 1.0, v59
  v_add_f32 v60, 1.0, v60
  v_add_f32 v61, 1.0, v61
  v_add_f32 v62, 1.0, v62
  v_add_f32 v63, 1.0, v63
  v_rcp_f32 v56, v56
  v_rcp_f32 v57, v57
  v_rcp_f32 v58, v58
  v_rcp_f32 v59, v59
  v_rcp_f32 v60, v60
  v_rcp_f32 v61, v61
  v_rcp_f32 v62, v62
  v_rcp_f32 v63, v63
  v_mul_f32 v88, v88, v56
  v_mul_f32 v89, v89, v57
  v_mul_f32 v90, v90, v58
  v_mul_f32 v91, v91, v59
  v_mul_f32 v92, v92, v60
  v_mul_f32 v93, v93, v61
  v_mul_f32 v94, v94, v62
  v_mul_f32 v95, v95, v63
  v_cvt_pk_bf16_f32 v56, v88, v89
  v_cvt_pk_bf16_f32 v57, v90, v91
  v_cvt_pk_bf16_f32 v58, v92, v93
  v_cvt_pk_bf16_f32 v59, v94, v95
  s_waitcnt lgkmcnt(0)
  buffer_store_dwordx4 v[56:59], v211, s[52:55], s63 offen offset:1024 sc1
L_join:
  v_mfma_f32_16x16x32_bf16 v[96:99], v[160:163], a[224:227], v[96:99]
  ds_read_b64_tr_b16 v[176:177], v206 offset:20480
  ds_read_b64_tr_b16 v[178:179], v206 offset:20992
  v_mfma_f32_16x16x32_bf16 v[104:107], v[160:163], a[228:231], v[104:107]
  ds_read_b64_tr_b16 v[180:181], v207 offset:20480
  ds_read_b64_tr_b16 v[182:183], v207 offset:20992
  v_mfma_f32_16x16x32_bf16 v[112:115], v[160:163], a[232:235], v[112:115]
  ds_read_b64_tr_b16 v[184:185], v206 offset:28672
  ds_read_b64_tr_b16 v[186:187], v206 offset:29184
  v_mfma_f32_16x16x32_bf16 v[120:123], v[160:163], a[236:239], v[120:123]
  ds_read_b64_tr_b16 v[188:189], v207 offset:28672
  ds_read_b64_tr_b16 v[190:191], v207 offset:29184
  v_mfma_f32_16x16x32_bf16 v[100:103], v[164:167], a[224:227], v[100:103]
  s_mov_b32 s100, 15794176
  buffer_load_dwordx2 v[250:251], v246, s[52:55], s100 offen sc1
  v_mfma_f32_16x16x32_bf16 v[108:111], v[164:167], a[228:231], v[108:111]
  s_add_u32 m0, s59, 40960
  s_add_u32 s16, s15, 65536
  v_mfma_f32_16x16x32_bf16 v[116:119], v[164:167], a[232:235], v[116:119]
  buffer_load_dwordx4 v232, s[88:91], s16 offen offset:0  lds
  s_add_u32 s17, s18, 0
  v_mfma_f32_16x16x32_bf16 v[124:127], v[164:167], a[236:239], v[124:127]
  s_add_u32 s60, s61, 65536
  v_mov_b32 v0, v214
  v_mfma_f32_16x16x32_bf16 v[128:131], v[168:171], a[224:227], v[128:131]
  v_mov_b32 v1, v214
  v_mov_b32 v2, v214
  v_mfma_f32_16x16x32_bf16 v[136:139], v[168:171], a[228:231], v[136:139]
  v_mov_b32 v3, v214
  s_add_u32 s62, s70, 0
  v_mfma_f32_16x16x32_bf16 v[144:147], v[168:171], a[232:235], v[144:147]
  ds_write_b128 v221, v[0:3] offset:0
  s_add_u32 s63, s70, 147456
  v_mfma_f32_16x16x32_bf16 v[152:155], v[168:171], a[236:239], v[152:155]
  s_mov_b32 s28, 0xffffffff
  s_mov_b32 s29, 0xfffffff0
  v_mfma_f32_16x16x32_bf16 v[132:135], v[172:175], a[224:227], v[132:135]
  ds_write_b128 v221, v[0:3] offset:1024
  s_mov_b32 s30, 0xfffffffe
  v_mfma_f32_16x16x32_bf16 v[140:143], v[172:175], a[228:231], v[140:143]
  buffer_load_dwordx4 v233, s[88:91], s16 offen offset:1024  lds
  s_mov_b32 s31, 0xffffffe0
  v_mfma_f32_16x16x32_bf16 v[148:151], v[172:175], a[232:235], v[148:151]
  s_mov_b32 s32, 0xfffffffc
  s_mov_b32 s33, 0xffffffc0
  v_mfma_f32_16x16x32_bf16 v[156:159], v[172:175], a[236:239], v[156:159]
  s_waitcnt lgkmcnt(2)
  ds_write_b128 v221, v[0:3] offset:2048
  v_mfma_f32_16x16x32_bf16 v[96:99], v[176:179], a[240:243], v[96:99]
  s_mov_b32 s34, 0xfffffff8
  s_mov_b32 s35, 0xffffff80
  v_mfma_f32_16x16x32_bf16 v[104:107], v[176:179], a[244:247], v[104:107]
  s_mov_b32 s36, 0xffffff00
  s_mov_b32 s37, 0xfffff000
  v_mfma_f32_16x16x32_bf16 v[112:115], v[176:179], a[248:251], v[112:115]
  s_barrier
  ds_write_b128 v221, v[0:3] offset:3072
  v_mfma_f32_16x16x32_bf16 v[120:123], v[176:179], a[252:255], v[120:123]
  s_mov_b32 s38, 0xfffffe00
  s_mov_b32 s39, 0xffffe000
  v_mfma_f32_16x16x32_bf16 v[100:103], v[180:183], a[240:243], v[100:103]
  buffer_load_dwordx4 v234, s[88:91], s16 offen offset:2048  lds
  s_mov_b32 s40, 0xfffffc00
  v_mfma_f32_16x16x32_bf16 v[108:111], v[180:183], a[244:247], v[108:111]
  s_mov_b32 s41, 0xffffc000
  s_mov_b32 s42, 0xfffff800
  v_mfma_f32_16x16x32_bf16 v[116:119], v[180:183], a[248:251], v[116:119]
  s_mov_b32 s43, 0xffff8000
  v_mov_b32 v32, 0xffff
  v_mfma_f32_16x16x32_bf16 v[124:127], v[180:183], a[252:255], v[124:127]
  v_mov_b32 v33, 0xffff0000
  v_cndmask_b32 v224, 0, v32, s[28:29]
  v_mfma_f32_16x16x32_bf16 v[128:131], v[184:187], a[240:243], v[128:131]
  v_cndmask_b32 v34, 0, v33, s[30:31]
  v_cndmask_b32 v225, 0, v32, s[32:33]
  v_mfma_f32_16x16x32_bf16 v[136:139], v[184:187], a[244:247], v[136:139]
  v_cndmask_b32 v35, 0, v33, s[34:35]
  v_cndmask_b32 v226, 0, v32, s[36:37]
  v_mfma_f32_16x16x32_bf16 v[144:147], v[184:187], a[248:251], v[144:147]
  v_cndmask_b32 v36, 0, v33, s[38:39]
  v_cndmask_b32 v227, 0, v32, s[40:41]
  v_mfma_f32_16x16x32_bf16 v[152:155], v[184:187], a[252:255], v[152:155]
  buffer_load_dwordx4 v235, s[88:91], s16 offen offset:3072  lds
  s_add_u32 s16, s15, 131072
  v_mfma_f32_16x16x32_bf16 v[132:135], v[188:191], a[240:243], v[132:135]
  s_waitcnt vmcnt(5)
  buffer_store_dwordx2 v[216:217], v252, s[52:55], s60 offen sc1
  v_mfma_f32_16x16x32_bf16 v[140:143], v[188:191], a[244:247], v[140:143]
  s_add_u32 s60, s61, 98304
  v_mul_f32 v128, v96, v128
  v_mfma_f32_16x16x32_bf16 v[148:151], v[188:191], a[248:251], v[148:151]
  v_mul_f32 v129, v97, v129
  v_mul_f32 v130, v98, v130
  v_mfma_f32_16x16x32_bf16 v[156:159], v[188:191], a[252:255], v[156:159]
  v_mul_f32 v131, v99, v131
  v_mul_f32 v132, v100, v132
  v_mul_f32 v133, v101, v133
  v_mul_f32 v134, v102, v134
  v_mul_f32 v135, v103, v135
  v_mul_f32 v96, 0xbfb8aa3b, v96
  v_mul_f32 v97, 0xbfb8aa3b, v97
  v_mul_f32 v98, 0xbfb8aa3b, v98
  v_mul_f32 v99, 0xbfb8aa3b, v99
  v_mul_f32 v100, 0xbfb8aa3b, v100
  v_mul_f32 v101, 0xbfb8aa3b, v101
  v_mul_f32 v102, 0xbfb8aa3b, v102
  v_mul_f32 v103, 0xbfb8aa3b, v103
  v_mul_f32 v136, v104, v136
  v_mul_f32 v137, v105, v137
  v_mul_f32 v138, v106, v138
  v_mul_f32 v139, v107, v139
  v_mul_f32 v140, v108, v140
  v_mul_f32 v141, v109, v141
  v_mul_f32 v142, v110, v142
  v_mul_f32 v143, v111, v143
  v_exp_f32 v96, v96
  v_exp_f32 v97, v97
  v_exp_f32 v98, v98
  v_exp_f32 v99, v99
  v_exp_f32 v100, v100
  v_exp_f32 v101, v101
  v_exp_f32 v102, v102
  v_exp_f32 v103, v103
  v_mul_f32 v104, 0xbfb8aa3b, v104
  v_mul_f32 v105, 0xbfb8aa3b, v105
  v_mul_f32 v106, 0xbfb8aa3b, v106
  v_mul_f32 v107, 0xbfb8aa3b, v107
  v_mul_f32 v108, 0xbfb8aa3b, v108
  v_mul_f32 v109, 0xbfb8aa3b, v109
  v_mul_f32 v110, 0xbfb8aa3b, v110
  v_mul_f32 v111, 0xbfb8aa3b, v111
  v_mul_f32 v144, v112, v144
  v_mul_f32 v145, v113, v145
  v_mul_f32 v146, v114, v146
  v_mul_f32 v147, v115, v147
  v_mul_f32 v148, v116, v148
  v_mul_f32 v149, v117, v149
  v_mul_f32 v150, v118, v150
  v_mul_f32 v151, v119, v151
  v_add_f32 v96, 1.0, v96
  v_add_f32 v97, 1.0, v97
  v_add_f32 v98, 1.0, v98
  v_add_f32 v99, 1.0, v99
  v_add_f32 v100, 1.0, v100
  v_add_f32 v101, 1.0, v101
  v_add_f32 v102, 1.0, v102
  v_add_f32 v103, 1.0, v103
  v_exp_f32 v104, v104
  v_exp_f32 v105, v105
  v_exp_f32 v106, v106
  v_exp_f32 v107, v107
  s_waitcnt vmcnt(5)
  v_cmp_ne_u64 vcc, v[250:251], v[216:217]
  s_nop 0
  s_cbranch_vccnz L_slow_q
L_back_q:
  s_add_u32 m0, s59, 122880
  s_mov_b32 s12, 3072
  buffer_load_dwordx4 v219, s[80:83], s12 offen offset:0 sc1 lds
  v_exp_f32 v108, v108
  v_exp_f32 v109, v109
  v_exp_f32 v110, v110
  v_exp_f32 v111, v111
  v_mul_f32 v112, 0xbfb8aa3b, v112
  v_mul_f32 v113, 0xbfb8aa3b, v113
  v_mul_f32 v114, 0xbfb8aa3b, v114
  v_mul_f32 v115, 0xbfb8aa3b, v115
  v_mul_f32 v116, 0xbfb8aa3b, v116
  v_mul_f32 v117, 0xbfb8aa3b, v117
  s_sub_u32 s12, s12, s57
  buffer_load_dwordx4 v219, s[80:83], s12 offen offset:1024 sc1 lds
  v_mul_f32 v118, 0xbfb8aa3b, v118
  v_mul_f32 v119, 0xbfb8aa3b, v119
  v_mul_f32 v152, v120, v152
  v_mul_f32 v153, v121, v153
  v_mul_f32 v154, v122, v154
  v_mul_f32 v155, v123, v155
  v_mul_f32 v156, v124, v156
  v_mul_f32 v157, v125, v157
  v_mul_f32 v158, v126, v158
  v_mul_f32 v159, v127, v159
  v_rcp_f32 v96, v96
  v_rcp_f32 v97, v97
  v_rcp_f32 v98, v98
  s_sub_u32 s12, s12, s57
  buffer_load_dwordx4 v219, s[80:83], s12 offen offset:2048 sc1 lds
  v_rcp_f32 v99, v99
  v_rcp_f32 v100, v100
  v_rcp_f32 v101, v101
  v_rcp_f32 v102, v102
  v_rcp_f32 v103, v103
  v_add_f32 v104, 1.0, v104
  v_add_f32 v105, 1.0, v105
  v_add_f32 v106, 1.0, v106
  v_add_f32 v107, 1.0, v107
  v_add_f32 v108, 1.0, v108
  s_sub_u32 s12, s12, s57
  buffer_load_dwordx4 v219, s[80:83], s12 offen offset:3072 sc1 lds
  v_add_f32 v109, 1.0, v109
  v_add_f32 v110, 1.0, v110
  v_add_f32 v111, 1.0, v111
  v_exp_f32 v112, v112
  v_exp_f32 v113, v113
  v_exp_f32 v114, v114
  v_exp_f32 v115, v115
  v_exp_f32 v116, v116
  v_exp_f32 v117, v117
  buffer_load_dwordx4 a[120:123], v211, s[52:55], s1 offen sc1
  v_exp_f32 v118, v118
  v_exp_f32 v119, v119
  v_mul_f32 v120, 0xbfb8aa3b, v120
  v_mul_f32 v121, 0xbfb8aa3b, v121
  v_mul_f32 v122, 0xbfb8aa3b, v122
  v_mul_f32 v123, 0xbfb8aa3b, v123
  v_mul_f32 v124, 0xbfb8aa3b, v124
  v_mul_f32 v125, 0xbfb8aa3b, v125
  v_mul_f32 v126, 0xbfb8aa3b, v126
  v_mul_f32 v127, 0xbfb8aa3b, v127
  v_mul_f32 v128, v128, v96
  v_mul_f32 v129, v129, v97
  v_mul_f32 v130, v130, v98
  v_mul_f32 v131, v131, v99
  s_add_u32 m0, s59, 139264
  s_mov_b32 s12, 0
  buffer_load_dwordx4 v220, s[84:87], s12 offen offset:0 sc1 lds
  v_mul_f32 v132, v132, v100
  v_mul_f32 v133, v133, v101
  v_mul_f32 v134, v134, v102
  v_mul_f32 v135, v135, v103
  v_rcp_f32 v104, v104
  v_rcp_f32 v105, v105
  v_rcp_f32 v106, v106
  v_rcp_f32 v107, v107
  v_rcp_f32 v108, v108
  s_mov_b32 s12, 1024
  buffer_load_dwordx4 v220, s[84:87], s12 offen offset:1024 sc1 lds
  v_rcp_f32 v109, v109
  v_rcp_f32 v110, v110
  v_rcp_f32 v111, v111
  v_add_f32 v112, 1.0, v112
  v_add_f32 v113, 1.0, v113
  v_add_f32 v114, 1.0, v114
  v_add_f32 v115, 1.0, v115
  v_add_f32 v116, 1.0, v116
  v_add_f32 v117, 1.0, v117
  v_add_f32 v118, 1.0, v118
  v_add_f32 v119, 1.0, v119
  v_exp_f32 v120, v120
  s_mov_b32 s12, 2048
  buffer_load_dwordx4 v220, s[84:87], s12 offen offset:2048 sc1 lds
  v_exp_f32 v121, v121
  v_exp_f32 v122, v122
  v_exp_f32 v123, v123
  v_exp_f32 v124, v124
  v_exp_f32 v125, v125
  v_exp_f32 v126, v126
  v_exp_f32 v127, v127
  v_cvt_pk_bf16_f32 v96, v128, v129
  s_mov_b32 s12, 3072
  buffer_load_dwordx4 v220, s[84:87], s12 offen offset:3072 sc1 lds
  v_cvt_pk_bf16_f32 v97, v130, v131
  v_cvt_pk_bf16_f32 v98, v132, v133
  v_cvt_pk_bf16_f32 v99, v134, v135
  v_mul_f32 v136, v136, v104
  v_mul_f32 v137, v137, v105
  v_mul_f32 v138, v138, v106
  v_mul_f32 v139, v139, v107
  v_mul_f32 v140, v140, v108
  v_mul_f32 v141, v141, v109
  v_mul_f32 v142, v142, v110
  v_mul_f32 v143, v143, v111
  v_rcp_f32 v112, v112
  v_rcp_f32 v113, v113
  buffer_load_dwordx4 a[124:127], v211, s[52:55], s1 offen offset:1024 sc1
  v_rcp_f32 v114, v114
  v_rcp_f32 v115, v115
  v_rcp_f32 v116, v116
  v_rcp_f32 v117, v117
  v_rcp_f32 v118, v118
  v_rcp_f32 v119, v119
  v_add_f32 v120, 1.0, v120
  v_add_f32 v121, 1.0, v121
  v_add_f32 v122, 1.0, v122
  v_add_f32 v123, 1.0, v123
  buffer_load_dword v254, v223, s[52:55], s13 offen offset:0 sc1
  v_add_f32 v124, 1.0, v124
  v_add_f32 v125, 1.0, v125
  v_add_f32 v126, 1.0, v126
  v_add_f32 v127, 1.0, v127
  v_cvt_pk_bf16_f32 v104, v136, v137
  v_cvt_pk_bf16_f32 v105, v138, v139
  v_cvt_pk_bf16_f32 v106, v140, v141
  v_cvt_pk_bf16_f32 v107, v142, v143
  v_mul_f32 v144, v144, v112
  v_mul_f32 v145, v145, v113
  v_mul_f32 v146, v146, v114
  v_mul_f32 v147, v147, v115
  v_mul_f32 v148, v148, v116
  v_mul_f32 v149, v149, v117
  v_mul_f32 v150, v150, v118
  v_mul_f32 v151, v151, v119
  buffer_load_dword v255, v223, s[52:55], s13 offen offset:128 sc1
  v_rcp_f32 v120, v120
  v_rcp_f32 v121, v121
  v_rcp_f32 v122, v122
  v_rcp_f32 v123, v123
  v_rcp_f32 v124, v124
  v_rcp_f32 v125, v125
  v_rcp_f32 v126, v126
  v_rcp_f32 v127, v127
  v_cvt_pk_bf16_f32 v112, v144, v145
  s_add_u32 m0, s59, 57344
  v_cvt_pk_bf16_f32 v113, v146, v147
  v_cvt_pk_bf16_f32 v114, v148, v149
  v_cvt_pk_bf16_f32 v115, v150, v151
  v_mul_f32 v152, v152, v120
  v_mul_f32 v153, v153, v121
  v_mul_f32 v154, v154, v122
  v_mul_f32 v155, v155, v123
  v_mul_f32 v156, v156, v124
  buffer_load_dwordx4 v232, s[88:91], s16 offen offset:0  lds
  v_mul_f32 v157, v157, v125
  v_mul_f32 v158, v158, v126
  v_mul_f32 v159, v159, v127
  v_cvt_pk_bf16_f32 v120, v152, v153
  v_cvt_pk_bf16_f32 v121, v154, v155
  v_cvt_pk_bf16_f32 v122, v156, v157
  v_cvt_pk_bf16_f32 v123, v158, v159
  v_cndmask_b32 v37, 0, v33, s[42:43]
  v_or_b32 v224, v224, v34
  v_or_b32 v225, v225, v35
  v_or_b32 v226, v226, v36
  v_or_b32 v227, v227, v37
  s_mov_b32 s44, 0xffff0000
  s_mov_b32 s45, 0xfff00000
  s_mov_b32 s46, 0xfffe0000
  s_mov_b32 s47, 0xffe00000
  s_mov_b32 s48, 0xfffc0000
  buffer_load_dwordx4 v233, s[88:91], s16 offen offset:1024  lds
  s_mov_b32 s49, 0xffc00000
  s_mov_b32 s50, 0xfff80000
  s_mov_b32 s51, 0xff800000
  s_mov_b32 s72, 0xff000000
  s_mov_b32 s73, 0xf0000000
  s_mov_b32 s74, 0xfe000000
  s_mov_b32 s75, 0xe0000000
  s_mov_b32 s76, 0xfc000000
  s_mov_b32 s77, 0xc0000000
  s_mov_b32 s78, 0xf8000000
  s_mov_b32 s79, 0x80000000
  v_cndmask_b32 v228, 0, v32, s[44:45]
  v_cndmask_b32 v38, 0, v33, s[46:47]
  v_cndmask_b32 v229, 0, v32, s[48:49]
  v_cndmask_b32 v39, 0, v33, s[50:51]
  v_cndmask_b32 v230, 0, v32, s[72:73]
  v_cndmask_b32 v40, 0, v33, s[74:75]
  v_cndmask_b32 v231, 0, v32, s[76:77]
  v_cndmask_b32 v41, 0, v33, s[78:79]
  v_or_b32 v228, v228, v38
  v_or_b32 v229, v229, v39
  v_or_b32 v230, v230, v40
  v_or_b32 v231, v231, v41
  s_add_u32 s65, s0, 147456
  buffer_load_dwordx4 v234, s[88:91], s16 offen offset:2048  lds
  v_add_u32 v192, 65536, v236
  v_add_u32 v193, 65536, v237
  v_add_u32 v194, 65536, v208
  v_add_u32 v195, 65536, v209
  v_add_u32 v196, 131072, v236
  v_add_u32 v197, 131072, v237
  v_add_u32 v198, 131072, v208
  v_add_u32 v199, 131072, v209
  s_add_u32 s64, s0, 0
  v_and_b32 v253, 63, v223
  v_lshlrev_b32 v239, 1, v218
  buffer_load_dwordx4 v235, s[88:91], s16 offen offset:3072  lds
  s_add_u32 s16, s15, 196608
  s_add_u32 m0, s59, 81920
  s_nop 0
  buffer_load_dwordx4 v232, s[88:91], s16 offen offset:0  lds
  s_waitcnt vmcnt(13)
  s_barrier
  ds_read_b128 a[28:31], v238 offset:7168
  ds_read_b128 a[0:3], v238 offset:0
  ds_read_b128 a[32:35], v238 offset:8192
  buffer_load_dwordx4 v233, s[88:91], s16 offen offset:1024  lds
  ds_read_b128 a[4:7], v238 offset:1024
  ds_read_b128 a[8:11], v238 offset:2048
  ds_read_b128 a[12:15], v238 offset:3072
  ds_read_b128 a[16:19], v238 offset:4096
  ds_read_b128 a[20:23], v238 offset:5120
  buffer_load_dwordx4 v234, s[88:91], s16 offen offset:2048  lds
  ds_read_b128 a[24:27], v238 offset:6144
  s_mov_b32 s100, 15859712
  buffer_load_dwordx2 v[250:251], v249, s[52:55], s100 offen sc1
  s_waitcnt vmcnt(15) lgkmcnt(7)
  v_mfma_f32_32x32x16_bf16 v[0:15], a[0:3], a[120:123], 0
  s_waitcnt lgkmcnt(6)
  v_mfma_f32_32x32x16_bf16 v[16:31], a[32:35], a[120:123], 0
  buffer_load_dwordx4 v235, s[88:91], s16 offen offset:3072  lds
  s_add_u32 s16, s27, 0
  s_waitcnt lgkmcnt(4)
  v_mfma_f32_32x32x16_bf16 v[32:47], a[4:7], a[120:123], 0
  s_nop 7
  v_cndmask_b32 v48, v0, v16, s[28:29]
  v_exp_f32 v48, v48
  v_cndmask_b32 v49, v1, v17, s[30:31]
  v_exp_f32 v49, v49
  v_cndmask_b32 v50, v2, v18, s[32:33]
  v_exp_f32 v50, v50
  v_cvt_pk_bf16_f32 v48, v48, v49
  v_and_b32 v176, v224, v48
  v_cndmask_b32 v51, v3, v19, s[34:35]
  v_cndmask_b32 v52, v4, v20, s[36:37]
  v_cndmask_b32 v53, v5, v21, s[38:39]
  v_cndmask_b32 v54, v6, v22, s[40:41]
  v_cndmask_b32 v55, v7, v23, s[42:43]
  v_exp_f32 v51, v51
  v_exp_f32 v52, v52
  v_exp_f32 v53, v53
  v_exp_f32 v54, v54
  v_exp_f32 v55, v55
  v_cvt_pk_bf16_f32 v49, v50, v51
  v_cvt_pk_bf16_f32 v50, v52, v53
  v_cvt_pk_bf16_f32 v51, v54, v55
  v_and_b32 v177, v225, v49
  v_and_b32 v178, v226, v50
  v_and_b32 v179, v227, v51
  v_bfi_b32 v48, v224, 0, v48
  v_bfi_b32 v49, v225, 0, v49
  v_bfi_b32 v50, v226, 0, v50
  v_bfi_b32 v51, v227, 0, v51
  v_cndmask_b32 v56, v8, v24, s[44:45]
  v_cndmask_b32 v57, v9, v25, s[46:47]
  v_cndmask_b32 v58, v10, v26, s[48:49]
  v_cndmask_b32 v59, v11, v27, s[50:51]
  v_cndmask_b32 v60, v12, v28, s[72:73]
  v_cndmask_b32 v61, v13, v29, s[74:75]
  v_cndmask_b32 v62, v14, v30, s[76:77]
  v_cndmask_b32 v63, v15, v31, s[78:79]
  v_mfma_f32_32x32x16_bf16 v[0:15], a[8:11], a[120:123], 0
  s_waitcnt vmcnt(12)
  s_barrier
  buffer_store_dwordx4 v[96:99], v211, s[52:55], s62 offen offset:0 sc1
  ds_read_b128 a[40:43], v222 offset:16384
  ds_read_b128 a[44:47], v222 offset:16640
  ds_read_b128 a[104:107], v222 offset:24576
  s_waitcnt lgkmcnt(3)
  v_mfma_f32_32x32x16_bf16 v[16:31], a[12:15], a[120:123], 0
  ds_read_b128 a[108:111], v222 offset:24832
  v_exp_f32 v56, v56
  v_exp_f32 v57, v57
  v_exp_f32 v58, v58
  v_exp_f32 v59, v59
  v_exp_f32 v60, v60
  ds_read_b128 a[48:51], v222 offset:17408
  buffer_store_dwordx4 v[104:107], v211, s[52:55], s62 offen offset:1024 sc1
  ds_read_b128 a[52:55], v222 offset:17664
  ds_read_b128 a[56:59], v222 offset:18432
  v_exp_f32 v61, v61
  v_exp_f32 v62, v62
  v_exp_f32 v63, v63
  v_cvt_pk_bf16_f32 v52, v56, v57
  s_waitcnt lgkmcnt(6)
  v_mfma_f32_32x32x16_bf16 v[80:95], a[40:43], v[48:51], 0
  ds_read_b128 a[60:63], v222 offset:18688
  ds_read_b128 a[64:67], v222 offset:19456
  ds_read_b128 a[68:71], v222 offset:19712
  v_cvt_pk_bf16_f32 v53, v58, v59
  v_cvt_pk_bf16_f32 v54, v60, v61
  v_cvt_pk_bf16_f32 v55, v62, v63
  v_and_b32 v180, v228, v52
  v_and_b32 v181, v229, v53
  v_and_b32 v182, v230, v54
  v_and_b32 v183, v231, v55
  buffer_store_dwordx4 v[112:115], v211, s[52:55], s63 offen offset:0 sc1
  ds_read_b128 a[72:75], v222 offset:20480
  ds_read_b128 a[76:79], v222 offset:20736
  ds_read_b128 a[80:83], v222 offset:21504
  v_bfi_b32 v52, v228, 0, v52
  v_bfi_b32 v53, v229, 0, v53
  v_bfi_b32 v54, v230, 0, v54
  v_bfi_b32 v55, v231, 0, v55
  v_exp_f32 v32, v32
  v_exp_f32 v33, v33
  s_waitcnt lgkmcnt(8)
  v_mfma_f32_32x32x16_bf16 v[80:95], a[44:47], v[52:55], v[80:95]
  ds_read_b128 a[84:87], v222 offset:21760
  ds_read_b128 a[88:91], v222 offset:22528
  buffer_store_dwordx4 v[120:123], v211, s[52:55], s63 offen offset:1024 sc1
  ds_read_b128 a[92:95], v222 offset:22784
  v_exp_f32 v34, v34
  v_mfma_f32_32x32x16_bf16 v[80:95], a[104:107], v[176:179], v[80:95]
  ds_read_b128 a[96:99], v222 offset:23552
  v_exp_f32 v35, v35
  v_exp_f32 v36, v36
  v_exp_f32 v37, v37
  v_mfma_f32_32x32x16_bf16 v[80:95], a[108:111], v[180:183], v[80:95]
  ds_read_b128 a[100:103], v222 offset:23808
  ds_read_b128 a[112:115], v222 offset:25600
  ds_read_b128 a[116:119], v222 offset:25856
  v_exp_f32 v38, v38
  v_exp_f32 v39, v39
  v_cvt_pk_bf16_f32 v32, v32, v33
  v_cvt_pk_bf16_f32 v33, v34, v35
  v_cvt_pk_bf16_f32 v34, v36, v37
  v_cvt_pk_bf16_f32 v35, v38, v39
  v_exp_f32 v40, v40
  ds_read_b128 a[36:39], v238 offset:9216
  v_mfma_f32_32x32x16_bf16 v[80:95], a[48:51], v[32:35], v[80:95]
  v_exp_f32 v41, v41
  v_exp_f32 v42, v42
  v_exp_f32 v43, v43
  v_exp_f32 v44, v44
  s_waitcnt vmcnt(5)
  v_cmp_ne_u64 vcc, v[250:251], v[216:217]
  s_nop 0
  s_cbranch_vccnz L_slow_v
L_back_v:
  buffer_load_dwordx4 a[128:131], v211, s[52:55], s17 offen offset:0 sc1
  v_exp_f32 v45, v45
  v_exp_f32 v46, v46
  v_exp_f32 v47, v47
  v_cvt_pk_bf16_f32 v36, v40, v41
  v_cvt_pk_bf16_f32 v37, v42, v43
  v_cvt_pk_bf16_f32 v38, v44, v45
  v_cvt_pk_bf16_f32 v39, v46, v47
  v_exp_f32 v0, v0
  v_exp_f32 v1, v1
  s_waitcnt lgkmcnt(1)
  v_mfma_f32_32x32x16_bf16 v[80:95], a[52:55], v[36:39], v[80:95]
  buffer_load_dwordx4 a[132:135], v211, s[52:55], s17 offen offset:1024 sc1
  s_waitcnt lgkmcnt(0)
  s_barrier
  v_exp_f32 v2, v2
  v_exp_f32 v3, v3
  v_mfma_f32_32x32x16_bf16 v[32:47], a[16:19], a[120:123], 0
  v_exp_f32 v4, v4
  v_exp_f32 v5, v5
  v_exp_f32 v6, v6
  v_exp_f32 v7, v7
  v_cvt_pk_bf16_f32 v0, v0, v1
  v_cvt_pk_bf16_f32 v1, v2, v3
  v_cvt_pk_bf16_f32 v2, v4, v5
  v_cvt_pk_bf16_f32 v3, v6, v7
  v_exp_f32 v8, v8
  v_exp_f32 v9, v9
  v_mfma_f32_32x32x16_bf16 v[80:95], a[56:59], v[0:3], v[80:95]
  buffer_load_dwordx4 a[136:139], v211, s[52:55], s17 offen offset:2048 sc1
  v_exp_f32 v10, v10
  v_exp_f32 v11, v11
  v_exp_f32 v12, v12
  v_exp_f32 v13, v13
  v_exp_f32 v14, v14
  v_exp_f32 v15, v15
  v_cvt_pk_bf16_f32 v4, v8, v9
  v_cvt_pk_bf16_f32 v5, v10, v11
  v_cvt_pk_bf16_f32 v6, v12, v13
  v_cvt_pk_bf16_f32 v7, v14, v15
  v_exp_f32 v16, v16
  v_exp_f32 v17, v17
  v_mfma_f32_32x32x16_bf16 v[80:95], a[60:63], v[4:7], v[80:95]
  buffer_load_dwordx4 a[140:143], v211, s[52:55], s17 offen offset:3072 sc1
  s_add_u32 s17, s18, 4096
  v_exp_f32 v18, v18
  v_exp_f32 v19, v19
  v_mfma_f32_32x32x16_bf16 v[0:15], a[20:23], a[120:123], 0
  v_exp_f32 v20, v20
  v_exp_f32 v21, v21
  v_exp_f32 v22, v22
  v_exp_f32 v23, v23
  v_cvt_pk_bf16_f32 v16, v16, v17
  v_cvt_pk_bf16_f32 v17, v18, v19
  v_cvt_pk_bf16_f32 v18, v20, v21
  v_cvt_pk_bf16_f32 v19, v22, v23
  v_exp_f32 v24, v24
  v_exp_f32 v25, v25
  v_mfma_f32_32x32x16_bf16 v[80:95], a[64:67], v[16:19], v[80:95]
  buffer_load_dwordx4 a[144:147], v211, s[52:55], s17 offen offset:0 sc1
  v_exp_f32 v26, v26
  v_exp_f32 v27, v27
  v_exp_f32 v28, v28
  v_exp_f32 v29, v29
  v_exp_f32 v30, v30
  v_exp_f32 v31, v31
  v_cvt_pk_bf16_f32 v20, v24, v25
  v_cvt_pk_bf16_f32 v21, v26, v27
  v_cvt_pk_bf16_f32 v22, v28, v29
  v_cvt_pk_bf16_f32 v23, v30, v31
  v_exp_f32 v32, v32
  v_exp_f32 v33, v33
  v_mfma_f32_32x32x16_bf16 v[80:95], a[68:71], v[20:23], v[80:95]
  buffer_load_dwordx4 a[148:151], v211, s[52:55], s17 offen offset:1024 sc1
  v_exp_f32 v34, v34
  v_exp_f32 v35, v35
  v_exp_f32 v36, v36
  v_mfma_f32_32x32x16_bf16 v[16:31], a[24:27], a[120:123], 0
  v_exp_f32 v37, v37
  v_exp_f32 v38, v38
  v_exp_f32 v39, v39
  v_cvt_pk_bf16_f32 v32, v32, v33
  v_cvt_pk_bf16_f32 v33, v34, v35
  v_cvt_pk_bf16_f32 v34, v36, v37
  v_cvt_pk_bf16_f32 v35, v38, v39
  v_exp_f32 v40, v40
  v_exp_f32 v41, v41
  v_mfma_f32_32x32x16_bf16 v[80:95], a[72:75], v[32:35], v[80:95]
  buffer_load_dwordx4 a[152:155], v211, s[52:55], s17 offen offset:2048 sc1
  v_exp_f32 v42, v42
  v_exp_f32 v43, v43
  v_exp_f32 v44, v44
L_pg4:
  s_cbranch_execz L_pg8
  v_exp_f32 v45, v45
  v_exp_f32 v46, v46
  v_exp_f32 v47, v47
  v_cvt_pk_bf16_f32 v36, v40, v41
  v_cvt_pk_bf16_f32 v37, v42, v43
  v_cvt_pk_bf16_f32 v38, v44, v45
  v_cvt_pk_bf16_f32 v39, v46, v47
  v_exp_f32 v0, v0
  v_exp_f32 v1, v1
  v_mfma_f32_32x32x16_bf16 v[80:95], a[76:79], v[36:39], v[80:95]
  s_waitcnt vmcnt(7)
  buffer_store_dwordx2 v[216:217], v252, s[52:55], s60 offen sc1
  buffer_load_dwordx4 a[156:159], v211, s[52:55], s17 offen offset:3072 sc1
  s_add_u32 s17, s18, 8192
  v_exp_f32 v2, v2
  v_mfma_f32_32x32x16_bf16 v[32:47], a[28:31], a[120:123], 0
  v_exp_f32 v3, v3
  v_exp_f32 v4, v4
  v_exp_f32 v5, v5
  v_exp_f32 v6, v6
  v_exp_f32 v7, v7
  v_cvt_pk_bf16_f32 v0, v0, v1
  v_cvt_pk_bf16_f32 v1, v2, v3
  v_cvt_pk_bf16_f32 v2, v4, v5
  v_cvt_pk_bf16_f32 v3, v6, v7
  v_exp_f32 v8, v8
  v_exp_f32 v9, v9
  v_mfma_f32_32x32x16_bf16 v[80:95], a[80:83], v[0:3], v[80:95]
  buffer_load_dwordx4 a[160:163], v211, s[52:55], s17 offen offset:0 sc1
  v_exp_f32 v10, v10
  v_exp_f32 v11, v11
  v_exp_f32 v12, v12
  v_exp_f32 v13, v13
  v_exp_f32 v14, v14
  v_exp_f32 v15, v15
  v_cvt_pk_bf16_f32 v4, v8, v9
  v_cvt_pk_bf16_f32 v5, v10, v11
  v_cvt_pk_bf16_f32 v6, v12, v13
  v_cvt_pk_bf16_f32 v7, v14, v15
  v_exp_f32 v16, v16
  v_exp_f32 v17, v17
  v_mfma_f32_32x32x16_bf16 v[80:95], a[84:87], v[4:7], v[80:95]
  buffer_load_dwordx4 a[164:167], v211, s[52:55], s17 offen offset:1024 sc1
  v_exp_f32 v18, v18
  v_exp_f32 v19, v19
  v_exp_f32 v20, v20
  v_mfma_f32_32x32x16_bf16 v[0:15], a[4:7], a[124:127], 0
  v_exp_f32 v21, v21
  v_exp_f32 v22, v22
  v_exp_f32 v23, v23
  v_cvt_pk_bf16_f32 v16, v16, v17
  v_cvt_pk_bf16_f32 v17, v18, v19
  v_cvt_pk_bf16_f32 v18, v20, v21
  v_cvt_pk_bf16_f32 v19, v22, v23
  v_exp_f32 v24, v24
  v_exp_f32 v25, v25
  v_mfma_f32_32x32x16_bf16 v[80:95], a[88:91], v[16:19], v[80:95]
  buffer_load_dwordx4 a[168:171], v211, s[52:55], s17 offen offset:2048 sc1
  v_exp_f32 v26, v26
  v_exp_f32 v27, v27
  v_exp_f32 v28, v28
  v_exp_f32 v29, v29
  v_exp_f32 v30, v30
  v_exp_f32 v31, v31
  v_cvt_pk_bf16_f32 v20, v24, v25
  v_cvt_pk_bf16_f32 v21, v26, v27
  v_cvt_pk_bf16_f32 v22, v28, v29
  v_cvt_pk_bf16_f32 v23, v30, v31
  v_exp_f32 v32, v32
  v_exp_f32 v33, v33
  v_mfma_f32_32x32x16_bf16 v[80:95], a[92:95], v[20:23], v[80:95]
  buffer_load_dwordx4 a[172:175], v211, s[52:55], s17 offen offset:3072 sc1
  s_add_u32 s17, s18, 0
  s_add_u32 s17, s17, s21
  v_exp_f32 v34, v34
  v_exp_f32 v35, v35
  v_mfma_f32_32x32x16_bf16 v[16:31], a[36:39], a[124:127], 0
  v_exp_f32 v36, v36
  v_exp_f32 v37, v37
  v_exp_f32 v38, v38
  v_exp_f32 v39, v39
  v_cvt_pk_bf16_f32 v32, v32, v33
  s_add_u32 m0, s59, 98304
  v_cvt_pk_bf16_f32 v33, v34, v35
  v_cvt_pk_bf16_f32 v34, v36, v37
  v_cvt_pk_bf16_f32 v35, v38, v39
  v_exp_f32 v40, v40
  v_exp_f32 v41, v41
  v_mfma_f32_32x32x16_bf16 v[80:95], a[96:99], v[32:35], v[80:95]
  buffer_load_dwordx4 v232, s[92:95], s16 offen offset:0  lds
  v_cndmask_b32 v64, v0, v16, s[28:29]
  v_cndmask_b32 v65, v1, v17, s[30:31]
  v_cndmask_b32 v66, v2, v18, s[32:33]
  v_cndmask_b32 v67, v3, v19, s[34:35]
  v_exp_f32 v64, v64
  v_exp_f32 v65, v65
  v_cndmask_b32 v68, v4, v20, s[36:37]
  v_cndmask_b32 v69, v5, v21, s[38:39]
  v_cndmask_b32 v70, v6, v22, s[40:41]
  v_cndmask_b32 v71, v7, v23, s[42:43]
  v_exp_f32 v66, v66
  v_exp_f32 v67, v67
  v_exp_f32 v68, v68
  v_exp_f32 v69, v69
  v_exp_f32 v70, v70
  v_exp_f32 v71, v71
  buffer_load_dwordx4 v233, s[92:95], s16 offen offset:1024  lds
  v_cvt_pk_bf16_f32 v64, v64, v65
  v_cvt_pk_bf16_f32 v65, v66, v67
  v_cvt_pk_bf16_f32 v66, v68, v69
  v_cvt_pk_bf16_f32 v67, v70, v71
  v_and_b32 v176, v224, v64
  v_and_b32 v177, v225, v65
  v_and_b32 v178, v226, v66
  v_and_b32 v179, v227, v67
  v_bfi_b32 v64, v224, 0, v64
  v_bfi_b32 v65, v225, 0, v65
  v_bfi_b32 v66, v226, 0, v66
  v_bfi_b32 v67, v227, 0, v67
  v_cndmask_b32 v72, v8, v24, s[44:45]
  v_cndmask_b32 v73, v9, v25, s[46:47]
  v_mfma_f32_32x32x16_bf16 v[160:175], a[48:51], v[64:67], 0
  v_cndmask_b32 v74, v10, v26, s[48:49]
  v_cndmask_b32 v75, v11, v27, s[50:51]
  v_cndmask_b32 v76, v12, v28, s[72:73]
  v_cndmask_b32 v77, v13, v29, s[74:75]
  v_cndmask_b32 v78, v14, v30, s[76:77]
  v_cndmask_b32 v79, v15, v31, s[78:79]
  v_mfma_f32_32x32x16_bf16 v[0:15], a[12:15], a[124:127], 0
  buffer_load_dwordx4 v234, s[92:95], s16 offen offset:2048  lds
  v_exp_f32 v72, v72
  v_exp_f32 v73, v73
  v_exp_f32 v74, v74
  v_mfma_f32_32x32x16_bf16 v[16:31], a[16:19], a[124:127], 0
  v_exp_f32 v75, v75
  v_exp_f32 v76, v76
  v_exp_f32 v77, v77
  v_exp_f32 v78, v78
  v_exp_f32 v79, v79
  v_exp_f32 v42, v42
  v_exp_f32 v43, v43
  v_exp_f32 v44, v44
  buffer_load_dwordx4 v235, s[92:95], s16 offen offset:3072  lds
  s_add_u32 s16, s27, 65536
  v_exp_f32 v45, v45
  v_exp_f32 v46, v46
  v_exp_f32 v47, v47
  v_cvt_pk_bf16_f32 v68, v72, v73
  v_cvt_pk_bf16_f32 v69, v74, v75
  v_cvt_pk_bf16_f32 v70, v76, v77
  v_cvt_pk_bf16_f32 v71, v78, v79
  v_cvt_pk_bf16_f32 v36, v40, v41
  v_cvt_pk_bf16_f32 v37, v42, v43
  v_cvt_pk_bf16_f32 v38, v44, v45
  v_cvt_pk_bf16_f32 v39, v46, v47
  v_and_b32 v180, v228, v68
  v_and_b32 v181, v229, v69
  v_mfma_f32_32x32x16_bf16 v[80:95], a[100:103], v[36:39], v[80:95]
  buffer_load_dwordx4 a[176:179], v211, s[52:55], s17 offen offset:0 sc1
  v_and_b32 v182, v230, v70
  v_and_b32 v183, v231, v71
  v_bfi_b32 v68, v228, 0, v68
  v_bfi_b32 v69, v229, 0, v69
  v_bfi_b32 v70, v230, 0, v70
  v_mfma_f32_32x32x16_bf16 v[32:47], a[8:11], a[124:127], 0
  v_bfi_b32 v71, v231, 0, v71
  v_exp_f32 v0, v0
  v_exp_f32 v1, v1
  v_exp_f32 v2, v2
  v_mfma_f32_32x32x16_bf16 v[160:175], a[52:55], v[68:71], v[160:175]
  v_exp_f32 v3, v3
  v_exp_f32 v4, v4
  v_exp_f32 v5, v5
  v_mfma_f32_32x32x16_bf16 v[160:175], a[112:115], v[176:179], v[160:175]
  buffer_load_dwordx4 a[180:183], v211, s[52:55], s17 offen offset:1024 sc1
  v_exp_f32 v6, v6
  v_exp_f32 v7, v7
  v_exp_f32 v32, v32
  v_mfma_f32_32x32x16_bf16 v[160:175], a[116:119], v[180:183], v[160:175]
  v_exp_f32 v33, v33
  v_exp_f32 v34, v34
  v_exp_f32 v35, v35
  v_exp_f32 v36, v36
  v_exp_f32 v37, v37
  v_exp_f32 v38, v38
  v_exp_f32 v39, v39
  v_cvt_pk_bf16_f32 v32, v32, v33
  v_cvt_pk_bf16_f32 v33, v34, v35
  buffer_load_dwordx4 a[184:187], v211, s[52:55], s17 offen offset:2048 sc1
  v_cvt_pk_bf16_f32 v34, v36, v37
  v_cvt_pk_bf16_f32 v35, v38, v39
  v_exp_f32 v40, v40
  v_exp_f32 v41, v41
  v_mfma_f32_32x32x16_bf16 v[160:175], a[56:59], v[32:35], v[160:175]
  v_exp_f32 v42, v42
  v_exp_f32 v43, v43
  v_exp_f32 v44, v44
  v_exp_f32 v45, v45
  v_exp_f32 v46, v46
  v_exp_f32 v47, v47
  v_cvt_pk_bf16_f32 v36, v40, v41
  v_cvt_pk_bf16_f32 v37, v42, v43
  v_cvt_pk_bf16_f32 v38, v44, v45
  v_cvt_pk_bf16_f32 v39, v46, v47
  buffer_load_dwordx4 a[188:191], v211, s[52:55], s17 offen offset:3072 sc1
  s_add_u32 s17, s18, 4096
  v_mfma_f32_32x32x16_bf16 v[160:175], a[60:63], v[36:39], v[160:175]
  s_add_u32 s17, s17, s21
  v_cvt_pk_bf16_f32 v0, v0, v1
  v_cvt_pk_bf16_f32 v1, v2, v3
  v_cvt_pk_bf16_f32 v2, v4, v5
  v_cvt_pk_bf16_f32 v3, v6, v7
  v_exp_f32 v8, v8
  v_mfma_f32_32x32x16_bf16 v[32:47], a[20:23], a[124:127], 0
  v_exp_f32 v9, v9
  v_exp_f32 v10, v10
  v_exp_f32 v11, v11
  v_mfma_f32_32x32x16_bf16 v[160:175], a[64:67], v[0:3], v[160:175]
  buffer_load_dwordx4 a[192:195], v211, s[52:55], s17 offen offset:0 sc1
  v_exp_f32 v12, v12
  v_exp_f32 v13, v13
  v_exp_f32 v14, v14
  v_exp_f32 v15, v15
  v_cvt_pk_bf16_f32 v4, v8, v9
  v_cvt_pk_bf16_f32 v5, v10, v11
  v_cvt_pk_bf16_f32 v6, v12, v13
  v_cvt_pk_bf16_f32 v7, v14, v15
  v_exp_f32 v16, v16
  v_exp_f32 v17, v17
  v_mfma_f32_32x32x16_bf16 v[160:175], a[68:71], v[4:7], v[160:175]
  buffer_load_dwordx4 a[196:199], v211, s[52:55], s17 offen offset:1024 sc1
  v_exp_f32 v18, v18
  v_exp_f32 v19, v19
  v_exp_f32 v20, v20
  v_mfma_f32_32x32x16_bf16 v[0:15], a[24:27], a[124:127], 0
  v_exp_f32 v21, v21
  v_exp_f32 v22, v22
  v_exp_f32 v23, v23
  v_cvt_pk_bf16_f32 v16, v16, v17
  v_cvt_pk_bf16_f32 v17, v18, v19
  v_cvt_pk_bf16_f32 v18, v20, v21
  v_cvt_pk_bf16_f32 v19, v22, v23
  v_exp_f32 v24, v24
  v_exp_f32 v25, v25
  v_mfma_f32_32x32x16_bf16 v[160:175], a[72:75], v[16:19], v[160:175]
  buffer_load_dwordx4 a[200:203], v211, s[52:55], s17 offen offset:2048 sc1
  v_exp_f32 v26, v26
  v_exp_f32 v27, v27
  v_exp_f32 v28, v28
  v_exp_f32 v29, v29
  v_exp_f32 v30, v30
  v_exp_f32 v31, v31
  v_cvt_pk_bf16_f32 v20, v24, v25
  v_cvt_pk_bf16_f32 v21, v26, v27
  v_cvt_pk_bf16_f32 v22, v28, v29
  v_cvt_pk_bf16_f32 v23, v30, v31
  v_exp_f32 v32, v32
  v_exp_f32 v33, v33
  v_mfma_f32_32x32x16_bf16 v[160:175], a[76:79], v[20:23], v[160:175]
  s_mov_b32 s100, 15892480
  buffer_load_dwordx2 v[250:251], v247, s[52:55], s100 offen sc1
  buffer_load_dwordx4 a[204:207], v211, s[52:55], s17 offen offset:3072 sc1
  s_add_u32 s17, s18, 8192
  s_add_u32 s17, s17, s21
  v_exp_f32 v34, v34
  v_mfma_f32_32x32x16_bf16 v[16:31], a[28:31], a[124:127], 0
  v_exp_f32 v35, v35
  v_exp_f32 v36, v36
  v_exp_f32 v37, v37
  v_exp_f32 v38, v38
  v_exp_f32 v39, v39
  v_cvt_pk_bf16_f32 v32, v32, v33
  v_cvt_pk_bf16_f32 v33, v34, v35
  v_cvt_pk_bf16_f32 v34, v36, v37
  v_cvt_pk_bf16_f32 v35, v38, v39
  v_exp_f32 v40, v40
  v_exp_f32 v41, v41
  v_mfma_f32_32x32x16_bf16 v[160:175], a[80:83], v[32:35], v[160:175]
  buffer_load_dwordx4 a[208:211], v211, s[52:55], s17 offen offset:0 sc1
  v_exp_f32 v42, v42
  v_exp_f32 v43, v43
  v_exp_f32 v44, v44
  v_exp_f32 v45, v45
  v_exp_f32 v46, v46
  v_exp_f32 v47, v47
  v_cvt_pk_bf16_f32 v36, v40, v41
  v_cvt_pk_bf16_f32 v37, v42, v43
  v_cvt_pk_bf16_f32 v38, v44, v45
  v_cvt_pk_bf16_f32 v39, v46, v47
  v_exp_f32 v0, v0
  v_exp_f32 v1, v1
  v_mfma_f32_32x32x16_bf16 v[160:175], a[84:87], v[36:39], v[160:175]
  buffer_load_dwordx4 a[212:215], v211, s[52:55], s17 offen offset:1024 sc1
  v_exp_f32 v2, v2
  v_exp_f32 v3, v3
  v_exp_f32 v4, v4
  v_mfma_f32_32x32x16_bf16 v[32:47], a[32:35], a[124:127], 0
  v_exp_f32 v5, v5
  v_exp_f32 v6, v6
  v_exp_f32 v7, v7
  v_cvt_pk_bf16_f32 v0, v0, v1
  v_cvt_pk_bf16_f32 v1, v2, v3
  v_cvt_pk_bf16_f32 v2, v4, v5
  v_cvt_pk_bf16_f32 v3, v6, v7
  v_exp_f32 v8, v8
  v_exp_f32 v9, v9
  v_mfma_f32_32x32x16_bf16 v[160:175], a[88:91], v[0:3], v[160:175]
  buffer_load_dwordx4 a[216:219], v211, s[52:55], s17 offen offset:2048 sc1
  v_exp_f32 v10, v10
  v_exp_f32 v11, v11
  v_exp_f32 v12, v12
  v_exp_f32 v13, v13
  v_exp_f32 v14, v14
  v_exp_f32 v15, v15
  v_cvt_pk_bf16_f32 v4, v8, v9
  v_cvt_pk_bf16_f32 v5, v10, v11
  v_cvt_pk_bf16_f32 v6, v12, v13
  v_cvt_pk_bf16_f32 v7, v14, v15
  v_exp_f32 v16, v16
  v_exp_f32 v17, v17
  v_mfma_f32_32x32x16_bf16 v[160:175], a[92:95], v[4:7], v[160:175]
  buffer_load_dwordx4 a[220:223], v211, s[52:55], s17 offen offset:3072 sc1
  s_add_u32 s17, s19, 0
  v_exp_f32 v18, v18
  v_exp_f32 v19, v19
  v_exp_f32 v20, v20
  v_exp_f32 v21, v21
  v_exp_f32 v22, v22
  v_exp_f32 v23, v23
  v_cvt_pk_bf16_f32 v16, v16, v17
  v_cvt_pk_bf16_f32 v17, v18, v19
  v_cvt_pk_bf16_f32 v18, v20, v21
  v_cvt_pk_bf16_f32 v19, v22, v23
  s_add_u32 m0, s59, 122880
  v_exp_f32 v24, v24
  v_mfma_f32_32x32x16_bf16 v[160:175], a[96:99], v[16:19], v[160:175]
  buffer_load_dwordx4 v232, s[92:95], s16 offen offset:0  lds
  v_exp_f32 v25, v25
  v_exp_f32 v26, v26
  v_exp_f32 v27, v27
  v_exp_f32 v28, v28
  v_exp_f32 v29, v29
  v_exp_f32 v30, v30
  v_exp_f32 v31, v31
  v_cvt_pk_bf16_f32 v20, v24, v25
  v_cvt_pk_bf16_f32 v21, v26, v27
  v_cvt_pk_bf16_f32 v22, v28, v29
  v_cvt_pk_bf16_f32 v23, v30, v31
  v_exp_f32 v32, v32
  v_exp_f32 v33, v33
  v_mfma_f32_32x32x16_bf16 v[160:175], a[100:103], v[20:23], v[160:175]
  buffer_load_dwordx4 v233, s[92:95], s16 offen offset:1024  lds
  v_exp_f32 v34, v34
  v_exp_f32 v35, v35
  v_exp_f32 v36, v36
  v_exp_f32 v37, v37
  v_exp_f32 v38, v38
  v_exp_f32 v39, v39
  v_cvt_pk_bf16_f32 v32, v32, v33
  v_cvt_pk_bf16_f32 v33, v34, v35
  v_cvt_pk_bf16_f32 v34, v36, v37
  v_cvt_pk_bf16_f32 v35, v38, v39
  v_exp_f32 v40, v40
  v_exp_f32 v41, v41
  v_mfma_f32_32x32x16_bf16 v[160:175], a[104:107], v[32:35], v[160:175]
  buffer_load_dwordx4 v234, s[92:95], s16 offen offset:2048  lds
  v_exp_f32 v42, v42
  v_exp_f32 v43, v43
  v_exp_f32 v44, v44
  s_waitcnt vmcnt(8)
  v_cmp_ne_u64 vcc, v[250:251], v[216:217]
  s_nop 0
  s_cbranch_vccnz L_slow_h
L_back_h:
  v_exp_f32 v45, v45
  v_exp_f32 v46, v46
  v_exp_f32 v47, v47
  v_cvt_pk_bf16_f32 v36, v40, v41
  v_cvt_pk_bf16_f32 v37, v42, v43
  v_cvt_pk_bf16_f32 v38, v44, v45
  v_cvt_pk_bf16_f32 v39, v46, v47
  buffer_load_dwordx4 v235, s[92:95], s16 offen offset:3072  lds
  s_add_u32 s16, s27, 131072
  v_mfma_f32_32x32x16_bf16 v[160:175], a[108:111], v[36:39], v[160:175]
  s_nop 11
  v_min_f32 v184, v88, v168
  v_max_f32 v185, v88, v168
  v_add_f32 v176, v88, v168
  v_cmp_nle_f32 vcc, 0x30800000, v184
  v_cmp_u_f32 s[4:5], v176, v176
  s_nop 0
  s_or_b64 s[4:5], s[4:5], vcc
  v_cmp_nge_f32 vcc, 0x4e800000, v185
  s_nop 0
  s_or_b64 vcc, s[4:5], vcc
  s_cbranch_vccnz L_safe
L_safe_back:
  buffer_load_dwordx4 a[224:227], v211, s[52:55], s17 offen offset:0 sc1
  v_rcp_f32 v168, v168
  v_rcp_f32 v88, v88
  v_mul_f32 v168, v168, v255
  v_mul_f32 v160, v160, v168
  v_mul_f32 v161, v161, v168
  v_mul_f32 v162, v162, v168
  v_mul_f32 v163, v163, v168
  v_cvt_pk_bf16_f32 v160, v160, v161
  v_mul_f32 v164, v164, v168
  v_mul_f32 v165, v165, v168
  v_mul_f32 v166, v166, v168
  v_mul_f32 v167, v167, v168
  v_cvt_pk_bf16_f32 v161, v162, v163
  v_cvt_pk_bf16_f32 v162, v164, v165
  v_cvt_pk_bf16_f32 v163, v166, v167
  v_mul_f32 v88, v88, v254
  v_mul_f32 v80, v80, v88
  v_mul_f32 v81, v81, v88
  v_mul_f32 v82, v82, v88
  v_mul_f32 v83, v83, v88
  v_cvt_pk_bf16_f32 v80, v80, v81
  v_mul_f32 v84, v84, v88
  buffer_load_dwordx4 a[228:231], v211, s[52:55], s17 offen offset:1024 sc1
  buffer_store_dwordx4 v[160:163], v210, s[52:55], s65 offen sc1
  v_mul_f32 v85, v85, v88
  v_mul_f32 v86, v86, v88
  v_mul_f32 v87, v87, v88
  v_cvt_pk_bf16_f32 v81, v82, v83
  v_cvt_pk_bf16_f32 v82, v84, v85
  v_cvt_pk_bf16_f32 v83, v86, v87
  s_sub_u32 s65, s56, 16777216
  s_barrier
  ds_read_b64_tr_b16 v[48:49], v236 offset:32768
  ds_read_b64_tr_b16 v[50:51], v236 offset:34816
  ds_read_b64_tr_b16 v[52:53], v237 offset:32768
  ds_read_b64_tr_b16 v[54:55], v237 offset:34816
  ds_read_b64_tr_b16 v[56:57], v208 offset:32768
  ds_read_b64_tr_b16 v[58:59], v208 offset:34816
  ds_read_b64_tr_b16 v[60:61], v209 offset:32768
  buffer_store_dwordx4 v[80:83], v210, s[52:55], s64 offen sc1
  buffer_load_dwordx4 a[232:235], v211, s[52:55], s17 offen offset:2048 sc1
  ds_read_b64_tr_b16 v[62:63], v209 offset:34816
  ds_read_b64_tr_b16 v[64:65], v192 offset:8192
  s_xor_b32 s64, s56, 16384
  ds_read_b64_tr_b16 v[66:67], v192 offset:10240
  s_lshr_b32 s65, s65, 7
  ds_read_b64_tr_b16 v[68:69], v193 offset:8192
  s_add_u32 s65, s65, 15958016
  ds_read_b64_tr_b16 v[70:71], v193 offset:10240
  ds_read_b64_tr_b16 v[72:73], v194 offset:8192
  ds_read_b64_tr_b16 v[74:75], v194 offset:10240
  ds_read_b64_tr_b16 v[76:77], v195 offset:8192
  ds_read_b64_tr_b16 v[78:79], v195 offset:10240
  buffer_load_dwordx4 a[236:239], v211, s[52:55], s17 offen offset:3072 sc1
  s_add_u32 s17, s19, 4096
  s_waitcnt lgkmcnt(14)
  v_mfma_f32_16x16x32_bf16 v[0:3], v[48:51], a[128:131], 0
  v_mfma_f32_16x16x32_bf16 v[8:11], v[48:51], a[132:135], 0
  s_waitcnt lgkmcnt(12)
  ds_read_b64_tr_b16 v[48:49], v192 offset:49152
  v_mfma_f32_16x16x32_bf16 v[4:7], v[52:55], a[128:131], 0
  ds_read_b64_tr_b16 v[50:51], v192 offset:51200
  v_mfma_f32_16x16x32_bf16 v[12:15], v[52:55], a[132:135], 0
  s_waitcnt lgkmcnt(11)
  buffer_load_dwordx4 a[240:243], v211, s[52:55], s17 offen offset:0 sc1
  v_mfma_f32_16x16x32_bf16 v[16:19], v[56:59], a[128:131], 0
  ds_read_b64_tr_b16 v[52:53], v193 offset:49152
  ds_read_b64_tr_b16 v[54:55], v193 offset:51200
  v_mfma_f32_16x16x32_bf16 v[24:27], v[56:59], a[132:135], 0
  s_waitcnt lgkmcnt(9)
  ds_read_b64_tr_b16 v[56:57], v194 offset:49152
  v_mfma_f32_16x16x32_bf16 v[20:23], v[60:63], a[128:131], 0
  ds_read_b64_tr_b16 v[58:59], v194 offset:51200
  v_mfma_f32_16x16x32_bf16 v[28:31], v[60:63], a[132:135], 0
  ds_read_b64_tr_b16 v[60:61], v195 offset:49152
  ds_read_b64_tr_b16 v[62:63], v195 offset:51200
  v_mfma_f32_16x16x32_bf16 v[0:3], v[64:67], a[136:139], v[0:3]
  buffer_load_dwordx4 a[244:247], v211, s[52:55], s17 offen offset:1024 sc1
  v_mfma_f32_16x16x32_bf16 v[8:11], v[64:67], a[140:143], v[8:11]
  s_waitcnt lgkmcnt(8)
  ds_read_b64_tr_b16 v[64:65], v196 offset:24576
  v_mfma_f32_16x16x32_bf16 v[4:7], v[68:71], a[136:139], v[4:7]
  ds_read_b64_tr_b16 v[66:67], v196 offset:26624
  v_mfma_f32_16x16x32_bf16 v[12:15], v[68:71], a[140:143], v[12:15]
  ds_read_b64_tr_b16 v[68:69], v197 offset:24576
  ds_read_b64_tr_b16 v[70:71], v197 offset:26624
  v_mfma_f32_16x16x32_bf16 v[16:19], v[72:75], a[136:139], v[16:19]
  v_mfma_f32_16x16x32_bf16 v[24:27], v[72:75], a[140:143], v[24:27]
  buffer_load_dwordx4 a[248:251], v211, s[52:55], s17 offen offset:2048 sc1
  ds_read_b64_tr_b16 v[72:73], v198 offset:24576
  v_mfma_f32_16x16x32_bf16 v[20:23], v[76:79], a[136:139], v[20:23]
  ds_read_b64_tr_b16 v[74:75], v198 offset:26624
  v_mfma_f32_16x16x32_bf16 v[28:31], v[76:79], a[140:143], v[28:31]
  s_waitcnt lgkmcnt(9)
  ds_read_b64_tr_b16 v[76:77], v199 offset:24576
  v_mfma_f32_16x16x32_bf16 v[0:3], v[48:51], a[144:147], v[0:3]
  ds_read_b64_tr_b16 v[78:79], v199 offset:26624
  v_mfma_f32_16x16x32_bf16 v[8:11], v[48:51], a[148:151], v[8:11]
  ds_read_b64_tr_b16 v[48:49], v236 offset:0
  ds_read_b64_tr_b16 v[50:51], v236 offset:2048
  v_mfma_f32_16x16x32_bf16 v[4:7], v[52:55], a[144:147], v[4:7]
  buffer_load_dwordx4 a[252:255], v211, s[52:55], s17 offen offset:3072 sc1
  s_add_u32 s17, s19, 8192
  v_mfma_f32_16x16x32_bf16 v[12:15], v[52:55], a[148:151], v[12:15]
  s_waitcnt lgkmcnt(9)
  ds_read_b64_tr_b16 v[52:53], v237 offset:0
  v_mfma_f32_16x16x32_bf16 v[16:19], v[56:59], a[144:147], v[16:19]
  ds_read_b64_tr_b16 v[54:55], v237 offset:2048
  v_mfma_f32_16x16x32_bf16 v[24:27], v[56:59], a[148:151], v[24:27]
  ds_read_b64_tr_b16 v[56:57], v208 offset:0
  ds_read_b64_tr_b16 v[58:59], v208 offset:2048
  v_mfma_f32_16x16x32_bf16 v[20:23], v[60:63], a[144:147], v[20:23]
  v_mfma_f32_16x16x32_bf16 v[28:31], v[60:63], a[148:151], v[28:31]
  s_waitcnt lgkmcnt(9)
  buffer_load_dwordx4 v[96:99], v211, s[52:55], s17 offen offset:0 sc1
  v_mfma_f32_16x16x32_bf16 v[0:3], v[64:67], a[152:155], v[0:3]
  ds_read_b64_tr_b16 v[60:61], v209 offset:0
  ds_read_b64_tr_b16 v[62:63], v209 offset:2048
  v_mfma_f32_16x16x32_bf16 v[8:11], v[64:67], a[156:159], v[8:11]
  ds_read_b64_tr_b16 v[64:65], v236 offset:8192
  ds_read_b64_tr_b16 v[66:67], v236 offset:10240
  v_mfma_f32_16x16x32_bf16 v[4:7], v[68:71], a[152:155], v[4:7]
  v_mfma_f32_16x16x32_bf16 v[12:15], v[68:71], a[156:159], v[12:15]
  s_waitcnt lgkmcnt(8)
  ds_read_b64_tr_b16 v[68:69], v237 offset:8192
  v_mfma_f32_16x16x32_bf16 v[16:19], v[72:75], a[152:155], v[16:19]
  buffer_load_dwordx4 v[100:103], v211, s[52:55], s17 offen offset:1024 sc1
  ds_read_b64_tr_b16 v[70:71], v237 offset:10240
  v_mfma_f32_16x16x32_bf16 v[24:27], v[72:75], a[156:159], v[24:27]
  ds_read_b64_tr_b16 v[72:73], v208 offset:8192
  ds_read_b64_tr_b16 v[74:75], v208 offset:10240
  v_mfma_f32_16x16x32_bf16 v[20:23], v[76:79], a[152:155], v[20:23]
  v_mfma_f32_16x16x32_bf16 v[28:31], v[76:79], a[156:159], v[28:31]
  ds_read_b64_tr_b16 v[76:77], v209 offset:8192
  ds_read_b64_tr_b16 v[78:79], v209 offset:10240
  v_mfma_f32_16x16x32_bf16 v[0:3], v[48:51], a[160:163], v[0:3]
  v_mfma_f32_16x16x32_bf16 v[8:11], v[48:51], a[164:167], v[8:11]
  s_waitcnt lgkmcnt(10)
  buffer_load_dwordx4 v[104:107], v211, s[52:55], s17 offen offset:2048 sc1
  v_mfma_f32_16x16x32_bf16 v[4:7], v[52:55], a[160:163], v[4:7]
  ds_read_b64_tr_b16 v[48:49], v236 offset:16384
  ds_read_b64_tr_b16 v[50:51], v236 offset:18432
  v_mfma_f32_16x16x32_bf16 v[12:15], v[52:55], a[164:167], v[12:15]
  ds_read_b64_tr_b16 v[52:53], v237 offset:16384
  ds_read_b64_tr_b16 v[54:55], v237 offset:18432
  v_mfma_f32_16x16x32_bf16 v[16:19], v[56:59], a[160:163], v[16:19]
  v_mfma_f32_16x16x32_bf16 v[24:27], v[56:59], a[164:167], v[24:27]
  s_waitcnt lgkmcnt(9)
  ds_read_b64_tr_b16 v[56:57], v208 offset:16384
  v_mfma_f32_16x16x32_bf16 v[20:23], v[60:63], a[160:163], v[20:23]
  buffer_load_dwordx4 v[108:111], v211, s[52:55], s17 offen offset:3072 sc1
  s_add_u32 s17, s19, 12288
  v_mfma_f32_16x16x32_bf16 v[28:31], v[60:63], a[164:167], v[28:31]
  ds_read_b64_tr_b16 v[58:59], v208 offset:18432
  ds_read_b64_tr_b16 v[60:61], v209 offset:16384
  v_mfma_f32_16x16x32_bf16 v[0:3], v[64:67], a[168:171], v[0:3]
  ds_read_b64_tr_b16 v[62:63], v209 offset:18432
  v_mfma_f32_16x16x32_bf16 v[8:11], v[64:67], a[172:175], v[8:11]
  s_waitcnt lgkmcnt(8)
  ds_read_b64_tr_b16 v[64:65], v236 offset:24576
  v_mfma_f32_16x16x32_bf16 v[4:7], v[68:71], a[168:171], v[4:7]
  ds_read_b64_tr_b16 v[66:67], v236 offset:26624
  v_mfma_f32_16x16x32_bf16 v[12:15], v[68:71], a[172:175], v[12:15]
  buffer_load_dwordx4 v[112:115], v211, s[52:55], s17 offen offset:0 sc1
  ds_read_b64_tr_b16 v[68:69], v237 offset:24576
  v_mfma_f32_16x16x32_bf16 v[16:19], v[72:75], a[168:171], v[16:19]
  ds_read_b64_tr_b16 v[70:71], v237 offset:26624
  v_mfma_f32_16x16x32_bf16 v[24:27], v[72:75], a[172:175], v[24:27]
  ds_read_b64_tr_b16 v[72:73], v208 offset:24576
  ds_read_b64_tr_b16 v[74:75], v208 offset:26624
  v_mfma_f32_16x16x32_bf16 v[20:23], v[76:79], a[168:171], v[20:23]
  v_mfma_f32_16x16x32_bf16 v[28:31], v[76:79], a[172:175], v[28:31]
  s_waitcnt lgkmcnt(9)
  s_waitcnt vmcnt(14)
  v_mfma_f32_16x16x32_bf16 v[0:3], v[48:51], a[224:227], v[0:3]
  buffer_load_dwordx4 v[116:119], v211, s[52:55], s17 offen offset:1024 sc1
  s_waitcnt vmcnt(14)
  v_mfma_f32_16x16x32_bf16 v[8:11], v[48:51], a[228:231], v[8:11]
  ds_read_b64_tr_b16 v[76:77], v209 offset:24576
  ds_read_b64_tr_b16 v[78:79], v209 offset:26624
  v_mfma_f32_16x16x32_bf16 v[4:7], v[52:55], a[224:227], v[4:7]
  ds_read_b64_tr_b16 v[48:49], v236 offset:40960
  ds_read_b64_tr_b16 v[50:51], v236 offset:43008
  v_mfma_f32_16x16x32_bf16 v[12:15], v[52:55], a[228:231], v[12:15]
  s_waitcnt lgkmcnt(9)
  ds_read_b64_tr_b16 v[52:53], v237 offset:40960
  v_mfma_f32_16x16x32_bf16 v[16:19], v[56:59], a[224:227], v[16:19]
  ds_read_b64_tr_b16 v[54:55], v237 offset:43008
  v_mfma_f32_16x16x32_bf16 v[24:27], v[56:59], a[228:231], v[24:27]
  buffer_load_dwordx4 v[120:123], v211, s[52:55], s17 offen offset:2048 sc1
  ds_read_b64_tr_b16 v[56:57], v208 offset:40960
  v_mfma_f32_16x16x32_bf16 v[20:23], v[60:63], a[224:227], v[20:23]
  ds_read_b64_tr_b16 v[58:59], v208 offset:43008
  v_mfma_f32_16x16x32_bf16 v[28:31], v[60:63], a[228:231], v[28:31]
  s_waitcnt lgkmcnt(8)
  s_waitcnt vmcnt(12)
  v_mfma_f32_16x16x32_bf16 v[0:3], v[64:67], a[232:235], v[0:3]
  buffer_store_dwordx2 v[216:217], v252, s[52:55], s25 offen sc1
  s_waitcnt vmcnt(12)
  v_mfma_f32_16x16x32_bf16 v[8:11], v[64:67], a[236:239], v[8:11]
  ds_read_b64_tr_b16 v[60:61], v209 offset:40960
  ds_read_b64_tr_b16 v[62:63], v209 offset:43008
  v_mfma_f32_16x16x32_bf16 v[4:7], v[68:71], a[232:235], v[4:7]
  buffer_load_dwordx4 v[124:127], v211, s[52:55], s17 offen offset:3072 sc1
  s_add_u32 s17, s19, 0
  v_mfma_f32_16x16x32_bf16 v[12:15], v[68:71], a[236:239], v[12:15]
  s_add_u32 s17, s17, s21
  ds_read_b64_tr_b16 v[64:65], v236 offset:49152
  v_mfma_f32_16x16x32_bf16 v[16:19], v[72:75], a[232:235], v[16:19]
  ds_read_b64_tr_b16 v[66:67], v236 offset:51200
  ds_read_b64_tr_b16 v[68:69], v237 offset:49152
  v_mfma_f32_16x16x32_bf16 v[24:27], v[72:75], a[236:239], v[24:27]
  s_waitcnt lgkmcnt(8)
  ds_read_b64_tr_b16 v[70:71], v237 offset:51200
  v_mfma_f32_16x16x32_bf16 v[20:23], v[76:79], a[232:235], v[20:23]
  ds_read_b64_tr_b16 v[72:73], v208 offset:49152
  ds_read_b64_tr_b16 v[74:75], v208 offset:51200
  v_mfma_f32_16x16x32_bf16 v[28:31], v[76:79], a[236:239], v[28:31]
  buffer_load_dwordx4 v[128:131], v211, s[52:55], s17 offen offset:0 sc1
  s_waitcnt vmcnt(13)
  v_mfma_f32_16x16x32_bf16 v[0:3], v[48:51], a[240:243], v[0:3]
  ds_read_b64_tr_b16 v[76:77], v209 offset:49152
  s_waitcnt vmcnt(12)
  v_mfma_f32_16x16x32_bf16 v[8:11], v[48:51], a[244:247], v[8:11]
  s_waitcnt lgkmcnt(9)
  ds_read_b64_tr_b16 v[78:79], v209 offset:51200
  v_mfma_f32_16x16x32_bf16 v[4:7], v[52:55], a[240:243], v[4:7]
  ds_read_b64_tr_b16 v[48:49], v236 offset:57344
  ds_read_b64_tr_b16 v[50:51], v236 offset:59392
  v_mfma_f32_16x16x32_bf16 v[12:15], v[52:55], a[244:247], v[12:15]
  ds_read_b64_tr_b16 v[52:53], v237 offset:57344
  ds_read_b64_tr_b16 v[54:55], v237 offset:59392
  v_mfma_f32_16x16x32_bf16 v[16:19], v[56:59], a[240:243], v[16:19]
  buffer_load_dwordx4 v[132:135], v211, s[52:55], s17 offen offset:1024 sc1
  v_mfma_f32_16x16x32_bf16 v[24:27], v[56:59], a[244:247], v[24:27]
  s_waitcnt lgkmcnt(11)
  ds_read_b64_tr_b16 v[56:57], v208 offset:57344
  v_mfma_f32_16x16x32_bf16 v[20:23], v[60:63], a[240:243], v[20:23]
  ds_read_b64_tr_b16 v[58:59], v208 offset:59392
  v_mfma_f32_16x16x32_bf16 v[28:31], v[60:63], a[244:247], v[28:31]
  s_waitcnt lgkmcnt(10)
  s_waitcnt vmcnt(12)
  v_mfma_f32_16x16x32_bf16 v[0:3], v[64:67], a[248:251], v[0:3]
  ds_read_b64_tr_b16 v[60:61], v209 offset:57344
L_pg5:
  s_cbranch_execz L_pg9
  s_waitcnt vmcnt(11)
  v_mfma_f32_16x16x32_bf16 v[8:11], v[64:67], a[252:255], v[8:11]
  buffer_load_dwordx4 v[136:139], v211, s[52:55], s17 offen offset:2048 sc1
  ds_read_b64_tr_b16 v[62:63], v209 offset:59392
  v_mfma_f32_16x16x32_bf16 v[4:7], v[68:71], a[248:251], v[4:7]
  ds_read_b64_tr_b16 v[64:65], v192 offset:0
  ds_read_b64_tr_b16 v[66:67], v192 offset:2048
  v_mfma_f32_16x16x32_bf16 v[12:15], v[68:71], a[252:255], v[12:15]
  s_waitcnt lgkmcnt(10)
  ds_read_b64_tr_b16 v[68:69], v193 offset:0
  v_mfma_f32_16x16x32_bf16 v[16:19], v[72:75], a[248:251], v[16:19]
  ds_read_b64_tr_b16 v[70:71], v193 offset:2048
  v_mfma_f32_16x16x32_bf16 v[24:27], v[72:75], a[252:255], v[24:27]
  ds_read_b64_tr_b16 v[72:73], v194 offset:0
  ds_read_b64_tr_b16 v[74:75], v194 offset:2048
  v_mfma_f32_16x16x32_bf16 v[20:23], v[76:79], a[248:251], v[20:23]
  buffer_load_dwordx4 v[140:143], v211, s[52:55], s17 offen offset:3072 sc1
  s_add_u32 s17, s19, 4096
  v_mfma_f32_16x16x32_bf16 v[28:31], v[76:79], a[252:255], v[28:31]
  s_waitcnt lgkmcnt(9)
  s_waitcnt vmcnt(12)
  v_mfma_f32_16x16x32_bf16 v[0:3], v[48:51], v[96:99], v[0:3]
  s_add_u32 s17, s17, s21
  s_waitcnt vmcnt(11)
  v_mfma_f32_16x16x32_bf16 v[8:11], v[48:51], v[100:103], v[8:11]
  ds_read_b64_tr_b16 v[76:77], v195 offset:0
  ds_read_b64_tr_b16 v[78:79], v195 offset:2048
  v_mfma_f32_16x16x32_bf16 v[4:7], v[52:55], v[96:99], v[4:7]
  ds_read_b64_tr_b16 v[48:49], v192 offset:16384
  ds_read_b64_tr_b16 v[50:51], v192 offset:18432
  v_mfma_f32_16x16x32_bf16 v[12:15], v[52:55], v[100:103], v[12:15]
  s_waitcnt lgkmcnt(10)
  buffer_load_dwordx4 v[144:147], v211, s[52:55], s17 offen offset:0 sc1
  v_mfma_f32_16x16x32_bf16 v[16:19], v[56:59], v[96:99], v[16:19]
  ds_read_b64_tr_b16 v[52:53], v193 offset:16384
  ds_read_b64_tr_b16 v[54:55], v193 offset:18432
  v_mfma_f32_16x16x32_bf16 v[24:27], v[56:59], v[100:103], v[24:27]
  ds_read_b64_tr_b16 v[56:57], v194 offset:16384
  ds_read_b64_tr_b16 v[58:59], v194 offset:18432
  v_mfma_f32_16x16x32_bf16 v[20:23], v[60:63], v[96:99], v[20:23]
  v_mfma_f32_16x16x32_bf16 v[28:31], v[60:63], v[100:103], v[28:31]
  s_waitcnt lgkmcnt(8)
  s_waitcnt vmcnt(11)
  v_mfma_f32_16x16x32_bf16 v[0:3], v[64:67], v[104:107], v[0:3]
  buffer_load_dwordx4 v[148:151], v211, s[52:55], s17 offen offset:1024 sc1
  s_waitcnt vmcnt(11)
  v_mfma_f32_16x16x32_bf16 v[8:11], v[64:67], v[108:111], v[8:11]
  ds_read_b64_tr_b16 v[60:61], v195 offset:16384
  ds_read_b64_tr_b16 v[62:63], v195 offset:18432
  v_mfma_f32_16x16x32_bf16 v[4:7], v[68:71], v[104:107], v[4:7]
  ds_read_b64_tr_b16 v[64:65], v192 offset:24576
  ds_read_b64_tr_b16 v[66:67], v192 offset:26624
  v_mfma_f32_16x16x32_bf16 v[12:15], v[68:71], v[108:111], v[12:15]
  ds_read_b64_tr_b16 v[68:69], v193 offset:24576
  ds_read_b64_tr_b16 v[70:71], v193 offset:26624
  v_mfma_f32_16x16x32_bf16 v[16:19], v[72:75], v[104:107], v[16:19]
  v_mfma_f32_16x16x32_bf16 v[24:27], v[72:75], v[108:111], v[24:27]
  s_waitcnt lgkmcnt(10)
  buffer_load_dwordx4 v[152:155], v211, s[52:55], s17 offen offset:2048 sc1
  v_mfma_f32_16x16x32_bf16 v[20:23], v[76:79], v[104:107], v[20:23]
  ds_read_b64_tr_b16 v[72:73], v194 offset:24576
  ds_read_b64_tr_b16 v[74:75], v194 offset:26624
  v_mfma_f32_16x16x32_bf16 v[28:31], v[76:79], v[108:111], v[28:31]
  s_waitcnt lgkmcnt(8)
  s_waitcnt vmcnt(11)
  v_mfma_f32_16x16x32_bf16 v[16:19], v[56:59], v[112:115], v[16:19]
  ds_read_b64_tr_b16 v[76:77], v195 offset:24576
  ds_read_b64_tr_b16 v[78:79], v195 offset:26624
  buffer_load_dwordx4 v[156:159], v211, s[52:55], s17 offen offset:3072 sc1
  s_waitcnt vmcnt(11)
  v_mfma_f32_16x16x32_bf16 v[24:27], v[56:59], v[116:119], v[24:27]
  s_waitcnt lgkmcnt(8)
  s_add_u32 s17, s19, 8192
  v_mfma_f32_16x16x32_bf16 v[20:23], v[60:63], v[112:115], v[20:23]
  s_add_u32 s17, s17, s21
  ds_read_b64_tr_b16 v[56:57], v208 offset:32768
  v_mfma_f32_16x16x32_bf16 v[28:31], v[60:63], v[116:119], v[28:31]
  ds_read_b64_tr_b16 v[58:59], v208 offset:34816
  ds_read_b64_tr_b16 v[60:61], v209 offset:32768
  ds_read_b64_tr_b16 v[62:63], v209 offset:34816
  buffer_load_dwordx4 a[0:3], v211, s[52:55], s17 offen offset:0 sc1
  s_waitcnt vmcnt(11) lgkmcnt(6)
  v_mfma_f32_16x16x32_bf16 v[16:19], v[72:75], v[120:123], v[16:19]
  buffer_load_dwordx4 a[4:7], v211, s[52:55], s17 offen offset:1024 sc1
  s_waitcnt vmcnt(10)
  v_mfma_f32_16x16x32_bf16 v[24:27], v[72:75], v[124:127], v[24:27]
  s_waitcnt lgkmcnt(4)
  ds_read_b64_tr_b16 v[72:73], v194 offset:8192
  v_mfma_f32_16x16x32_bf16 v[20:23], v[76:79], v[120:123], v[20:23]
  ds_read_b64_tr_b16 v[74:75], v194 offset:10240
  v_mfma_f32_16x16x32_bf16 v[28:31], v[76:79], v[124:127], v[28:31]
  ds_read_b64_tr_b16 v[76:77], v195 offset:8192
  ds_read_b64_tr_b16 v[78:79], v195 offset:10240
  v_mfma_f32_16x16x32_bf16 v[0:3], v[48:51], v[112:115], v[0:3]
  v_mfma_f32_16x16x32_bf16 v[8:11], v[48:51], v[116:119], v[8:11]
  buffer_load_dwordx4 a[8:11], v211, s[52:55], s17 offen offset:2048 sc1
  ds_read_b64_tr_b16 v[48:49], v236 offset:32768
  v_mfma_f32_16x16x32_bf16 v[4:7], v[52:55], v[112:115], v[4:7]
  ds_write_b128 v240, v[16:19] offset:0
  ds_write_b128 v240, v[20:23] offset:1024
  ds_write_b128 v240, v[24:27] offset:2048
  ds_write_b128 v240, v[28:31] offset:3072
  v_mfma_f32_16x16x32_bf16 v[12:15], v[52:55], v[116:119], v[12:15]
  v_mfma_f32_16x16x32_bf16 v[0:3], v[64:67], v[120:123], v[0:3]
  v_mfma_f32_16x16x32_bf16 v[8:11], v[64:67], v[124:127], v[8:11]
  v_mfma_f32_16x16x32_bf16 v[4:7], v[68:71], v[120:123], v[4:7]
  buffer_load_dwordx4 a[12:15], v211, s[52:55], s17 offen offset:3072 sc1
  s_add_u32 s17, s19, 12288
  v_mfma_f32_16x16x32_bf16 v[12:15], v[68:71], v[124:127], v[12:15]
  s_add_u32 s17, s17, s21
  s_waitcnt lgkmcnt(0)
  s_barrier
  buffer_load_dwordx4 a[16:19], v211, s[52:55], s17 offen offset:0 sc1
  ds_read_b128 v[80:83], v244 offset:0
  ds_read_b128 v[84:87], v244 offset:1024
  ds_read_b128 v[88:91], v244 offset:2048
  ds_read_b128 v[92:95], v244 offset:3072
  buffer_load_dwordx4 a[20:23], v211, s[52:55], s17 offen offset:1024 sc1
  ds_read_b64_tr_b16 v[50:51], v236 offset:34816
  ds_read_b64_tr_b16 v[52:53], v237 offset:32768
  ds_read_b64_tr_b16 v[54:55], v237 offset:34816
  ds_read_b64_tr_b16 v[64:65], v192 offset:8192
  ds_read_b64_tr_b16 v[66:67], v192 offset:10240
  ds_read_b64_tr_b16 v[68:69], v193 offset:8192
  ds_read_b64_tr_b16 v[70:71], v193 offset:10240
  s_waitcnt lgkmcnt(10)
  v_add_f32 v0, v0, v80
  v_add_f32 v1, v1, v81
  v_add_f32 v2, v2, v82
  v_add_f32 v3, v3, v83
  s_waitcnt lgkmcnt(9)
  v_add_f32 v4, v4, v84
  v_add_f32 v5, v5, v85
  v_add_f32 v6, v6, v86
  v_add_f32 v7, v7, v87
  v_cvt_pk_bf16_f32 v0, v0, v1
  v_cvt_pk_bf16_f32 v1, v2, v3
  v_cvt_pk_bf16_f32 v2, v4, v5
  s_waitcnt lgkmcnt(6)
  v_mfma_f32_16x16x32_bf16 v[160:163], v[48:51], a[176:179], 0
  v_cvt_pk_bf16_f32 v3, v6, v7
  v_add_f32 v8, v8, v88
  v_mfma_f32_16x16x32_bf16 v[168:171], v[48:51], a[180:183], 0
  s_waitcnt lgkmcnt(4)
  v_add_f32 v9, v9, v89
  v_mfma_f32_16x16x32_bf16 v[164:167], v[52:55], a[176:179], 0
  v_add_f32 v10, v10, v90
  v_add_f32 v11, v11, v91
  v_mfma_f32_16x16x32_bf16 v[172:175], v[52:55], a[180:183], 0
  s_waitcnt lgkmcnt(0)
  s_barrier
  v_mfma_f32_16x16x32_bf16 v[32:35], v[56:59], a[176:179], 0
  v_add_f32 v12, v12, v92
  v_add_f32 v13, v13, v93
  v_mfma_f32_16x16x32_bf16 v[40:43], v[56:59], a[180:183], 0
  v_add_f32 v14, v14, v94
  v_add_f32 v15, v15, v95
  v_mfma_f32_16x16x32_bf16 v[36:39], v[60:63], a[176:179], 0
  v_cvt_pk_bf16_f32 v4, v8, v9
  v_cvt_pk_bf16_f32 v5, v10, v11
  v_mfma_f32_16x16x32_bf16 v[44:47], v[60:63], a[180:183], 0
  v_cvt_pk_bf16_f32 v6, v12, v13
  v_cvt_pk_bf16_f32 v7, v14, v15
  v_mfma_f32_16x16x32_bf16 v[160:163], v[64:67], a[184:187], v[160:163]
  buffer_store_dwordx4 v[0:3], v211, s[52:55], s56 offen offset:0 sc1
  buffer_store_dwordx4 v[4:7], v211, s[52:55], s56 offen offset:1024 sc1
  v_mfma_f32_16x16x32_bf16 v[168:171], v[64:67], a[188:191], v[168:171]
  buffer_load_dwordx4 a[24:27], v211, s[52:55], s17 offen offset:2048 sc1
  ds_read_b64_tr_b16 v[48:49], v192 offset:49152
  v_mfma_f32_16x16x32_bf16 v[164:167], v[68:71], a[184:187], v[164:167]
  ds_read_b64_tr_b16 v[50:51], v192 offset:51200
  ds_read_b64_tr_b16 v[52:53], v193 offset:49152
  v_mfma_f32_16x16x32_bf16 v[172:175], v[68:71], a[188:191], v[172:175]
  s_mov_b32 s100, 15794176
  buffer_load_dwordx2 v[250:251], v248, s[52:55], s100 offen sc1
  v_mfma_f32_16x16x32_bf16 v[32:35], v[72:75], a[184:187], v[32:35]
  ds_read_b64_tr_b16 v[54:55], v193 offset:51200
  ds_read_b64_tr_b16 v[56:57], v194 offset:49152
  v_mfma_f32_16x16x32_bf16 v[40:43], v[72:75], a[188:191], v[40:43]
  ds_read_b64_tr_b16 v[58:59], v194 offset:51200
  ds_read_b64_tr_b16 v[60:61], v195 offset:49152
  v_mfma_f32_16x16x32_bf16 v[36:39], v[76:79], a[184:187], v[36:39]
  buffer_load_dwordx4 a[28:31], v211, s[52:55], s17 offen offset:3072 sc1
  ds_read_b64_tr_b16 v[62:63], v195 offset:51200
  v_mfma_f32_16x16x32_bf16 v[44:47], v[76:79], a[188:191], v[44:47]
  ds_read_b64_tr_b16 v[64:65], v196 offset:24576
  ds_read_b64_tr_b16 v[66:67], v196 offset:26624
  ds_read_b64_tr_b16 v[68:69], v197 offset:24576
  ds_read_b64_tr_b16 v[70:71], v197 offset:26624
  ds_read_b64_tr_b16 v[72:73], v198 offset:24576
  ds_read_b64_tr_b16 v[74:75], v198 offset:26624
  ds_read_b64_tr_b16 v[76:77], v199 offset:24576
  s_waitcnt lgkmcnt(13)
  v_mfma_f32_16x16x32_bf16 v[160:163], v[48:51], a[192:195], v[160:163]
  ds_read_b64_tr_b16 v[78:79], v199 offset:26624
  s_add_u32 s17, s9, 0
  v_mfma_f32_16x16x32_bf16 v[168:171], v[48:51], a[196:199], v[168:171]
  ds_read_b64_tr_b16 v[48:49], v236 offset:0
  s_waitcnt lgkmcnt(13)
  v_mfma_f32_16x16x32_bf16 v[164:167], v[52:55], a[192:195], v[164:167]
  s_add_u32 m0, s59, 139264
  ds_read_b64_tr_b16 v[50:51], v236 offset:2048
  v_mfma_f32_16x16x32_bf16 v[172:175], v[52:55], a[196:199], v[172:175]
  s_waitcnt lgkmcnt(12)
  buffer_load_dwordx4 v232, s[92:95], s16 offen offset:0  lds
  v_mfma_f32_16x16x32_bf16 v[32:35], v[56:59], a[192:195], v[32:35]
  ds_read_b64_tr_b16 v[52:53], v237 offset:0
  ds_read_b64_tr_b16 v[54:55], v237 offset:2048
  v_mfma_f32_16x16x32_bf16 v[40:43], v[56:59], a[196:199], v[40:43]
  s_waitcnt lgkmcnt(12)
  ds_read_b64_tr_b16 v[56:57], v208 offset:0
  v_mfma_f32_16x16x32_bf16 v[36:39], v[60:63], a[192:195], v[36:39]
  ds_read_b64_tr_b16 v[58:59], v208 offset:2048
  v_add_u32 v196, v239, v196
  v_mfma_f32_16x16x32_bf16 v[44:47], v[60:63], a[196:199], v[44:47]
  s_waitcnt lgkmcnt(12)
  ds_read_b64_tr_b16 v[60:61], v209 offset:0
  v_mfma_f32_16x16x32_bf16 v[160:163], v[64:67], a[200:203], v[160:163]
  ds_read_b64_tr_b16 v[62:63], v209 offset:2048
  buffer_load_dwordx4 v233, s[92:95], s16 offen offset:1024  lds
  v_mfma_f32_16x16x32_bf16 v[168:171], v[64:67], a[204:207], v[168:171]
  s_waitcnt lgkmcnt(9)
  ds_read_b64_tr_b16 v[64:65], v236 offset:8192
  v_mfma_f32_16x16x32_bf16 v[164:167], v[68:71], a[200:203], v[164:167]
  ds_read_b64_tr_b16 v[66:67], v236 offset:10240
  v_add_u32 v197, v239, v197
  v_mfma_f32_16x16x32_bf16 v[172:175], v[68:71], a[204:207], v[172:175]
  ds_read_b64_tr_b16 v[68:69], v237 offset:8192
  ds_read_b64_tr_b16 v[70:71], v237 offset:10240
  v_mfma_f32_16x16x32_bf16 v[32:35], v[72:75], a[200:203], v[32:35]
  v_add_u32 v198, v239, v198
  v_add_u32 v199, v239, v199
  v_mfma_f32_16x16x32_bf16 v[40:43], v[72:75], a[204:207], v[40:43]
  s_waitcnt lgkmcnt(10)
  buffer_load_dwordx4 v234, s[92:95], s16 offen offset:2048  lds
  v_mfma_f32_16x16x32_bf16 v[36:39], v[76:79], a[200:203], v[36:39]
  ds_read_b64_tr_b16 v[72:73], v208 offset:8192
  ds_read_b64_tr_b16 v[74:75], v208 offset:10240
  v_mfma_f32_16x16x32_bf16 v[44:47], v[76:79], a[204:207], v[44:47]
  ds_read_b64_tr_b16 v[76:77], v209 offset:8192
  ds_read_b64_tr_b16 v[78:79], v209 offset:10240
  v_mfma_f32_16x16x32_bf16 v[160:163], v[48:51], a[208:211], v[160:163]
  v_mfma_f32_16x16x32_bf16 v[168:171], v[48:51], a[212:215], v[168:171]
  s_waitcnt lgkmcnt(9)
  ds_read_b64_tr_b16 v[48:49], v236 offset:16384
  v_mfma_f32_16x16x32_bf16 v[164:167], v[52:55], a[208:211], v[164:167]
  ds_read_b64_tr_b16 v[50:51], v236 offset:18432
  buffer_load_dwordx4 v235, s[92:95], s16 offen offset:3072  lds
  v_mfma_f32_16x16x32_bf16 v[172:175], v[52:55], a[212:215], v[172:175]
  s_add_u32 s16, s27, 196608
  ds_read_b64_tr_b16 v[52:53], v237 offset:16384
  v_mfma_f32_16x16x32_bf16 v[32:35], v[56:59], a[208:211], v[32:35]
  ds_read_b64_tr_b16 v[54:55], v237 offset:18432
  v_mfma_f32_16x16x32_bf16 v[40:43], v[56:59], a[212:215], v[40:43]
  s_waitcnt lgkmcnt(8)
  ds_read_b64_tr_b16 v[56:57], v208 offset:16384
  v_mfma_f32_16x16x32_bf16 v[36:39], v[60:63], a[208:211], v[36:39]
  ds_read_b64_tr_b16 v[58:59], v208 offset:18432
  v_mfma_f32_16x16x32_bf16 v[44:47], v[60:63], a[212:215], v[44:47]
  ds_read_b64_tr_b16 v[60:61], v209 offset:16384
  s_add_u32 m0, s8, 0
  v_mfma_f32_16x16x32_bf16 v[160:163], v[64:67], a[216:219], v[160:163]
  buffer_load_dwordx4 v232, s[92:95], s16 offen offset:0  lds
  ds_read_b64_tr_b16 v[62:63], v209 offset:18432
  v_mfma_f32_16x16x32_bf16 v[168:171], v[64:67], a[220:223], v[168:171]
  ds_read_b64_tr_b16 v[64:65], v236 offset:24576
  ds_read_b64_tr_b16 v[66:67], v236 offset:26624
  v_mfma_f32_16x16x32_bf16 v[164:167], v[68:71], a[216:219], v[164:167]
  v_mfma_f32_16x16x32_bf16 v[172:175], v[68:71], a[220:223], v[172:175]
  s_waitcnt lgkmcnt(9)
  ds_read_b64_tr_b16 v[68:69], v237 offset:24576
  v_mfma_f32_16x16x32_bf16 v[32:35], v[72:75], a[216:219], v[32:35]
  ds_read_b64_tr_b16 v[70:71], v237 offset:26624
  v_mfma_f32_16x16x32_bf16 v[40:43], v[72:75], a[220:223], v[40:43]
  buffer_load_dwordx4 v233, s[92:95], s16 offen offset:1024  lds
  ds_read_b64_tr_b16 v[72:73], v208 offset:24576
  v_mfma_f32_16x16x32_bf16 v[36:39], v[76:79], a[216:219], v[36:39]
  ds_read_b64_tr_b16 v[74:75], v208 offset:26624
  v_mfma_f32_16x16x32_bf16 v[44:47], v[76:79], a[220:223], v[44:47]
  s_waitcnt lgkmcnt(9)
  s_waitcnt vmcnt(24)
  v_mfma_f32_16x16x32_bf16 v[160:163], v[48:51], v[128:131], v[160:163]
  ds_read_b64_tr_b16 v[76:77], v209 offset:24576
  s_waitcnt vmcnt(23)
  v_mfma_f32_16x16x32_bf16 v[168:171], v[48:51], v[132:135], v[168:171]
  ds_read_b64_tr_b16 v[78:79], v209 offset:26624
  ds_read_b64_tr_b16 v[48:49], v236 offset:40960
  v_mfma_f32_16x16x32_bf16 v[164:167], v[52:55], v[128:131], v[164:167]
  buffer_load_dwordx4 v234, s[92:95], s16 offen offset:2048  lds
  ds_read_b64_tr_b16 v[50:51], v236 offset:43008
  v_mfma_f32_16x16x32_bf16 v[172:175], v[52:55], v[132:135], v[172:175]
  s_waitcnt lgkmcnt(8)
  ds_read_b64_tr_b16 v[52:53], v237 offset:40960
  v_mfma_f32_16x16x32_bf16 v[32:35], v[56:59], v[128:131], v[32:35]
  ds_read_b64_tr_b16 v[54:55], v237 offset:43008
  v_mfma_f32_16x16x32_bf16 v[40:43], v[56:59], v[132:135], v[40:43]
  ds_read_b64_tr_b16 v[56:57], v208 offset:40960
  ds_read_b64_tr_b16 v[58:59], v208 offset:43008
  v_mfma_f32_16x16x32_bf16 v[36:39], v[60:63], v[128:131], v[36:39]
  s_waitcnt vmcnt(8)
  v_cmp_ne_u64 vcc, v[250:251], v[216:217]
  s_nop 0
  s_cbranch_vccnz L_slow_o
L_back_o:
  v_mfma_f32_16x16x32_bf16 v[44:47], v[60:63], v[132:135], v[44:47]
  buffer_load_dwordx4 v235, s[92:95], s16 offen offset:3072  lds
  ds_read_b64_tr_b16 v[60:61], v209 offset:40960
  v_mfma_f32_16x16x32_bf16 v[160:163], v[64:67], v[136:139], v[160:163]
  ds_read_b64_tr_b16 v[62:63], v209 offset:43008
  buffer_load_dword v184, v253, s[52:55], s20 offen offset:0 sc1
  v_mfma_f32_16x16x32_bf16 v[168:171], v[64:67], v[140:143], v[168:171]
  s_waitcnt lgkmcnt(9)
  ds_read_b64_tr_b16 v[64:65], v236 offset:49152
  v_mfma_f32_16x16x32_bf16 v[164:167], v[68:71], v[136:139], v[164:167]
  ds_read_b64_tr_b16 v[66:67], v236 offset:51200
  buffer_load_dword v254, v253, s[52:55], s20 offen offset:64 sc1
  v_mfma_f32_16x16x32_bf16 v[172:175], v[68:71], v[140:143], v[172:175]
  ds_read_b64_tr_b16 v[68:69], v237 offset:49152
  ds_read_b64_tr_b16 v[70:71], v237 offset:51200
  v_mfma_f32_16x16x32_bf16 v[32:35], v[72:75], v[136:139], v[32:35]
  buffer_load_dwordx4 a[32:35], v211, s[52:55], s17 offen offset:0 sc1
  v_mfma_f32_16x16x32_bf16 v[40:43], v[72:75], v[140:143], v[40:43]
  s_waitcnt lgkmcnt(8)
  ds_read_b64_tr_b16 v[72:73], v208 offset:49152
  v_mfma_f32_16x16x32_bf16 v[36:39], v[76:79], v[136:139], v[36:39]
  ds_read_b64_tr_b16 v[74:75], v208 offset:51200
  v_mfma_f32_16x16x32_bf16 v[44:47], v[76:79], v[140:143], v[44:47]
  buffer_store_dwordx2 v[216:217], v252, s[52:55], s65 offen sc1
  ds_read_b64_tr_b16 v[76:77], v209 offset:49152
  v_mfma_f32_16x16x32_bf16 v[160:163], v[48:51], v[144:147], v[160:163]
  ds_read_b64_tr_b16 v[78:79], v209 offset:51200
  v_mfma_f32_16x16x32_bf16 v[168:171], v[48:51], v[148:151], v[168:171]
  buffer_load_dwordx4 a[36:39], v211, s[52:55], s17 offen offset:1024 sc1
  ds_read_b64_tr_b16 v[48:49], v236 offset:57344
  v_mfma_f32_16x16x32_bf16 v[164:167], v[52:55], v[144:147], v[164:167]
  ds_read_b64_tr_b16 v[50:51], v236 offset:59392
  v_add_u32 v236, v239, v236
  v_mfma_f32_16x16x32_bf16 v[172:175], v[52:55], v[148:151], v[172:175]
  s_waitcnt lgkmcnt(9)
  ds_read_b64_tr_b16 v[52:53], v237 offset:57344
  v_mfma_f32_16x16x32_bf16 v[32:35], v[56:59], v[144:147], v[32:35]
  ds_read_b64_tr_b16 v[54:55], v237 offset:59392
  v_add_u32 v237, v239, v237
  v_mfma_f32_16x16x32_bf16 v[40:43], v[56:59], v[148:151], v[40:43]
  ds_read_b64_tr_b16 v[56:57], v208 offset:57344
  ds_read_b64_tr_b16 v[58:59], v208 offset:59392
  v_mfma_f32_16x16x32_bf16 v[36:39], v[60:63], v[144:147], v[36:39]
  buffer_load_dwordx4 a[40:43], v211, s[52:55], s17 offen offset:2048 sc1
  v_add_u32 v208, v239, v208
  v_mfma_f32_16x16x32_bf16 v[44:47], v[60:63], v[148:151], v[44:47]
  s_waitcnt lgkmcnt(9)
  ds_read_b64_tr_b16 v[60:61], v209 offset:57344
  v_mfma_f32_16x16x32_bf16 v[160:163], v[64:67], v[152:155], v[160:163]
  ds_read_b64_tr_b16 v[62:63], v209 offset:59392
  v_add_u32 v209, v239, v209
  v_mfma_f32_16x16x32_bf16 v[168:171], v[64:67], v[156:159], v[168:171]
  ds_read_b64_tr_b16 v[64:65], v192 offset:0
  ds_read_b64_tr_b16 v[66:67], v192 offset:2048
  v_mfma_f32_16x16x32_bf16 v[164:167], v[68:71], v[152:155], v[164:167]
  v_mfma_f32_16x16x32_bf16 v[172:175], v[68:71], v[156:159], v[172:175]
  s_waitcnt lgkmcnt(9)
  buffer_load_dwordx4 a[44:47], v211, s[52:55], s17 offen offset:3072 sc1
  v_mfma_f32_16x16x32_bf16 v[32:35], v[72:75], v[152:155], v[32:35]
  s_add_u32 s17, s9, 4096
  ds_read_b64_tr_b16 v[68:69], v193 offset:0
  v_mfma_f32_16x16x32_bf16 v[40:43], v[72:75], v[156:159], v[40:43]
  ds_read_b64_tr_b16 v[70:71], v193 offset:2048
  ds_read_b64_tr_b16 v[72:73], v194 offset:0
  v_mfma_f32_16x16x32_bf16 v[36:39], v[76:79], v[152:155], v[36:39]
  ds_read_b64_tr_b16 v[74:75], v194 offset:2048
  v_mfma_f32_16x16x32_bf16 v[44:47], v[76:79], v[156:159], v[44:47]
  s_waitcnt lgkmcnt(8)
  ds_read_b64_tr_b16 v[76:77], v195 offset:0
  v_mfma_f32_16x16x32_bf16 v[160:163], v[48:51], a[0:3], v[160:163]
  ds_read_b64_tr_b16 v[78:79], v195 offset:2048
  buffer_load_dwordx4 a[48:51], v211, s[52:55], s17 offen offset:0 sc1
  v_mfma_f32_16x16x32_bf16 v[168:171], v[48:51], a[4:7], v[168:171]
  ds_read_b64_tr_b16 v[48:49], v192 offset:16384
  ds_read_b64_tr_b16 v[50:51], v192 offset:18432
  v_mfma_f32_16x16x32_bf16 v[164:167], v[52:55], a[0:3], v[164:167]
  v_mfma_f32_16x16x32_bf16 v[172:175], v[52:55], a[4:7], v[172:175]
  ds_read_b64_tr_b16 v[52:53], v193 offset:16384
  ds_read_b64_tr_b16 v[54:55], v193 offset:18432
  v_mfma_f32_16x16x32_bf16 v[32:35], v[56:59], a[0:3], v[32:35]
  v_mfma_f32_16x16x32_bf16 v[40:43], v[56:59], a[4:7], v[40:43]
  s_waitcnt lgkmcnt(10)
  buffer_load_dwordx4 a[52:55], v211, s[52:55], s17 offen offset:1024 sc1
  v_mfma_f32_16x16x32_bf16 v[36:39], v[60:63], a[0:3], v[36:39]
  ds_read_b64_tr_b16 v[56:57], v194 offset:16384
  ds_read_b64_tr_b16 v[58:59], v194 offset:18432
  v_mfma_f32_16x16x32_bf16 v[44:47], v[60:63], a[4:7], v[44:47]
  ds_read_b64_tr_b16 v[60:61], v195 offset:16384
  ds_read_b64_tr_b16 v[62:63], v195 offset:18432
  v_mfma_f32_16x16x32_bf16 v[160:163], v[64:67], a[8:11], v[160:163]
  v_mfma_f32_16x16x32_bf16 v[168:171], v[64:67], a[12:15], v[168:171]
  s_waitcnt lgkmcnt(9)
  ds_read_b64_tr_b16 v[64:65], v192 offset:24576
  v_mfma_f32_16x16x32_bf16 v[164:167], v[68:71], a[8:11], v[164:167]
  ds_read_b64_tr_b16 v[66:67], v192 offset:26624
  buffer_load_dwordx4 a[56:59], v211, s[52:55], s17 offen offset:2048 sc1
  v_mfma_f32_16x16x32_bf16 v[172:175], v[68:71], a[12:15], v[172:175]
  ds_read_b64_tr_b16 v[68:69], v193 offset:24576
  ds_read_b64_tr_b16 v[70:71], v193 offset:26624
  v_mfma_f32_16x16x32_bf16 v[32:35], v[72:75], a[8:11], v[32:35]
  v_add_u32 v192, v239, v192
  v_add_u32 v193, v239, v193
  v_mfma_f32_16x16x32_bf16 v[40:43], v[72:75], a[12:15], v[40:43]
  s_waitcnt lgkmcnt(8)
  ds_read_b64_tr_b16 v[72:73], v194 offset:24576
  v_mfma_f32_16x16x32_bf16 v[36:39], v[76:79], a[8:11], v[36:39]
  ds_read_b64_tr_b16 v[74:75], v194 offset:26624
  v_add_u32 v194, v239, v194
  v_mfma_f32_16x16x32_bf16 v[44:47], v[76:79], a[12:15], v[44:47]
  ds_read_b64_tr_b16 v[76:77], v195 offset:24576
  buffer_load_dwordx4 a[60:63], v211, s[52:55], s17 offen offset:3072 sc1
  v_mfma_f32_16x16x32_bf16 v[160:163], v[48:51], a[16:19], v[160:163]
  s_add_u32 s17, s9, 8192
  ds_read_b64_tr_b16 v[78:79], v195 offset:26624
  v_mfma_f32_16x16x32_bf16 v[168:171], v[48:51], a[20:23], v[168:171]
  ds_read_b64_tr_b16 v[48:49], v192 offset:32768
  ds_read_b64_tr_b16 v[50:51], v192 offset:33792
  v_mfma_f32_16x16x32_bf16 v[164:167], v[52:55], a[16:19], v[164:167]
  v_add_u32 v195, v239, v195
  v_mfma_f32_16x16x32_bf16 v[172:175], v[52:55], a[20:23], v[172:175]
  s_waitcnt lgkmcnt(8)
  ds_read_b64_tr_b16 v[52:53], v193 offset:32768
  v_mfma_f32_16x16x32_bf16 v[160:163], v[64:67], a[24:27], v[160:163]
  ds_read_b64_tr_b16 v[54:55], v193 offset:33792
  s_waitcnt vmcnt(19)
  v_mfma_f32_16x16x32_bf16 v[168:171], v[64:67], a[28:31], v[168:171]
  s_waitcnt lgkmcnt(8)
  buffer_load_dwordx4 a[64:67], v211, s[52:55], s17 offen offset:0 sc1
  v_mfma_f32_16x16x32_bf16 v[164:167], v[68:71], a[24:27], v[164:167]
  ds_read_b64_tr_b16 v[64:65], v192 offset:40960
  ds_read_b64_tr_b16 v[66:67], v192 offset:41984
  v_mfma_f32_16x16x32_bf16 v[172:175], v[68:71], a[28:31], v[172:175]
  ds_read_b64_tr_b16 v[68:69], v193 offset:40960
  ds_read_b64_tr_b16 v[70:71], v193 offset:41984
  v_mfma_f32_16x16x32_bf16 v[32:35], v[56:59], a[16:19], v[32:35]
  s_waitcnt vmcnt(11)
  v_sub_f32 v184, 1.0, v184
  v_mfma_f32_16x16x32_bf16 v[40:43], v[56:59], a[20:23], v[40:43]
  ds_read_b64_tr_b16 v[56:57], v194 offset:32768
  ds_read_b64_tr_b16 v[58:59], v194 offset:33792
  v_mfma_f32_16x16x32_bf16 v[36:39], v[60:63], a[16:19], v[36:39]
  v_mul_f32 v160, v160, v184
  v_mul_f32 v161, v161, v184
  v_mfma_f32_16x16x32_bf16 v[44:47], v[60:63], a[20:23], v[44:47]
  s_waitcnt lgkmcnt(8)
  buffer_load_dwordx4 a[68:71], v211, s[52:55], s17 offen offset:1024 sc1
  v_mfma_f32_16x16x32_bf16 v[32:35], v[72:75], a[24:27], v[32:35]
  ds_read_b64_tr_b16 v[60:61], v195 offset:32768
  ds_read_b64_tr_b16 v[62:63], v195 offset:33792
  v_mfma_f32_16x16x32_bf16 v[40:43], v[72:75], a[28:31], v[40:43]
  ds_read_b64_tr_b16 v[72:73], v194 offset:40960
  ds_read_b64_tr_b16 v[74:75], v194 offset:41984
  v_mfma_f32_16x16x32_bf16 v[36:39], v[76:79], a[24:27], v[36:39]
  v_mul_f32 v162, v162, v184
  v_mul_f32 v163, v163, v184
  v_mfma_f32_16x16x32_bf16 v[44:47], v[76:79], a[28:31], v[44:47]
  s_mov_b32 s100, 15958016
  buffer_load_dwordx2 v[250:251], v245, s[52:55], s100 offen sc1
  s_waitcnt vmcnt(11)
  v_mfma_f32_16x16x32_bf16 v[160:163], v[48:51], a[32:35], v[160:163]
  buffer_load_dwordx4 a[72:75], v211, s[52:55], s17 offen offset:2048 sc1
  ds_read_b64_tr_b16 v[76:77], v195 offset:40960
  ds_read_b64_tr_b16 v[78:79], v195 offset:41984
  v_mul_f32 v164, v164, v184
  v_mul_f32 v165, v165, v184
  v_mul_f32 v166, v166, v184
  v_mul_f32 v167, v167, v184
  v_mul_f32 v32, v32, v184
  v_mul_f32 v33, v33, v184
  v_mul_f32 v34, v34, v184
  v_mul_f32 v35, v35, v184
  v_mul_f32 v36, v36, v184
  v_mul_f32 v37, v37, v184
  v_mul_f32 v38, v38, v184
  v_mul_f32 v39, v39, v184
  v_sub_f32 v254, 1.0, v254
  v_mul_f32 v168, v168, v254
  v_mul_f32 v169, v169, v254
  v_mul_f32 v170, v170, v254
  v_mul_f32 v171, v171, v254
  v_mul_f32 v172, v172, v254
  v_mul_f32 v173, v173, v254
  s_waitcnt vmcnt(10)
  v_mfma_f32_16x16x32_bf16 v[168:171], v[48:51], a[36:39], v[168:171]
  s_waitcnt lgkmcnt(2)
  buffer_load_dwordx4 a[76:79], v211, s[52:55], s17 offen offset:3072 sc1
  v_mfma_f32_16x16x32_bf16 v[164:167], v[52:55], a[32:35], v[164:167]
  s_add_u32 s17, s9, 12288
  ds_read_b64_tr_b16 v[48:49], v192 offset:57344
  ds_read_b64_tr_b16 v[50:51], v192 offset:58368
  v_mul_f32 v174, v174, v254
  v_mul_f32 v175, v175, v254
  v_mul_f32 v40, v40, v254
  v_mul_f32 v41, v41, v254
  v_mfma_f32_16x16x32_bf16 v[172:175], v[52:55], a[36:39], v[172:175]
  ds_read_b64_tr_b16 v[52:53], v193 offset:57344
  s_waitcnt vmcnt(10)
  v_mfma_f32_16x16x32_bf16 v[160:163], v[64:67], a[40:43], v[160:163]
  ds_read_b64_tr_b16 v[54:55], v193 offset:58368
  v_mul_f32 v42, v42, v254
  v_mul_f32 v43, v43, v254
  v_mul_f32 v44, v44, v254
  v_mul_f32 v45, v45, v254
  v_mul_f32 v46, v46, v254
  v_mul_f32 v47, v47, v254
  s_waitcnt vmcnt(9)
  v_mfma_f32_16x16x32_bf16 v[168:171], v[64:67], a[44:47], v[168:171]
  buffer_load_dwordx4 a[80:83], v211, s[52:55], s17 offen offset:0 sc1
  ds_read_b64_tr_b16 v[64:65], v196 offset:0
  v_mfma_f32_16x16x32_bf16 v[164:167], v[68:71], a[40:43], v[164:167]
  ds_read_b64_tr_b16 v[66:67], v196 offset:1024
  v_mfma_f32_16x16x32_bf16 v[172:175], v[68:71], a[44:47], v[172:175]
  ds_read_b64_tr_b16 v[68:69], v197 offset:0
  ds_read_b64_tr_b16 v[70:71], v197 offset:1024
  v_mfma_f32_16x16x32_bf16 v[32:35], v[56:59], a[32:35], v[32:35]
  v_mfma_f32_16x16x32_bf16 v[40:43], v[56:59], a[36:39], v[40:43]
  ds_read_b64_tr_b16 v[56:57], v194 offset:57344
  ds_read_b64_tr_b16 v[58:59], v194 offset:58368
  v_mfma_f32_16x16x32_bf16 v[36:39], v[60:63], a[32:35], v[36:39]
  buffer_load_dwordx4 a[84:87], v211, s[52:55], s17 offen offset:1024 sc1
  v_mfma_f32_16x16x32_bf16 v[44:47], v[60:63], a[36:39], v[44:47]
  ds_read_b64_tr_b16 v[60:61], v195 offset:57344
  ds_read_b64_tr_b16 v[62:63], v195 offset:58368
  v_mfma_f32_16x16x32_bf16 v[32:35], v[72:75], a[40:43], v[32:35]
  v_mfma_f32_16x16x32_bf16 v[40:43], v[72:75], a[44:47], v[40:43]
  s_waitcnt lgkmcnt(8)
  ds_read_b64_tr_b16 v[72:73], v198 offset:0
  v_mfma_f32_16x16x32_bf16 v[36:39], v[76:79], a[40:43], v[36:39]
  ds_read_b64_tr_b16 v[74:75], v198 offset:1024
  v_mfma_f32_16x16x32_bf16 v[44:47], v[76:79], a[44:47], v[44:47]
  s_barrier
  s_waitcnt vmcnt(10)
  v_mfma_f32_16x16x32_bf16 v[160:163], v[48:51], a[48:51], v[160:163]
  buffer_load_dwordx4 a[88:91], v211, s[52:55], s17 offen offset:2048 sc1
  s_waitcnt vmcnt(10)
  v_mfma_f32_16x16x32_bf16 v[168:171], v[48:51], a[52:55], v[168:171]
  ds_read_b64_tr_b16 v[76:77], v199 offset:0
  ds_read_b64_tr_b16 v[78:79], v199 offset:1024
  v_mfma_f32_16x16x32_bf16 v[164:167], v[52:55], a[48:51], v[164:167]
  ds_read_b64_tr_b16 v[48:49], v196 offset:8192
  ds_read_b64_tr_b16 v[50:51], v196 offset:9216
  v_mfma_f32_16x16x32_bf16 v[172:175], v[52:55], a[52:55], v[172:175]
  s_waitcnt lgkmcnt(8)
  ds_read_b64_tr_b16 v[52:53], v197 offset:8192
  v_mfma_f32_16x16x32_bf16 v[32:35], v[56:59], a[48:51], v[32:35]
  ds_read_b64_tr_b16 v[54:55], v197 offset:9216
  v_mfma_f32_16x16x32_bf16 v[40:43], v[56:59], a[52:55], v[40:43]
  s_waitcnt lgkmcnt(8)
  buffer_load_dwordx4 a[92:95], v211, s[52:55], s17 offen offset:3072 sc1
  v_mfma_f32_16x16x32_bf16 v[36:39], v[60:63], a[48:51], v[36:39]
  ds_read_b64_tr_b16 v[56:57], v198 offset:8192
  ds_read_b64_tr_b16 v[58:59], v198 offset:9216
  v_mfma_f32_16x16x32_bf16 v[44:47], v[60:63], a[52:55], v[44:47]
  ds_read_b64_tr_b16 v[60:61], v199 offset:8192
  s_waitcnt vmcnt(10)
  v_mfma_f32_16x16x32_bf16 v[160:163], v[64:67], a[56:59], v[160:163]
  ds_read_b64_tr_b16 v[62:63], v199 offset:9216
  s_waitcnt vmcnt(9)
  v_mfma_f32_16x16x32_bf16 v[168:171], v[64:67], a[60:63], v[168:171]
  ds_read_b64_tr_b16 v[64:65], v196 offset:16384
  ds_read_b64_tr_b16 v[66:67], v196 offset:17408
  v_mfma_f32_16x16x32_bf16 v[164:167], v[68:71], a[56:59], v[164:167]
  v_mfma_f32_16x16x32_bf16 v[172:175], v[68:71], a[60:63], v[172:175]
  s_waitcnt lgkmcnt(10)
  ds_read_b64_tr_b16 v[68:69], v197 offset:16384
  v_mfma_f32_16x16x32_bf16 v[32:35], v[72:75], a[56:59], v[32:35]
  ds_read_b64_tr_b16 v[70:71], v197 offset:17408
  v_mfma_f32_16x16x32_bf16 v[40:43], v[72:75], a[60:63], v[40:43]
  ds_read_b64_tr_b16 v[72:73], v198 offset:16384
  ds_read_b64_tr_b16 v[74:75], v198 offset:17408
  v_mfma_f32_16x16x32_bf16 v[36:39], v[76:79], a[56:59], v[36:39]
  v_mfma_f32_16x16x32_bf16 v[44:47], v[76:79], a[60:63], v[44:47]
  s_waitcnt lgkmcnt(10)
  s_waitcnt vmcnt(8)
  v_mfma_f32_16x16x32_bf16 v[160:163], v[48:51], a[64:67], v[160:163]
  ds_read_b64_tr_b16 v[76:77], v199 offset:16384
  ds_read_b64_tr_b16 v[78:79], v199 offset:17408
  s_waitcnt vmcnt(6)
  v_cmp_ne_u64 vcc, v[250:251], v[216:217]
L_pg6:
  s_cbranch_execz L_walked
  s_nop 0
  s_cbranch_vccnz L_slow_p
L_back_p:
  buffer_load_dwordx4 v[80:83], v211, s[52:55], s64 offen offset:0 sc1
  buffer_load_dwordx4 v[84:87], v211, s[52:55], s64 offen offset:1024 sc1
  v_mfma_f32_16x16x32_bf16 v[168:171], v[48:51], a[68:71], v[168:171]
  ds_read_b64_tr_b16 v[48:49], v236 offset:32768
  ds_read_b64_tr_b16 v[50:51], v236 offset:33792
  v_mfma_f32_16x16x32_bf16 v[164:167], v[52:55], a[64:67], v[164:167]
  v_mfma_f32_16x16x32_bf16 v[172:175], v[52:55], a[68:71], v[172:175]
  s_waitcnt lgkmcnt(4)
  ds_read_b64_tr_b16 v[52:53], v237 offset:32768
  v_mfma_f32_16x16x32_bf16 v[32:35], v[56:59], a[64:67], v[32:35]
  ds_read_b64_tr_b16 v[54:55], v237 offset:33792
  v_mfma_f32_16x16x32_bf16 v[40:43], v[56:59], a[68:71], v[40:43]
  ds_read_b64_tr_b16 v[56:57], v208 offset:32768
  ds_read_b64_tr_b16 v[58:59], v208 offset:33792
  v_mfma_f32_16x16x32_bf16 v[36:39], v[60:63], a[64:67], v[36:39]
  v_mfma_f32_16x16x32_bf16 v[44:47], v[60:63], a[68:71], v[44:47]
  ds_read_b64_tr_b16 v[60:61], v209 offset:32768
  s_waitcnt vmcnt(7)
  v_mfma_f32_16x16x32_bf16 v[160:163], v[64:67], a[72:75], v[160:163]
  ds_read_b64_tr_b16 v[62:63], v209 offset:33792
  s_waitcnt vmcnt(6)
  v_mfma_f32_16x16x32_bf16 v[168:171], v[64:67], a[76:79], v[168:171]
  ds_read_b64_tr_b16 v[64:65], v192 offset:8192
  ds_read_b64_tr_b16 v[66:67], v192 offset:9216
  v_mfma_f32_16x16x32_bf16 v[164:167], v[68:71], a[72:75], v[164:167]
  v_mfma_f32_16x16x32_bf16 v[172:175], v[68:71], a[76:79], v[172:175]
  ds_read_b64_tr_b16 v[68:69], v193 offset:8192
  ds_read_b64_tr_b16 v[70:71], v193 offset:9216
  v_mfma_f32_16x16x32_bf16 v[32:35], v[72:75], a[72:75], v[32:35]
  v_mfma_f32_16x16x32_bf16 v[40:43], v[72:75], a[76:79], v[40:43]
  s_waitcnt lgkmcnt(5)
  ds_read_b64_tr_b16 v[72:73], v194 offset:8192
  v_mfma_f32_16x16x32_bf16 v[36:39], v[76:79], a[72:75], v[36:39]
  ds_read_b64_tr_b16 v[74:75], v194 offset:9216
  v_mfma_f32_16x16x32_bf16 v[44:47], v[76:79], a[76:79], v[44:47]
  ds_read_b64_tr_b16 v[76:77], v195 offset:8192
  ds_read_b64_tr_b16 v[78:79], v195 offset:9216
  s_waitcnt vmcnt(5)
  v_mfma_f32_16x16x32_bf16 v[32:35], v[56:59], a[80:83], v[32:35]
  s_waitcnt vmcnt(4)
  v_mfma_f32_16x16x32_bf16 v[40:43], v[56:59], a[84:87], v[40:43]
  s_waitcnt lgkmcnt(4)
  v_mfma_f32_16x16x32_bf16 v[36:39], v[60:63], a[80:83], v[36:39]
  v_mfma_f32_16x16x32_bf16 v[44:47], v[60:63], a[84:87], v[44:47]
  s_waitcnt lgkmcnt(2)
  s_waitcnt vmcnt(3)
  v_mfma_f32_16x16x32_bf16 v[32:35], v[72:75], a[88:91], v[32:35]
  s_waitcnt vmcnt(2)
  v_mfma_f32_16x16x32_bf16 v[40:43], v[72:75], a[92:95], v[40:43]
  s_waitcnt lgkmcnt(0)
  v_mfma_f32_16x16x32_bf16 v[36:39], v[76:79], a[88:91], v[36:39]
  v_mfma_f32_16x16x32_bf16 v[44:47], v[76:79], a[92:95], v[44:47]
  v_mfma_f32_16x16x32_bf16 v[160:163], v[48:51], a[80:83], v[160:163]
  v_mfma_f32_16x16x32_bf16 v[168:171], v[48:51], a[84:87], v[168:171]
  v_mfma_f32_16x16x32_bf16 v[164:167], v[52:55], a[80:83], v[164:167]
  ds_write_b128 v242, v[32:35] offset:0
  s_nop 2
  ds_write_b128 v242, v[36:39] offset:1024
  ds_write_b128 v242, v[40:43] offset:2048
  ds_write_b128 v242, v[44:47] offset:3072
  v_mfma_f32_16x16x32_bf16 v[172:175], v[52:55], a[84:87], v[172:175]
  v_mfma_f32_16x16x32_bf16 v[160:163], v[64:67], a[88:91], v[160:163]
  v_mfma_f32_16x16x32_bf16 v[168:171], v[64:67], a[92:95], v[168:171]
  v_mfma_f32_16x16x32_bf16 v[164:167], v[68:71], a[88:91], v[164:167]
  v_mfma_f32_16x16x32_bf16 v[172:175], v[68:71], a[92:95], v[172:175]
  s_waitcnt lgkmcnt(0)
  s_barrier
  ds_read_b128 v[0:3], v243 offset:0
  ds_read_b128 v[4:7], v243 offset:1024
  ds_read_b128 v[8:11], v243 offset:2048
  ds_read_b128 v[12:15], v243 offset:3072
  s_waitcnt vmcnt(1)
  v_lshlrev_b32 v16, 16, v80
  v_and_b32 v17, 0xffff0000, v80
  v_lshlrev_b32 v20, 16, v82
  v_and_b32 v21, 0xffff0000, v82
  v_lshlrev_b32 v18, 16, v81
  v_and_b32 v19, 0xffff0000, v81
  v_lshlrev_b32 v22, 16, v83
  v_and_b32 v23, 0xffff0000, v83
  v_pk_fma_f32 v[160:161], v[16:17], v[184:185], v[160:161] op_sel_hi:[1,0,1]
  v_pk_fma_f32 v[164:165], v[20:21], v[184:185], v[164:165] op_sel_hi:[1,0,1]
  s_waitcnt vmcnt(0)
  v_lshlrev_b32 v24, 16, v84
  v_and_b32 v25, 0xffff0000, v84
  v_lshlrev_b32 v26, 16, v85
  v_and_b32 v27, 0xffff0000, v85
  v_lshlrev_b32 v28, 16, v86
  v_and_b32 v29, 0xffff0000, v86
  v_lshlrev_b32 v30, 16, v87
  v_and_b32 v31, 0xffff0000, v87
  v_pk_fma_f32 v[162:163], v[18:19], v[184:185], v[162:163] op_sel_hi:[1,0,1]
  v_pk_fma_f32 v[166:167], v[22:23], v[184:185], v[166:167] op_sel_hi:[1,0,1]
  v_pk_fma_f32 v[168:169], v[24:25], v[254:255], v[168:169] op_sel_hi:[1,0,1]
  v_pk_fma_f32 v[170:171], v[26:27], v[254:255], v[170:171] op_sel_hi:[1,0,1]
  s_waitcnt lgkmcnt(3)
  v_pk_add_f32 v[160:161], v[160:161], v[0:1]
  s_waitcnt lgkmcnt(2)
  v_pk_add_f32 v[164:165], v[164:165], v[4:5]
  v_pk_fma_f32 v[172:173], v[28:29], v[254:255], v[172:173] op_sel_hi:[1,0,1]
  v_pk_fma_f32 v[174:175], v[30:31], v[254:255], v[174:175] op_sel_hi:[1,0,1]
  v_pk_add_f32 v[162:163], v[162:163], v[2:3]
  v_pk_add_f32 v[166:167], v[166:167], v[6:7]
  v_cvt_pk_bf16_f32 v160, v160, v161
  v_cvt_pk_bf16_f32 v164, v164, v165
  s_waitcnt lgkmcnt(0)
  v_pk_add_f32 v[168:169], v[168:169], v[8:9]
  v_pk_add_f32 v[170:171], v[170:171], v[10:11]
  v_pk_add_f32 v[172:173], v[172:173], v[12:13]
  v_pk_add_f32 v[174:175], v[174:175], v[14:15]
  v_cvt_pk_bf16_f32 v161, v162, v163
  v_cvt_pk_bf16_f32 v165, v166, v167
  v_cvt_pk_bf16_f32 v162, v168, v169
  v_cvt_pk_bf16_f32 v163, v170, v171
  v_cvt_pk_bf16_f32 v166, v172, v173
  v_cvt_pk_bf16_f32 v167, v174, v175
  v_permlane16_swap_b32 v160, v162
  v_permlane16_swap_b32 v161, v163
  v_permlane16_swap_b32 v164, v166
  v_permlane16_swap_b32 v165, v167
  buffer_store_dwordx4 v[160:163], v241, s[96:99], s24 offen offset:0
  buffer_store_dwordx4 v[164:167], v241, s[96:99], s24 offen offset:32
L_end:
  s_endpgm
L_mainB:
  s_waitcnt vmcnt(6)
  s_barrier
  ds_read_b128 a[0:3], v204 offset:0
  ds_read_b64_tr_b16 v[160:161], v206 offset:0
  ds_read_b64_tr_b16 v[162:163], v206 offset:512
  ds_read_b128 a[4:7], v204 offset:2048
  ds_read_b128 a[8:11], v204 offset:4096
  ds_read_b128 a[12:15], v204 offset:6144
  ds_read_b64_tr_b16 v[164:165], v207 offset:0
  ds_read_b64_tr_b16 v[166:167], v207 offset:512
  ds_read_b64_tr_b16 v[168:169], v206 offset:8192
  ds_read_b64_tr_b16 v[170:171], v206 offset:8704
  ds_read_b64_tr_b16 v[172:173], v207 offset:8192
  ds_read_b64_tr_b16 v[174:175], v207 offset:8704
  s_add_u32 m0, s60, 49152
  s_xor_b32 s62, s58, 2
  s_lshr_b32 s100, s27, 1
  s_lshl_b32 s100, s100, 2
  s_and_b32 s101, s3, 3
  s_add_u32 s73, s100, s101
  s_lshr_b32 s100, s3, 2
  s_lshl_b32 s75, s100, 7
  s_and_b32 s72, s27, 1
  s_lshl_b32 s100, s73, 1
  s_add_u32 s74, s100, s72
  s_add_u32 s88, s16, s75
  s_addc_u32 s89, s17, 0
  s_add_u32 s92, s8, s75
  s_addc_u32 s93, s9, 0
  s_sub_u32 s90, 1835008, s75
  s_sub_u32 s94, 524288, s75
  s_waitcnt lgkmcnt(9)
  v_mfma_f32_16x16x32_bf16 v[0:3], v[160:163], a[0:3], 0
  s_waitcnt lgkmcnt(8)
  s_lshl_b32 s100, s74, 16
  v_mfma_f32_16x16x32_bf16 v[8:11], v[160:163], a[4:7], 0
  s_waitcnt lgkmcnt(7)
  buffer_load_dwordx4 v200, s[36:39], s64 offen offset:0 lds
  v_mfma_f32_16x16x32_bf16 v[16:19], v[160:163], a[8:11], 0
  s_waitcnt lgkmcnt(6)
  s_add_u32 m0, s60, 57344
  v_mfma_f32_16x16x32_bf16 v[24:27], v[160:163], a[12:15], 0
  s_waitcnt lgkmcnt(4)
  s_xor_b32 s79, s74, 1
  v_mfma_f32_16x16x32_bf16 v[4:7], v[164:167], a[0:3], 0
  buffer_load_dwordx4 v200, s[40:43], s64 offen offset:0 lds
  s_add_u32 m0, s11, 40960
  v_mfma_f32_16x16x32_bf16 v[12:15], v[164:167], a[4:7], 0
  s_add_u32 s75, s100, s75
  s_lshl_b32 s100, s79, 1
  v_mfma_f32_16x16x32_bf16 v[20:23], v[164:167], a[8:11], 0
  buffer_load_dwordx4 v198, s[28:31], s63 offen offset:0 lds
  s_sub_u32 s98, 2097152, s75
  v_mfma_f32_16x16x32_bf16 v[28:31], v[164:167], a[12:15], 0
  s_waitcnt lgkmcnt(0)
  ds_read_b64_tr_b16 v[176:177], v206 offset:16384
  v_mfma_f32_16x16x32_bf16 v[32:35], a[0:3], v[168:171], 0
  ds_read_b64_tr_b16 v[178:179], v206 offset:16896
  s_add_u32 s100, s100, s77
  v_mfma_f32_16x16x32_bf16 v[40:43], a[4:7], v[168:171], 0
  buffer_load_dwordx4 v199, s[28:31], s63 offen offset:1024 lds
  s_add_u32 m0, s10, 40960
  v_mfma_f32_16x16x32_bf16 v[48:51], a[8:11], v[168:171], 0
  ds_read_b64_tr_b16 v[180:181], v207 offset:16384
  ds_read_b64_tr_b16 v[182:183], v207 offset:16896
  v_mfma_f32_16x16x32_bf16 v[56:59], a[12:15], v[168:171], 0
  buffer_load_dwordx4 v201, s[32:35], s64 offen offset:0 lds
  s_add_u32 m0, s10, 49152
  v_mfma_f32_16x16x32_bf16 v[36:39], a[0:3], v[172:175], 0
  s_lshl_b32 s63, s62, 7
  ds_read_b128 a[16:19], v205 offset:0
  v_mfma_f32_16x16x32_bf16 v[44:47], a[4:7], v[172:175], 0
  ds_read_b64_tr_b16 v[184:185], v206 offset:4096
  s_mul_i32 s101, s77, 196608
  v_mfma_f32_16x16x32_bf16 v[52:55], a[8:11], v[172:175], 0
  buffer_load_dwordx4 v201, s[36:39], s64 offen offset:0 lds
  s_add_u32 m0, s10, 57344
  v_mfma_f32_16x16x32_bf16 v[60:63], a[12:15], v[172:175], 0
  s_waitcnt lgkmcnt(4)
  ds_read_b64_tr_b16 v[186:187], v206 offset:4608
  v_mfma_f32_16x16x32_bf16 v[64:67], a[0:3], v[176:179], 0
  ds_read_b128 a[20:23], v205 offset:2048
  s_mov_b32 s25, s78
  v_mfma_f32_16x16x32_bf16 v[72:75], a[4:7], v[176:179], 0
  buffer_load_dwordx4 v201, s[40:43], s64 offen offset:0 lds
  s_add_u32 m0, s59, 81920
  v_mfma_f32_16x16x32_bf16 v[80:83], a[8:11], v[176:179], 0
  s_mul_i32 s64, s62, 196608
  ds_read_b128 a[24:27], v205 offset:4096
  v_mfma_f32_16x16x32_bf16 v[88:91], a[12:15], v[176:179], 0
  s_waitcnt lgkmcnt(5)
  buffer_load_dwordx4 v196, s[28:31], s63 offen offset:0 lds
  v_mfma_f32_16x16x32_bf16 v[68:71], a[0:3], v[180:183], 0
  ds_read_b128 a[28:31], v205 offset:6144
  s_xor_b32 s62, s58, 3
  v_mfma_f32_16x16x32_bf16 v[76:79], a[4:7], v[180:183], 0
  ds_read_b64_tr_b16 v[188:189], v207 offset:4096
  v_and_b32 v131, 8, v213
  v_mfma_f32_16x16x32_bf16 v[84:87], a[8:11], v[180:183], 0
  buffer_load_dwordx4 v197, s[28:31], s63 offen offset:1024 lds
  s_add_u32 m0, s60, 81920
  v_mfma_f32_16x16x32_bf16 v[92:95], a[12:15], v[180:183], 0
  s_waitcnt lgkmcnt(4)
  ds_read_b64_tr_b16 v[190:191], v207 offset:4608
  v_mfma_f32_16x16x32_bf16 v[0:3], v[184:187], a[16:19], v[0:3]
  s_waitcnt lgkmcnt(4)
  ds_read_b64_tr_b16 v[160:161], v206 offset:12288
  v_mfma_f32_16x16x32_bf16 v[8:11], v[184:187], a[20:23], v[8:11]
  buffer_load_dwordx4 v200, s[32:35], s64 offen offset:0 lds
  s_waitcnt lgkmcnt(4)
  v_mfma_f32_16x16x32_bf16 v[16:19], v[184:187], a[24:27], v[16:19]
  s_add_u32 m0, s60, 90112
  ds_read_b64_tr_b16 v[162:163], v206 offset:12800
  ds_read_b64_tr_b16 v[164:165], v207 offset:12288
  s_waitcnt lgkmcnt(5)
  v_mfma_f32_16x16x32_bf16 v[24:27], v[184:187], a[28:31], v[24:27]
  buffer_load_dwordx4 v200, s[36:39], s64 offen offset:0 lds
  s_add_u32 m0, s60, 98304
  ds_read_b64_tr_b16 v[166:167], v207 offset:12800
  ds_read_b64_tr_b16 v[168:169], v206 offset:20480
  s_add_u32 s96, s20, s75
  s_addc_u32 s97, s21, 0
  ds_read_b64_tr_b16 v[170:171], v206 offset:20992
  s_mul_i32 s75, s100, 147456
  s_sub_u32 s100, s74, s79
  s_mul_i32 s21, s100, 294912
  s_waitcnt lgkmcnt(6)
  v_mfma_f32_16x16x32_bf16 v[4:7], v[188:191], a[16:19], v[4:7]
  ds_read_b64_tr_b16 v[172:173], v207 offset:20480
  ds_read_b64_tr_b16 v[174:175], v207 offset:20992
  v_mfma_f32_16x16x32_bf16 v[12:15], v[188:191], a[20:23], v[12:15]
  s_mul_i32 s100, s72, 24576
  s_add_u32 s73, s100, 65536
  v_mfma_f32_16x16x32_bf16 v[20:23], v[188:191], a[24:27], v[20:23]
  buffer_load_dwordx4 v200, s[40:43], s64 offen offset:0 lds
  s_add_u32 m0, s11, 81920
  v_mfma_f32_16x16x32_bf16 v[28:31], v[188:191], a[28:31], v[28:31]
  s_waitcnt lgkmcnt(6)
  s_mul_i32 s100, s76, 12288
  v_mfma_f32_16x16x32_bf16 v[32:35], a[16:19], v[160:163], v[32:35]
  buffer_load_dwordx4 v198, s[28:31], s63 offen offset:0 lds
  s_add_u32 s75, s75, 6291456
  v_mfma_f32_16x16x32_bf16 v[40:43], a[20:23], v[160:163], v[40:43]
  s_add_u32 s100, s100, s73
  s_add_u32 s18, s100, s75
  v_mfma_f32_16x16x32_bf16 v[48:51], a[24:27], v[160:163], v[48:51]
  s_lshl_b32 s100, s73, 4
  s_add_u32 s100, s100, s101
  v_mfma_f32_16x16x32_bf16 v[56:59], a[28:31], v[160:163], v[56:59]
  s_waitcnt lgkmcnt(3)
  buffer_load_dwordx4 v199, s[28:31], s63 offen offset:1024 lds
  v_mfma_f32_16x16x32_bf16 v[36:39], a[16:19], v[164:167], v[36:39]
  s_waitcnt vmcnt(7) lgkmcnt(0)
  s_barrier
  v_mfma_f32_16x16x32_bf16 v[44:47], a[20:23], v[164:167], v[44:47]
  s_add_u32 m0, s10, 81920
  ds_read_b128 a[32:35], v204 offset:40960
  v_mfma_f32_16x16x32_bf16 v[52:55], a[24:27], v[164:167], v[52:55]
  buffer_load_dwordx4 v201, s[32:35], s64 offen offset:0 lds
  s_add_u32 m0, s10, 90112
  v_mfma_f32_16x16x32_bf16 v[60:63], a[28:31], v[164:167], v[60:63]
  ds_read_b64_tr_b16 v[176:177], v206 offset:40960
  ds_read_b64_tr_b16 v[178:179], v206 offset:41472
  v_mfma_f32_16x16x32_bf16 v[64:67], a[16:19], v[168:171], v[64:67]
  buffer_load_dwordx4 v201, s[36:39], s64 offen offset:0 lds
  s_add_u32 m0, s10, 98304
  v_mfma_f32_16x16x32_bf16 v[72:75], a[20:23], v[168:171], v[72:75]
  s_lshl_b32 s63, s62, 7
  ds_read_b128 a[36:39], v204 offset:43008
  v_mfma_f32_16x16x32_bf16 v[80:83], a[24:27], v[168:171], v[80:83]
  ds_read_b128 a[40:43], v204 offset:45056
  s_lshl_b32 s101, s76, 15
  v_mfma_f32_16x16x32_bf16 v[88:91], a[28:31], v[168:171], v[88:91]
  buffer_load_dwordx4 v201, s[40:43], s64 offen offset:0 lds
  s_add_u32 m0, s59, 122880
  v_mfma_f32_16x16x32_bf16 v[68:71], a[16:19], v[172:175], v[68:71]
  ds_read_b128 a[44:47], v204 offset:47104
  s_mul_i32 s64, s62, 196608
  v_mfma_f32_16x16x32_bf16 v[76:79], a[20:23], v[172:175], v[76:79]
  buffer_load_dwordx4 v196, s[28:31], s63 offen offset:0 lds
  s_xor_b32 s62, s58, 4
  v_mfma_f32_16x16x32_bf16 v[84:87], a[24:27], v[172:175], v[84:87]
  ds_read_b64_tr_b16 v[180:181], v207 offset:40960
  v_add_u32 v204, 0x14000, v204
  v_mfma_f32_16x16x32_bf16 v[92:95], a[28:31], v[172:175], v[92:95]
  s_waitcnt lgkmcnt(4)
  ds_read_b64_tr_b16 v[182:183], v207 offset:41472
  v_mfma_f32_16x16x32_bf16 v[0:3], v[176:179], a[32:35], v[0:3]
  buffer_load_dwordx4 v197, s[28:31], s63 offen offset:1024 lds
  s_waitcnt lgkmcnt(4)
  v_mfma_f32_16x16x32_bf16 v[8:11], v[176:179], a[36:39], v[8:11]
  s_waitcnt lgkmcnt(3)
  s_add_u32 m0, s60, 122880
  v_mfma_f32_16x16x32_bf16 v[16:19], v[176:179], a[40:43], v[16:19]
  ds_read_b64_tr_b16 v[184:185], v206 offset:49152
  ds_read_b64_tr_b16 v[186:187], v206 offset:49664
  s_add_u32 s14, s100, s101
  s_waitcnt lgkmcnt(4)
  v_mfma_f32_16x16x32_bf16 v[24:27], v[176:179], a[44:47], v[24:27]
  buffer_load_dwordx4 v200, s[32:35], s64 offen offset:0 lds
  s_add_u32 m0, s60, 131072
  ds_read_b64_tr_b16 v[188:189], v207 offset:49152
  ds_read_b64_tr_b16 v[190:191], v207 offset:49664
  s_add_u32 s16, s14, 0
  ds_read_b64_tr_b16 v[160:161], v206 offset:57344
  s_lshl_b32 s100, s77, 18
  s_add_u32 s27, s100, s101
  s_lshl_b32 s73, s72, 15
  ds_read_b64_tr_b16 v[162:163], v206 offset:57856
  s_waitcnt lgkmcnt(6)
  v_mfma_f32_16x16x32_bf16 v[4:7], v[180:183], a[32:35], v[4:7]
  ds_read_b64_tr_b16 v[164:165], v207 offset:57344
  s_lshl_b32 s100, s76, 14
  v_mfma_f32_16x16x32_bf16 v[12:15], v[180:183], a[36:39], v[12:15]
  buffer_load_dwordx4 v200, s[36:39], s64 offen offset:0 lds
  s_add_u32 m0, s60, 139264
  v_mfma_f32_16x16x32_bf16 v[20:23], v[180:183], a[40:43], v[20:23]
  ds_read_b64_tr_b16 v[166:167], v207 offset:57856
  ds_read_b128 a[48:51], v205 offset:40960
  v_mfma_f32_16x16x32_bf16 v[28:31], v[180:183], a[44:47], v[28:31]
  s_waitcnt lgkmcnt(7)
  s_add_u32 s101, s100, s73
  v_mfma_f32_16x16x32_bf16 v[32:35], a[32:35], v[184:187], v[32:35]
  buffer_load_dwordx4 v200, s[40:43], s64 offen offset:0 lds
  s_add_u32 m0, s11, 122880
  v_mfma_f32_16x16x32_bf16 v[40:43], a[36:39], v[184:187], v[40:43]
  ds_read_b64_tr_b16 v[168:169], v206 offset:45056
  ds_read_b64_tr_b16 v[170:171], v206 offset:45568
  v_mfma_f32_16x16x32_bf16 v[48:51], a[40:43], v[184:187], v[48:51]
  buffer_load_dwordx4 v198, s[28:31], s63 offen offset:0 lds
  ds_read_b128 a[52:55], v205 offset:43008
  v_mfma_f32_16x16x32_bf16 v[56:59], a[44:47], v[184:187], v[56:59]
  s_waitcnt lgkmcnt(8)
  s_add_u32 s100, s100, 114688
  v_mfma_f32_16x16x32_bf16 v[36:39], a[32:35], v[188:191], v[36:39]
  ds_read_b128 a[56:59], v205 offset:45056
  s_add_u32 s100, s100, s75
  v_mfma_f32_16x16x32_bf16 v[44:47], a[36:39], v[188:191], v[44:47]
  buffer_load_dwordx4 v199, s[28:31], s63 offen offset:1024 lds
  s_add_u32 m0, s10, 122880
  v_mfma_f32_16x16x32_bf16 v[52:55], a[40:43], v[188:191], v[52:55]
  s_lshl_b32 s63, s62, 7
  ds_read_b128 a[60:63], v205 offset:47104
  v_mfma_f32_16x16x32_bf16 v[60:63], a[44:47], v[188:191], v[60:63]
  s_waitcnt lgkmcnt(7)
  v_add_u32 v205, 0x14000, v205
  v_mfma_f32_16x16x32_bf16 v[64:67], a[32:35], v[160:163], v[64:67]
  buffer_load_dwordx4 v201, s[32:35], s64 offen offset:0 lds
  s_add_u32 m0, s10, 131072
  v_mfma_f32_16x16x32_bf16 v[72:75], a[36:39], v[160:163], v[72:75]
  ds_read_b64_tr_b16 v[172:173], v207 offset:45056
  ds_read_b64_tr_b16 v[174:175], v207 offset:45568
  v_mfma_f32_16x16x32_bf16 v[80:83], a[40:43], v[160:163], v[80:83]
  buffer_load_dwordx4 v201, s[36:39], s64 offen offset:0 lds
  s_add_u32 m0, s10, 139264
  v_mfma_f32_16x16x32_bf16 v[88:91], a[44:47], v[160:163], v[88:91]
  s_waitcnt lgkmcnt(5)
  ds_read_b64_tr_b16 v[176:177], v206 offset:53248
  v_mfma_f32_16x16x32_bf16 v[68:71], a[32:35], v[164:167], v[68:71]
  ds_read_b64_tr_b16 v[178:179], v206 offset:53760
  ds_read_b64_tr_b16 v[180:181], v207 offset:53248
  v_mfma_f32_16x16x32_bf16 v[76:79], a[36:39], v[164:167], v[76:79]
  buffer_load_dwordx4 v201, s[40:43], s64 offen offset:0 lds
  s_add_u32 m0, s59, 0
  v_mfma_f32_16x16x32_bf16 v[84:87], a[40:43], v[164:167], v[84:87]
  s_mul_i32 s64, s62, 196608
  ds_read_b64_tr_b16 v[182:183], v207 offset:53760
  v_mfma_f32_16x16x32_bf16 v[92:95], a[44:47], v[164:167], v[92:95]
  buffer_load_dwordx4 v196, s[28:31], s63 offen offset:0 lds
  ds_read_b64_tr_b16 v[184:185], v206 offset:61440
  v_mfma_f32_16x16x32_bf16 v[0:3], v[168:171], a[48:51], v[0:3]
  s_waitcnt lgkmcnt(7)
  ds_read_b64_tr_b16 v[186:187], v206 offset:61952
  v_mfma_f32_16x16x32_bf16 v[8:11], v[168:171], a[52:55], v[8:11]
  ds_read_b64_tr_b16 v[188:189], v207 offset:61440
  ds_read_b64_tr_b16 v[190:191], v207 offset:61952
  v_mfma_f32_16x16x32_bf16 v[16:19], v[168:171], a[56:59], v[16:19]
  buffer_load_dwordx4 v197, s[28:31], s63 offen offset:1024 lds
  s_add_u32 m0, s60, 0
  v_mfma_f32_16x16x32_bf16 v[24:27], v[168:171], a[60:63], v[24:27]
  s_waitcnt lgkmcnt(8)
  v_add_u32 v206, 0x14000, v206
  v_mfma_f32_16x16x32_bf16 v[4:7], v[172:175], a[48:51], v[4:7]
  buffer_load_dwordx4 v200, s[32:35], s64 offen offset:0 lds
  s_add_u32 m0, s60, 8192
  v_mfma_f32_16x16x32_bf16 v[12:15], v[172:175], a[52:55], v[12:15]
  v_add_u32 v207, 0x14000, v207
  s_xor_b32 s62, s58, 5
  v_mfma_f32_16x16x32_bf16 v[20:23], v[172:175], a[56:59], v[20:23]
  s_add_u32 s9, s100, s21
  s_lshl_b32 s100, s73, 4
  v_mfma_f32_16x16x32_bf16 v[28:31], v[172:175], a[60:63], v[28:31]
  s_waitcnt lgkmcnt(5)
  buffer_load_dwordx4 v200, s[36:39], s64 offen offset:0 lds
  v_mfma_f32_16x16x32_bf16 v[32:35], a[48:51], v[176:179], v[32:35]
  s_add_u32 m0, s60, 16384
  buffer_load_dword v102, v99, s[44:47], 0 offen
  v_mfma_f32_16x16x32_bf16 v[40:43], a[52:55], v[176:179], v[40:43]
  s_waitcnt vmcnt(15) lgkmcnt(0)
  s_barrier
  v_mfma_f32_16x16x32_bf16 v[48:51], a[56:59], v[176:179], v[48:51]
  ds_read_b128 a[64:67], v204 offset:0
  buffer_load_dword v103, v99, s[48:51], 0 offen
  v_mfma_f32_16x16x32_bf16 v[56:59], a[60:63], v[176:179], v[56:59]
  ds_read_b64_tr_b16 v[160:161], v206 offset:0
  s_add_u32 s15, s27, s100
  v_mfma_f32_16x16x32_bf16 v[36:39], a[48:51], v[180:183], v[36:39]
  buffer_load_dwordx4 v200, s[40:43], s64 offen offset:0 lds
  s_add_u32 m0, s11, 0
  v_mfma_f32_16x16x32_bf16 v[44:47], a[52:55], v[180:183], v[44:47]
  ds_read_b64_tr_b16 v[162:163], v206 offset:512
  ds_read_b128 a[68:71], v204 offset:2048
  v_mfma_f32_16x16x32_bf16 v[52:55], a[56:59], v[180:183], v[52:55]
  s_lshl_b32 s100, s74, 1
  s_add_u32 s78, s100, s77
  v_mfma_f32_16x16x32_bf16 v[60:63], a[60:63], v[180:183], v[60:63]
  ds_read_b128 a[72:75], v204 offset:4096
  s_lshl_b32 s100, s78, 7
  v_mfma_f32_16x16x32_bf16 v[64:67], a[48:51], v[184:187], v[64:67]
  buffer_load_dwordx4 v198, s[28:31], s63 offen offset:0 lds
  s_add_u32 s19, s101, s75
  v_mfma_f32_16x16x32_bf16 v[72:75], a[52:55], v[184:187], v[72:75]
  ds_read_b128 a[76:79], v204 offset:6144
  s_add_u32 s20, s100, 15728640
  v_mfma_f32_16x16x32_bf16 v[80:83], a[56:59], v[184:187], v[80:83]
  s_lshl_b32 s100, s77, 15
  s_lshl_b32 s101, s76, 6
  v_mfma_f32_16x16x32_bf16 v[88:91], a[60:63], v[184:187], v[88:91]
  ds_read_b64_tr_b16 v[164:165], v207 offset:0
  s_add_u32 s24, s100, s101
  v_mfma_f32_16x16x32_bf16 v[68:71], a[48:51], v[188:191], v[68:71]
  ds_read_b64_tr_b16 v[166:167], v207 offset:512
  s_mul_i32 s100, s76, 40960
  v_mfma_f32_16x16x32_bf16 v[76:79], a[52:55], v[188:191], v[76:79]
  buffer_load_dwordx4 v199, s[28:31], s63 offen offset:1024 lds
  s_add_u32 m0, s10, 0
  v_mfma_f32_16x16x32_bf16 v[84:87], a[56:59], v[188:191], v[84:87]
  ds_read_b64_tr_b16 v[168:169], v206 offset:8192
  ds_read_b64_tr_b16 v[170:171], v206 offset:8704
  v_mfma_f32_16x16x32_bf16 v[92:95], a[60:63], v[188:191], v[92:95]
  s_waitcnt lgkmcnt(6)
  ds_read_b64_tr_b16 v[172:173], v207 offset:8192
  v_mfma_f32_16x16x32_bf16 v[0:3], v[160:163], a[64:67], v[0:3]
  ds_read_b64_tr_b16 v[174:175], v207 offset:8704
  s_lshl_b32 s63, s62, 7
  v_mfma_f32_16x16x32_bf16 v[8:11], v[160:163], a[68:71], v[8:11]
  s_waitcnt lgkmcnt(7)
  ds_read_b64_tr_b16 v[176:177], v206 offset:16384
  v_mfma_f32_16x16x32_bf16 v[16:19], v[160:163], a[72:75], v[16:19]
  s_waitcnt lgkmcnt(7)
  buffer_load_dwordx4 v201, s[32:35], s64 offen offset:0 lds
  v_mfma_f32_16x16x32_bf16 v[24:27], v[160:163], a[76:79], v[24:27]
  s_waitcnt lgkmcnt(5)
  s_add_u32 m0, s10, 8192
  v_mfma_f32_16x16x32_bf16 v[4:7], v[164:167], a[64:67], v[4:7]
  ds_read_b64_tr_b16 v[178:179], v206 offset:16896
  ds_read_b64_tr_b16 v[180:181], v207 offset:16384
  v_mfma_f32_16x16x32_bf16 v[12:15], v[164:167], a[68:71], v[12:15]
  ds_read_b64_tr_b16 v[182:183], v207 offset:16896
  s_lshl_b32 s101, s77, 12
  v_mfma_f32_16x16x32_bf16 v[20:23], v[164:167], a[72:75], v[20:23]
  ds_read_b128 a[80:83], v205 offset:0
  s_add_u32 s100, s100, s101
  v_mfma_f32_16x16x32_bf16 v[28:31], v[164:167], a[76:79], v[28:31]
  s_waitcnt lgkmcnt(7)
  buffer_load_dwordx4 v201, s[36:39], s64 offen offset:0 lds
  v_mfma_f32_16x16x32_bf16 v[32:35], a[64:67], v[168:171], v[32:35]
  s_add_u32 m0, s10, 16384
  ds_read_b64_tr_b16 v[184:185], v206 offset:4096
  v_mfma_f32_16x16x32_bf16 v[40:43], a[68:71], v[168:171], v[40:43]
  ds_read_b64_tr_b16 v[186:187], v206 offset:4608
  s_add_u32 s8, s100, 32768
  v_mfma_f32_16x16x32_bf16 v[48:51], a[72:75], v[168:171], v[48:51]
  ds_read_b128 a[84:87], v205 offset:2048
  s_lshl_b32 s100, s2, 2
  v_mfma_f32_16x16x32_bf16 v[56:59], a[76:79], v[168:171], v[56:59]
  s_waitcnt lgkmcnt(7)
  s_add_u32 s78, s100, s26
  v_mfma_f32_16x16x32_bf16 v[36:39], a[64:67], v[172:175], v[36:39]
  buffer_load_dwordx4 v201, s[40:43], s64 offen offset:0 lds
  s_add_u32 m0, s59, 40960
  v_mfma_f32_16x16x32_bf16 v[44:47], a[68:71], v[172:175], v[44:47]
  ds_read_b128 a[88:91], v205 offset:4096
  s_mul_i32 s64, s62, 196608
  v_mfma_f32_16x16x32_bf16 v[52:55], a[72:75], v[172:175], v[52:55]
  ds_read_b128 a[92:95], v205 offset:6144
  s_xor_b32 s62, s58, 6
  v_mfma_f32_16x16x32_bf16 v[60:63], a[76:79], v[172:175], v[60:63]
  s_waitcnt lgkmcnt(6)
  s_lshl_b32 s100, s78, 12
  v_mfma_f32_16x16x32_bf16 v[64:67], a[64:67], v[176:179], v[64:67]
  buffer_load_dwordx4 v196, s[28:31], s63 offen offset:0 lds
  ds_read_b64_tr_b16 v[188:189], v207 offset:4096
  v_mfma_f32_16x16x32_bf16 v[72:75], a[68:71], v[176:179], v[72:75]
  ds_read_b64_tr_b16 v[190:191], v207 offset:4608
  s_add_u32 s56, s100, 16777216
  v_mfma_f32_16x16x32_bf16 v[80:83], a[72:75], v[176:179], v[80:83]
  ds_read_b64_tr_b16 v[160:161], v206 offset:12288
  s_and_b32 s100, s74, 30
  v_mfma_f32_16x16x32_bf16 v[88:91], a[76:79], v[176:179], v[88:91]
  ds_read_b64_tr_b16 v[162:163], v206 offset:12800
  s_lshl_b32 s100, s100, 5
  v_mfma_f32_16x16x32_bf16 v[68:71], a[64:67], v[180:183], v[68:71]
  ds_read_b64_tr_b16 v[164:165], v207 offset:12288
  s_lshl_b32 s101, s72, 4
  v_mfma_f32_16x16x32_bf16 v[76:79], a[68:71], v[180:183], v[76:79]
  buffer_load_dwordx4 v197, s[28:31], s63 offen offset:1024 lds
  s_add_u32 m0, s60, 40960
  v_mfma_f32_16x16x32_bf16 v[84:87], a[72:75], v[180:183], v[84:87]
  ds_read_b64_tr_b16 v[166:167], v207 offset:12800
  ds_read_b64_tr_b16 v[168:169], v206 offset:20480
  v_mfma_f32_16x16x32_bf16 v[92:95], a[76:79], v[180:183], v[92:95]
  s_waitcnt lgkmcnt(8)
  ds_read_b64_tr_b16 v[170:171], v206 offset:20992
  v_mfma_f32_16x16x32_bf16 v[0:3], v[184:187], a[80:83], v[0:3]
  ds_read_b64_tr_b16 v[172:173], v207 offset:20480
  s_add_u32 s100, s100, s101
  v_mfma_f32_16x16x32_bf16 v[8:11], v[184:187], a[84:87], v[8:11]
  ds_read_b64_tr_b16 v[174:175], v207 offset:20992
  s_lshl_b32 s101, s76, 3
  v_mfma_f32_16x16x32_bf16 v[16:19], v[184:187], a[88:91], v[16:19]
  s_waitcnt lgkmcnt(9)
  buffer_load_dwordx4 v200, s[32:35], s64 offen offset:0 lds
  v_mfma_f32_16x16x32_bf16 v[24:27], v[184:187], a[92:95], v[24:27]
  s_waitcnt lgkmcnt(8)
  s_add_u32 m0, s60, 49152
  v_mfma_f32_16x16x32_bf16 v[4:7], v[188:191], a[80:83], v[4:7]
  s_add_u32 s100, s100, s101
  v_lshl_add_u32 v131, v131, 2, s100
  v_mfma_f32_16x16x32_bf16 v[12:15], v[188:191], a[84:87], v[12:15]
  v_and_b32 v127, 7, v213
  v_add_u32 v126, v127, v131
  v_mfma_f32_16x16x32_bf16 v[20:23], v[188:191], a[88:91], v[20:23]
  v_lshlrev_b32 v247, 5, v126
  v_min_u32 v127, 5, v127
  v_mfma_f32_16x16x32_bf16 v[28:31], v[188:191], a[92:95], v[28:31]
  s_waitcnt lgkmcnt(5)
  buffer_load_dwordx4 v200, s[36:39], s64 offen offset:0 lds
  v_mfma_f32_16x16x32_bf16 v[32:35], a[80:83], v[160:163], v[32:35]
  s_add_u32 m0, s60, 57344
  v_add_u32 v126, v127, v131
  v_mfma_f32_16x16x32_bf16 v[40:43], a[84:87], v[160:163], v[40:43]
  s_waitcnt vmcnt(16) lgkmcnt(0)
  s_barrier
  v_mfma_f32_16x16x32_bf16 v[48:51], a[88:91], v[160:163], v[48:51]
  ds_read_b128 a[96:99], v204 offset:40960
  s_lshl_b32 s100, s74, 5
  v_mfma_f32_16x16x32_bf16 v[56:59], a[92:95], v[160:163], v[56:59]
  ds_read_b64_tr_b16 v[176:177], v206 offset:40960
  v_add_u32 v127, s100, v129
  v_mfma_f32_16x16x32_bf16 v[36:39], a[80:83], v[164:167], v[36:39]
  buffer_load_dwordx4 v200, s[40:43], s64 offen offset:0 lds
  s_add_u32 m0, s11, 40960
  v_mfma_f32_16x16x32_bf16 v[44:47], a[84:87], v[164:167], v[44:47]
  ds_read_b64_tr_b16 v[178:179], v206 offset:41472
  ds_read_b128 a[100:103], v204 offset:43008
  v_mfma_f32_16x16x32_bf16 v[52:55], a[88:91], v[164:167], v[52:55]
  s_lshl_b32 s101, s76, 4
  v_lshlrev_b32 v249, 5, v126
  v_mfma_f32_16x16x32_bf16 v[60:63], a[92:95], v[164:167], v[60:63]
  ds_read_b128 a[104:107], v204 offset:45056
  s_add_u32 s100, s100, s101
  v_mfma_f32_16x16x32_bf16 v[64:67], a[80:83], v[168:171], v[64:67]
  buffer_load_dwordx4 v198, s[28:31], s63 offen offset:0 lds
  v_and_b32 v126, 15, v213
  v_mfma_f32_16x16x32_bf16 v[72:75], a[84:87], v[168:171], v[72:75]
  ds_read_b128 a[108:111], v204 offset:47104
L_pg7:
  s_cbranch_execz L_walked
  v_add_u32 v204, 0xfffec000, v204
  v_mfma_f32_16x16x32_bf16 v[80:83], a[88:91], v[168:171], v[80:83]
  s_add_u32 s100, s100, 4096
  v_add_u32 v126, s100, v126
  v_mfma_f32_16x16x32_bf16 v[88:91], a[92:95], v[168:171], v[88:91]
  ds_read_b64_tr_b16 v[180:181], v207 offset:40960
  v_lshrrev_b32 v131, 5, v218
  v_mfma_f32_16x16x32_bf16 v[68:71], a[80:83], v[172:175], v[68:71]
  ds_read_b64_tr_b16 v[182:183], v207 offset:41472
  s_xor_b32 s100, s78, 4
  v_mfma_f32_16x16x32_bf16 v[76:79], a[84:87], v[172:175], v[76:79]
  buffer_load_dwordx4 v199, s[28:31], s63 offen offset:1024 lds
  s_add_u32 m0, s10, 40960
  v_mfma_f32_16x16x32_bf16 v[84:87], a[88:91], v[172:175], v[84:87]
  ds_read_b64_tr_b16 v[184:185], v206 offset:49152
  ds_read_b64_tr_b16 v[186:187], v206 offset:49664
  v_mfma_f32_16x16x32_bf16 v[92:95], a[92:95], v[172:175], v[92:95]
  s_waitcnt lgkmcnt(6)
  ds_read_b64_tr_b16 v[188:189], v207 offset:49152
  v_mfma_f32_16x16x32_bf16 v[0:3], v[176:179], a[96:99], v[0:3]
  ds_read_b64_tr_b16 v[190:191], v207 offset:49664
  s_lshl_b32 s63, s62, 7
  v_mfma_f32_16x16x32_bf16 v[8:11], v[176:179], a[100:103], v[8:11]
  s_waitcnt lgkmcnt(7)
  ds_read_b64_tr_b16 v[160:161], v206 offset:57344
  v_mfma_f32_16x16x32_bf16 v[16:19], v[176:179], a[104:107], v[16:19]
  s_waitcnt lgkmcnt(7)
  buffer_load_dwordx4 v201, s[32:35], s64 offen offset:0 lds
  v_mfma_f32_16x16x32_bf16 v[24:27], v[176:179], a[108:111], v[24:27]
  s_waitcnt lgkmcnt(5)
  s_add_u32 m0, s10, 49152
  v_mfma_f32_16x16x32_bf16 v[4:7], v[180:183], a[96:99], v[4:7]
  ds_read_b64_tr_b16 v[162:163], v206 offset:57856
  ds_read_b64_tr_b16 v[164:165], v207 offset:57344
  v_mfma_f32_16x16x32_bf16 v[12:15], v[180:183], a[100:103], v[12:15]
  ds_read_b64_tr_b16 v[166:167], v207 offset:57856
  v_lshl_add_u32 v242, s26, 12, v211
  v_mfma_f32_16x16x32_bf16 v[20:23], v[180:183], a[104:107], v[20:23]
  ds_read_b128 a[112:115], v205 offset:40960
  v_lshl_add_u32 v241, v129, 10, v131
  v_mfma_f32_16x16x32_bf16 v[28:31], v[180:183], a[108:111], v[28:31]
  s_waitcnt lgkmcnt(7)
  buffer_load_dwordx4 v201, s[36:39], s64 offen offset:0 lds
  v_mfma_f32_16x16x32_bf16 v[32:35], a[96:99], v[184:187], v[32:35]
  s_add_u32 m0, s10, 57344
  ds_read_b64_tr_b16 v[168:169], v206 offset:45056
  v_mfma_f32_16x16x32_bf16 v[40:43], a[100:103], v[184:187], v[40:43]
  ds_read_b64_tr_b16 v[170:171], v206 offset:45568
  s_lshl_b32 s100, s100, 5
  v_mfma_f32_16x16x32_bf16 v[48:51], a[104:107], v[184:187], v[48:51]
  ds_read_b128 a[116:119], v205 offset:43008
  v_xor_b32 v243, 8192, v242
  v_mfma_f32_16x16x32_bf16 v[56:59], a[108:111], v[184:187], v[56:59]
  s_waitcnt lgkmcnt(7)
  v_cmp_gt_u32 vcc, 32, v213
  s_nop 1
  v_cndmask_b32 v126, v127, v126, vcc
  v_mfma_f32_16x16x32_bf16 v[36:39], a[96:99], v[188:191], v[36:39]
  buffer_load_dwordx4 v201, s[40:43], s64 offen offset:0 lds
  s_add_u32 m0, s59, 81920
  v_mfma_f32_16x16x32_bf16 v[44:47], a[100:103], v[188:191], v[44:47]
  ds_read_b128 a[120:123], v205 offset:45056
  s_mul_i32 s64, s62, 196608
  v_mfma_f32_16x16x32_bf16 v[52:55], a[104:107], v[188:191], v[52:55]
  ds_read_b128 a[124:127], v205 offset:47104
  s_xor_b32 s62, s58, 7
  v_mfma_f32_16x16x32_bf16 v[60:63], a[108:111], v[188:191], v[60:63]
  s_waitcnt lgkmcnt(5)
  v_add_u32 v205, 0xfffec000, v205
  v_mfma_f32_16x16x32_bf16 v[64:67], a[96:99], v[160:163], v[64:67]
  buffer_load_dwordx4 v196, s[28:31], s63 offen offset:0 lds
  ds_read_b64_tr_b16 v[172:173], v207 offset:45056
  v_mfma_f32_16x16x32_bf16 v[72:75], a[100:103], v[160:163], v[72:75]
  ds_read_b64_tr_b16 v[174:175], v207 offset:45568
  v_lshlrev_b32 v248, 5, v126
  v_mfma_f32_16x16x32_bf16 v[80:83], a[104:107], v[160:163], v[80:83]
  ds_read_b64_tr_b16 v[176:177], v206 offset:53248
  v_lshlrev_b32 v146, 16, v142
  v_mfma_f32_16x16x32_bf16 v[88:91], a[108:111], v[160:163], v[88:91]
  ds_read_b64_tr_b16 v[178:179], v206 offset:53760
  v_lshlrev_b32 v154, 16, v134
  v_mfma_f32_16x16x32_bf16 v[68:71], a[96:99], v[164:167], v[68:71]
  ds_read_b64_tr_b16 v[180:181], v207 offset:53248
  v_and_b32 v147, 0xffff0000, v142
  v_mfma_f32_16x16x32_bf16 v[76:79], a[100:103], v[164:167], v[76:79]
  buffer_load_dwordx4 v197, s[28:31], s63 offen offset:1024 lds
  s_add_u32 m0, s60, 81920
  v_mfma_f32_16x16x32_bf16 v[84:87], a[104:107], v[164:167], v[84:87]
  ds_read_b64_tr_b16 v[182:183], v207 offset:53760
  ds_read_b64_tr_b16 v[184:185], v206 offset:61440
  v_mfma_f32_16x16x32_bf16 v[92:95], a[108:111], v[164:167], v[92:95]
  s_waitcnt lgkmcnt(8)
  ds_read_b64_tr_b16 v[186:187], v206 offset:61952
  v_mfma_f32_16x16x32_bf16 v[0:3], v[168:171], a[112:115], v[0:3]
  ds_read_b64_tr_b16 v[188:189], v207 offset:61440
  v_add_u32 v206, 0xfffec000, v206
  v_mfma_f32_16x16x32_bf16 v[8:11], v[168:171], a[116:119], v[8:11]
  ds_read_b64_tr_b16 v[190:191], v207 offset:61952
  v_add_u32 v207, 0xfffec000, v207
  v_mfma_f32_16x16x32_bf16 v[16:19], v[168:171], a[120:123], v[16:19]
  s_waitcnt lgkmcnt(9)
  buffer_load_dwordx4 v200, s[32:35], s64 offen offset:0 lds
  v_mfma_f32_16x16x32_bf16 v[24:27], v[168:171], a[124:127], v[24:27]
  s_waitcnt lgkmcnt(8)
  s_add_u32 m0, s60, 90112
  v_mfma_f32_16x16x32_bf16 v[4:7], v[172:175], a[112:115], v[4:7]
  v_and_b32 v155, 0xffff0000, v134
  v_mul_f32 v158, v154, v146
  v_mfma_f32_16x16x32_bf16 v[12:15], v[172:175], a[116:119], v[12:15]
  v_lshlrev_b32 v148, 16, v143
  v_fmac_f32 v158, v155, v147
  v_mfma_f32_16x16x32_bf16 v[20:23], v[172:175], a[120:123], v[20:23]
  v_lshlrev_b32 v154, 16, v135
  v_and_b32 v149, 0xffff0000, v143
  v_mfma_f32_16x16x32_bf16 v[28:31], v[172:175], a[124:127], v[28:31]
  s_waitcnt lgkmcnt(5)
  buffer_load_dwordx4 v200, s[36:39], s64 offen offset:0 lds
  v_mfma_f32_16x16x32_bf16 v[32:35], a[112:115], v[176:179], v[32:35]
  s_add_u32 m0, s60, 98304
  v_and_b32 v155, 0xffff0000, v135
  v_mfma_f32_16x16x32_bf16 v[40:43], a[116:119], v[176:179], v[40:43]
  s_waitcnt vmcnt(14) lgkmcnt(0)
  s_barrier
  v_mfma_f32_16x16x32_bf16 v[48:51], a[120:123], v[176:179], v[48:51]
  ds_read_b128 a[128:131], v204 offset:0
  v_fmac_f32 v158, v154, v148
  v_mfma_f32_16x16x32_bf16 v[56:59], a[124:127], v[176:179], v[56:59]
  ds_read_b64_tr_b16 v[160:161], v206 offset:0
  v_lshlrev_b32 v150, 16, v144
  v_mfma_f32_16x16x32_bf16 v[36:39], a[112:115], v[180:183], v[36:39]
  buffer_load_dwordx4 v200, s[40:43], s64 offen offset:0 lds
  s_add_u32 m0, s11, 81920
  v_mfma_f32_16x16x32_bf16 v[44:47], a[116:119], v[180:183], v[44:47]
  ds_read_b64_tr_b16 v[162:163], v206 offset:512
  ds_read_b128 a[132:135], v204 offset:2048
  v_mfma_f32_16x16x32_bf16 v[52:55], a[120:123], v[180:183], v[52:55]
  v_fmac_f32 v158, v155, v149
  v_lshlrev_b32 v154, 16, v136
  v_mfma_f32_16x16x32_bf16 v[60:63], a[124:127], v[180:183], v[60:63]
  ds_read_b128 a[136:139], v204 offset:4096
  v_lshlrev_b32 v156, 16, v138
  v_mfma_f32_16x16x32_bf16 v[64:67], a[112:115], v[184:187], v[64:67]
  buffer_load_dwordx4 v198, s[28:31], s63 offen offset:0 lds
  v_and_b32 v151, 0xffff0000, v144
  v_mfma_f32_16x16x32_bf16 v[72:75], a[116:119], v[184:187], v[72:75]
  ds_read_b128 a[140:143], v204 offset:6144
  v_and_b32 v155, 0xffff0000, v136
  v_mfma_f32_16x16x32_bf16 v[80:83], a[120:123], v[184:187], v[80:83]
  v_fmac_f32 v158, v154, v150
  v_and_b32 v157, 0xffff0000, v138
  v_mfma_f32_16x16x32_bf16 v[88:91], a[124:127], v[184:187], v[88:91]
  ds_read_b64_tr_b16 v[164:165], v207 offset:0
  v_mul_f32 v159, v156, v146
  v_mfma_f32_16x16x32_bf16 v[68:71], a[112:115], v[188:191], v[68:71]
  ds_read_b64_tr_b16 v[166:167], v207 offset:512
  v_fmac_f32 v158, v155, v151
  v_mfma_f32_16x16x32_bf16 v[76:79], a[116:119], v[188:191], v[76:79]
  buffer_load_dwordx4 v199, s[28:31], s63 offen offset:1024 lds
  s_add_u32 m0, s10, 81920
  v_mfma_f32_16x16x32_bf16 v[84:87], a[120:123], v[188:191], v[84:87]
  ds_read_b64_tr_b16 v[168:169], v206 offset:8192
  ds_read_b64_tr_b16 v[170:171], v206 offset:8704
  v_mfma_f32_16x16x32_bf16 v[92:95], a[124:127], v[188:191], v[92:95]
  s_waitcnt lgkmcnt(6)
  ds_read_b64_tr_b16 v[172:173], v207 offset:8192
  v_mfma_f32_16x16x32_bf16 v[0:3], v[160:163], a[128:131], v[0:3]
  ds_read_b64_tr_b16 v[174:175], v207 offset:8704
  s_lshl_b32 s63, s62, 7
  v_mfma_f32_16x16x32_bf16 v[8:11], v[160:163], a[132:135], v[8:11]
  s_waitcnt lgkmcnt(7)
  ds_read_b64_tr_b16 v[176:177], v206 offset:16384
  v_mfma_f32_16x16x32_bf16 v[16:19], v[160:163], a[136:139], v[16:19]
  s_waitcnt lgkmcnt(7)
  buffer_load_dwordx4 v201, s[32:35], s64 offen offset:0 lds
  v_mfma_f32_16x16x32_bf16 v[24:27], v[160:163], a[140:143], v[24:27]
  s_waitcnt lgkmcnt(5)
  s_add_u32 m0, s10, 90112
  v_mfma_f32_16x16x32_bf16 v[4:7], v[164:167], a[128:131], v[4:7]
  ds_read_b64_tr_b16 v[178:179], v206 offset:16896
  ds_read_b64_tr_b16 v[180:181], v207 offset:16384
  v_mfma_f32_16x16x32_bf16 v[12:15], v[164:167], a[132:135], v[12:15]
  ds_read_b64_tr_b16 v[182:183], v207 offset:16896
  v_fmac_f32 v159, v157, v147
  v_mfma_f32_16x16x32_bf16 v[20:23], v[164:167], a[136:139], v[20:23]
  ds_read_b128 a[144:147], v205 offset:0
  v_lshlrev_b32 v154, 16, v137
  v_mfma_f32_16x16x32_bf16 v[28:31], v[164:167], a[140:143], v[28:31]
  s_waitcnt lgkmcnt(7)
  buffer_load_dwordx4 v201, s[36:39], s64 offen offset:0 lds
  v_mfma_f32_16x16x32_bf16 v[32:35], a[128:131], v[168:171], v[32:35]
  s_add_u32 m0, s10, 98304
  ds_read_b64_tr_b16 v[184:185], v206 offset:4096
  v_mfma_f32_16x16x32_bf16 v[40:43], a[132:135], v[168:171], v[40:43]
  ds_read_b64_tr_b16 v[186:187], v206 offset:4608
  global_load_dword v104, v100, s[4:5]
  v_mfma_f32_16x16x32_bf16 v[48:51], a[136:139], v[168:171], v[48:51]
  ds_read_b128 a[148:151], v205 offset:2048
  global_load_dword v105, v101, s[6:7]
  v_mfma_f32_16x16x32_bf16 v[56:59], a[140:143], v[168:171], v[56:59]
  s_waitcnt lgkmcnt(7)
  v_and_b32 v155, 0xffff0000, v137
  v_mfma_f32_16x16x32_bf16 v[36:39], a[128:131], v[172:175], v[36:39]
  buffer_load_dwordx4 v201, s[40:43], s64 offen offset:0 lds
  s_add_u32 m0, s59, 122880
  v_mfma_f32_16x16x32_bf16 v[44:47], a[132:135], v[172:175], v[44:47]
  ds_read_b128 a[152:155], v205 offset:4096
  s_mul_i32 s64, s62, 196608
  v_mfma_f32_16x16x32_bf16 v[52:55], a[136:139], v[172:175], v[52:55]
  ds_read_b128 a[156:159], v205 offset:6144
  s_xor_b32 s62, s58, 0
  v_mfma_f32_16x16x32_bf16 v[60:63], a[140:143], v[172:175], v[60:63]
  s_waitcnt lgkmcnt(6)
  s_mul_i32 s65, s62, 229376
  v_mfma_f32_16x16x32_bf16 v[64:67], a[128:131], v[176:179], v[64:67]
  buffer_load_dwordx4 v196, s[28:31], s63 offen offset:0 lds
  ds_read_b64_tr_b16 v[188:189], v207 offset:4096
  v_mfma_f32_16x16x32_bf16 v[72:75], a[132:135], v[176:179], v[72:75]
  ds_read_b64_tr_b16 v[190:191], v207 offset:4608
  s_xor_b32 s62, s58, 1
  v_mfma_f32_16x16x32_bf16 v[80:83], a[136:139], v[176:179], v[80:83]
  ds_read_b64_tr_b16 v[160:161], v206 offset:12288
  v_lshlrev_b32 v156, 16, v139
  v_mfma_f32_16x16x32_bf16 v[88:91], a[140:143], v[176:179], v[88:91]
  ds_read_b64_tr_b16 v[162:163], v206 offset:12800
  v_and_b32 v157, 0xffff0000, v139
  v_mfma_f32_16x16x32_bf16 v[68:71], a[128:131], v[180:183], v[68:71]
  ds_read_b64_tr_b16 v[164:165], v207 offset:12288
  v_fmac_f32 v159, v156, v148
  v_mfma_f32_16x16x32_bf16 v[76:79], a[132:135], v[180:183], v[76:79]
  buffer_load_dwordx4 v197, s[28:31], s63 offen offset:1024 lds
  s_add_u32 m0, s60, 122880
  v_mfma_f32_16x16x32_bf16 v[84:87], a[136:139], v[180:183], v[84:87]
  ds_read_b64_tr_b16 v[166:167], v207 offset:12800
  ds_read_b64_tr_b16 v[168:169], v206 offset:20480
  v_mfma_f32_16x16x32_bf16 v[92:95], a[140:143], v[180:183], v[92:95]
  s_waitcnt lgkmcnt(8)
  ds_read_b64_tr_b16 v[170:171], v206 offset:20992
  v_mfma_f32_16x16x32_bf16 v[0:3], v[184:187], a[144:147], v[0:3]
  ds_read_b64_tr_b16 v[172:173], v207 offset:20480
  v_lshlrev_b32 v152, 16, v145
  v_mfma_f32_16x16x32_bf16 v[8:11], v[184:187], a[148:151], v[8:11]
  ds_read_b64_tr_b16 v[174:175], v207 offset:20992
  v_and_b32 v153, 0xffff0000, v145
  v_mfma_f32_16x16x32_bf16 v[16:19], v[184:187], a[152:155], v[16:19]
  s_waitcnt lgkmcnt(9)
  buffer_load_dwordx4 v200, s[32:35], s64 offen offset:0 lds
  v_mfma_f32_16x16x32_bf16 v[24:27], v[184:187], a[156:159], v[24:27]
  s_waitcnt lgkmcnt(8)
  s_add_u32 m0, s60, 131072
  v_mfma_f32_16x16x32_bf16 v[4:7], v[188:191], a[144:147], v[4:7]
  v_fmac_f32 v159, v157, v149
  v_lshlrev_b32 v156, 16, v140
  v_mfma_f32_16x16x32_bf16 v[12:15], v[188:191], a[148:151], v[12:15]
  v_and_b32 v157, 0xffff0000, v140
  v_fmac_f32 v159, v156, v150
  v_mfma_f32_16x16x32_bf16 v[20:23], v[188:191], a[152:155], v[20:23]
  v_fmac_f32 v159, v157, v151
  v_lshlrev_b32 v156, 16, v141
  v_mfma_f32_16x16x32_bf16 v[28:31], v[188:191], a[156:159], v[28:31]
  s_waitcnt lgkmcnt(5)
  buffer_load_dwordx4 v200, s[36:39], s64 offen offset:0 lds
  v_mfma_f32_16x16x32_bf16 v[32:35], a[144:147], v[160:163], v[32:35]
  s_add_u32 m0, s60, 139264
  v_fmac_f32 v158, v154, v152
  v_mfma_f32_16x16x32_bf16 v[40:43], a[148:151], v[160:163], v[40:43]
  s_waitcnt vmcnt(16) lgkmcnt(0)
  s_barrier
  v_mfma_f32_16x16x32_bf16 v[48:51], a[152:155], v[160:163], v[48:51]
  ds_read_b128 a[160:163], v204 offset:40960
  v_and_b32 v157, 0xffff0000, v141
  v_mfma_f32_16x16x32_bf16 v[56:59], a[156:159], v[160:163], v[56:59]
  ds_read_b64_tr_b16 v[176:177], v206 offset:40960
  v_fmac_f32 v159, v156, v152
  v_mfma_f32_16x16x32_bf16 v[36:39], a[144:147], v[164:167], v[36:39]
  buffer_load_dwordx4 v200, s[40:43], s64 offen offset:0 lds
  ds_read_b64_tr_b16 v[178:179], v206 offset:41472
  v_mfma_f32_16x16x32_bf16 v[44:47], a[148:151], v[164:167], v[44:47]
  ds_read_b128 a[164:167], v204 offset:43008
  s_add_u32 m0, s11, 122880
  v_mfma_f32_16x16x32_bf16 v[52:55], a[152:155], v[164:167], v[52:55]
  v_fmac_f32 v158, v155, v153
  v_fmac_f32 v159, v157, v153
  v_mfma_f32_16x16x32_bf16 v[60:63], a[156:159], v[164:167], v[60:63]
  ds_read_b128 a[168:171], v204 offset:45056
  v_permlane32_swap_b32 v158, v159
  v_mfma_f32_16x16x32_bf16 v[64:67], a[144:147], v[168:171], v[64:67]
  buffer_load_dwordx4 v198, s[28:31], s63 offen offset:0 lds
  v_add_f32 v158, v158, v159
  v_mfma_f32_16x16x32_bf16 v[72:75], a[148:151], v[168:171], v[72:75]
  ds_read_b128 a[172:175], v204 offset:47104
  v_add_u32 v204, 0x14000, v204
  v_mfma_f32_16x16x32_bf16 v[80:83], a[152:155], v[168:171], v[80:83]
  v_add_f32_dpp v158, v158, v158 row_shr:1 row_mask:0xf bank_mask:0xf bound_ctrl:1
  s_add_u32 s4, s67, 0
  v_mfma_f32_16x16x32_bf16 v[88:91], a[156:159], v[168:171], v[88:91]
  ds_read_b64_tr_b16 v[180:181], v207 offset:40960
  v_add_f32_dpp v158, v158, v158 row_shr:2 row_mask:0xf bank_mask:0xf bound_ctrl:1
  v_mfma_f32_16x16x32_bf16 v[68:71], a[144:147], v[172:175], v[68:71]
  ds_read_b64_tr_b16 v[182:183], v207 offset:41472
  v_add_f32_dpp v158, v158, v158 row_shr:4 row_mask:0xf bank_mask:0xf bound_ctrl:1
  v_mfma_f32_16x16x32_bf16 v[76:79], a[148:151], v[172:175], v[76:79]
  ds_read_b64_tr_b16 v[184:185], v206 offset:49152
  buffer_load_dwordx4 v199, s[28:31], s63 offen offset:1024 lds
  v_mfma_f32_16x16x32_bf16 v[84:87], a[152:155], v[172:175], v[84:87]
  ds_read_b64_tr_b16 v[186:187], v206 offset:49664
  s_add_u32 m0, s10, 122880
  v_mfma_f32_16x16x32_bf16 v[92:95], a[156:159], v[172:175], v[92:95]
  s_waitcnt lgkmcnt(6)
  ds_read_b64_tr_b16 v[188:189], v207 offset:49152
  v_mfma_f32_16x16x32_bf16 v[0:3], v[176:179], a[160:163], v[0:3]
  ds_read_b64_tr_b16 v[190:191], v207 offset:49664
  v_add_f32_dpp v158, v158, v158 row_shr:8 row_mask:0xf bank_mask:0xf bound_ctrl:1
  v_mfma_f32_16x16x32_bf16 v[8:11], v[176:179], a[164:167], v[8:11]
  s_waitcnt lgkmcnt(7)
  ds_read_b64_tr_b16 v[160:161], v206 offset:57344
  v_mfma_f32_16x16x32_bf16 v[16:19], v[176:179], a[168:171], v[16:19]
  s_waitcnt lgkmcnt(7)
  ds_read_b64_tr_b16 v[162:163], v206 offset:57856
  v_mfma_f32_16x16x32_bf16 v[24:27], v[176:179], a[172:175], v[24:27]
  s_waitcnt lgkmcnt(6)
  ds_read_b64_tr_b16 v[164:165], v207 offset:57344
  v_mfma_f32_16x16x32_bf16 v[4:7], v[180:183], a[160:163], v[4:7]
  ds_read_b64_tr_b16 v[166:167], v207 offset:57856
  buffer_load_dwordx4 v201, s[32:35], s64 offen offset:0 lds
  v_mfma_f32_16x16x32_bf16 v[12:15], v[180:183], a[164:167], v[12:15]
  ds_read_b128 a[176:179], v205 offset:40960
  s_add_u32 m0, s10, 131072
  v_mfma_f32_16x16x32_bf16 v[20:23], v[180:183], a[168:171], v[20:23]
  v_add_f32_dpp v158, v158, v158 row_bcast:15 row_mask:0xa bank_mask:0xf
  v_mul_f32 v158, 0xbfb8aa3b, v158
  v_mfma_f32_16x16x32_bf16 v[28:31], v[180:183], a[172:175], v[28:31]
  s_waitcnt lgkmcnt(7)
  ds_read_b64_tr_b16 v[168:169], v206 offset:45056
  v_mfma_f32_16x16x32_bf16 v[32:35], a[160:163], v[184:187], v[32:35]
  ds_read_b64_tr_b16 v[170:171], v206 offset:45568
  buffer_load_dwordx4 v201, s[36:39], s64 offen offset:0 lds
  v_mfma_f32_16x16x32_bf16 v[40:43], a[164:167], v[184:187], v[40:43]
  ds_read_b128 a[180:183], v205 offset:43008
  s_add_u32 m0, s10, 139264
  v_mfma_f32_16x16x32_bf16 v[48:51], a[168:171], v[184:187], v[48:51]
  v_exp_f32 v158, v158
  v_mfma_f32_16x16x32_bf16 v[56:59], a[172:175], v[184:187], v[56:59]
  s_waitcnt lgkmcnt(7)
  ds_read_b128 a[184:187], v205 offset:45056
  v_mfma_f32_16x16x32_bf16 v[36:39], a[160:163], v[188:191], v[36:39]
  buffer_load_dwordx4 v201, s[40:43], s64 offen offset:0 lds
  s_add_u32 m0, s60, 0xffffc000
  v_mfma_f32_16x16x32_bf16 v[44:47], a[164:167], v[188:191], v[44:47]
  ds_read_b128 a[188:191], v205 offset:47104
  v_add_u32 v205, 0x14000, v205
  v_mfma_f32_16x16x32_bf16 v[52:55], a[168:171], v[188:191], v[52:55]
  v_add_f32 v158, 1.0, v158
  s_mov_b32 s91, 0x20000
  v_mfma_f32_16x16x32_bf16 v[60:63], a[172:175], v[188:191], v[60:63]
  s_waitcnt lgkmcnt(5)
  ds_read_b64_tr_b16 v[172:173], v207 offset:45056
  v_mfma_f32_16x16x32_bf16 v[64:67], a[160:163], v[160:163], v[64:67]
  ds_read_b64_tr_b16 v[174:175], v207 offset:45568
  buffer_load_dwordx4 v202, s[44:47], s65 offen lds
  v_mfma_f32_16x16x32_bf16 v[72:75], a[164:167], v[160:163], v[72:75]
  ds_read_b64_tr_b16 v[176:177], v206 offset:53248
  s_add_u32 m0, s60, 0xffffe000
  v_mfma_f32_16x16x32_bf16 v[80:83], a[168:171], v[160:163], v[80:83]
  ds_read_b64_tr_b16 v[178:179], v206 offset:53760
  v_add_u32 v233, 7168, v232
  v_mfma_f32_16x16x32_bf16 v[88:91], a[172:175], v[160:163], v[88:91]
  ds_read_b64_tr_b16 v[180:181], v207 offset:53248
  v_add_u32 v234, 14336, v232
  v_mfma_f32_16x16x32_bf16 v[68:71], a[160:163], v[164:167], v[68:71]
  ds_read_b64_tr_b16 v[182:183], v207 offset:53760
  v_add_u32 v235, 21504, v232
  v_mfma_f32_16x16x32_bf16 v[76:79], a[164:167], v[164:167], v[76:79]
  ds_read_b64_tr_b16 v[184:185], v206 offset:61440
  buffer_load_dwordx4 v202, s[48:51], s65 offen lds
  v_mfma_f32_16x16x32_bf16 v[84:87], a[168:171], v[164:167], v[84:87]
  ds_read_b64_tr_b16 v[186:187], v206 offset:61952
  v_add_u32 v206, 0x14000, v206
  v_mfma_f32_16x16x32_bf16 v[92:95], a[172:175], v[164:167], v[92:95]
  s_waitcnt lgkmcnt(8)
  ds_read_b64_tr_b16 v[188:189], v207 offset:61440
  v_mfma_f32_16x16x32_bf16 v[0:3], v[168:171], a[176:179], v[0:3]
  ds_read_b64_tr_b16 v[190:191], v207 offset:61952
  v_add_u32 v207, 0x14000, v207
  v_mfma_f32_16x16x32_bf16 v[8:11], v[168:171], a[180:183], v[8:11]
  s_add_u32 m0, s10, 0xffffc000
  s_add_u32 s5, s67, 65536
  v_mfma_f32_16x16x32_bf16 v[16:19], v[168:171], a[184:187], v[16:19]
  buffer_load_dwordx4 v203, s[44:47], s65 offen lds
  s_add_u32 m0, s10, 0xffffe000
  v_mfma_f32_16x16x32_bf16 v[24:27], v[168:171], a[188:191], v[24:27]
  s_waitcnt lgkmcnt(7)
  v_rcp_f32 v253, v158
  v_mfma_f32_16x16x32_bf16 v[4:7], v[172:175], a[176:179], v[4:7]
  s_mov_b32 s95, 0x20000
  s_mov_b32 s99, 0x20000
  v_mfma_f32_16x16x32_bf16 v[12:15], v[172:175], a[180:183], v[12:15]
  v_mov_b32 v245, s100
  v_xor_b32 v237, 32, v236
  v_mfma_f32_16x16x32_bf16 v[20:23], v[172:175], a[184:187], v[20:23]
  v_xor_b32 v208, 64, v236
  v_xor_b32 v209, 96, v236
  v_mfma_f32_16x16x32_bf16 v[28:31], v[172:175], a[188:191], v[28:31]
  s_waitcnt lgkmcnt(3)
  buffer_load_dwordx4 v203, s[48:51], s65 offen lds
  v_mfma_f32_16x16x32_bf16 v[32:35], a[176:179], v[176:179], v[32:35]
  s_waitcnt vmcnt(14) lgkmcnt(0)
  s_barrier
  v_mfma_f32_16x16x32_bf16 v[40:43], a[180:183], v[176:179], v[40:43]
  ds_read_b128 a[192:195], v204 offset:0
  s_add_u32 m0, s60, 0x0
  v_mfma_f32_16x16x32_bf16 v[48:51], a[184:187], v[176:179], v[48:51]
  ds_read_b64_tr_b16 v[160:161], v206 offset:0
  s_mul_i32 s65, s62, 229376
  v_mfma_f32_16x16x32_bf16 v[56:59], a[188:191], v[176:179], v[56:59]
  ds_read_b64_tr_b16 v[162:163], v206 offset:512
  s_xor_b32 s62, s58, 2
  v_mfma_f32_16x16x32_bf16 v[36:39], a[176:179], v[180:183], v[36:39]
  ds_read_b128 a[196:199], v204 offset:2048
  buffer_load_dwordx4 v202, s[44:47], s65 offen lds
  v_mfma_f32_16x16x32_bf16 v[44:47], a[180:183], v[180:183], v[44:47]
  s_add_u32 m0, s60, 0x2000
  v_add_u32 v240, 139264, v242
  v_mfma_f32_16x16x32_bf16 v[52:55], a[184:187], v[180:183], v[52:55]
  ds_read_b128 a[200:203], v204 offset:4096
  v_add_u32 v244, 139264, v243
  v_mfma_f32_16x16x32_bf16 v[60:63], a[188:191], v[180:183], v[60:63]
  s_add_u32 s6, s67, 1024
  s_add_u32 s7, s67, 66560
  v_mfma_f32_16x16x32_bf16 v[64:67], a[176:179], v[184:187], v[64:67]
  ds_read_b128 a[204:207], v204 offset:6144
  s_add_u32 s63, s68, 2048
  v_mfma_f32_16x16x32_bf16 v[72:75], a[180:183], v[184:187], v[72:75]
  buffer_load_dwordx4 v202, s[48:51], s65 offen lds
  s_add_u32 m0, s10, 0x0
  v_mfma_f32_16x16x32_bf16 v[80:83], a[184:187], v[184:187], v[80:83]
  ds_read_b64_tr_b16 v[164:165], v207 offset:0
  s_add_u32 s64, s68, 262144
  v_mfma_f32_16x16x32_bf16 v[88:91], a[188:191], v[184:187], v[88:91]
  ds_read_b64_tr_b16 v[166:167], v207 offset:512
  v_mov_b32 v250, 0
  v_mfma_f32_16x16x32_bf16 v[68:71], a[176:179], v[188:191], v[68:71]
  ds_read_b64_tr_b16 v[168:169], v206 offset:8192
  global_load_dwordx2 v[216:217], v250, s[22:23] sc1
  v_mfma_f32_16x16x32_bf16 v[76:79], a[180:183], v[188:191], v[76:79]
  ds_read_b64_tr_b16 v[170:171], v206 offset:8704
  buffer_load_dwordx4 v203, s[44:47], s65 offen lds
  v_mfma_f32_16x16x32_bf16 v[84:87], a[184:187], v[188:191], v[84:87]
  ds_read_b64_tr_b16 v[172:173], v207 offset:8192
  s_add_u32 m0, s10, 0x2000
  v_mfma_f32_16x16x32_bf16 v[92:95], a[188:191], v[188:191], v[92:95]
  s_waitcnt lgkmcnt(7)
  ds_read_b64_tr_b16 v[174:175], v207 offset:8704
  v_mfma_f32_16x16x32_bf16 v[0:3], v[160:163], a[192:195], v[0:3]
  ds_read_b64_tr_b16 v[176:177], v206 offset:16384
  s_lshl_b32 s59, s26, 12
  v_mfma_f32_16x16x32_bf16 v[8:11], v[160:163], a[196:199], v[8:11]
  s_waitcnt lgkmcnt(8)
  ds_read_b64_tr_b16 v[178:179], v206 offset:16896
  v_mfma_f32_16x16x32_bf16 v[16:19], v[160:163], a[200:203], v[16:19]
  s_waitcnt lgkmcnt(8)
  ds_read_b64_tr_b16 v[180:181], v207 offset:16384
  v_mfma_f32_16x16x32_bf16 v[24:27], v[160:163], a[204:207], v[24:27]
  s_waitcnt lgkmcnt(7)
  ds_read_b64_tr_b16 v[182:183], v207 offset:16896
  v_mfma_f32_16x16x32_bf16 v[4:7], v[164:167], a[192:195], v[4:7]
  ds_read_b128 a[208:211], v205 offset:0
  buffer_load_dwordx4 v203, s[48:51], s65 offen lds
  v_mfma_f32_16x16x32_bf16 v[12:15], v[164:167], a[196:199], v[12:15]
  s_add_u32 m0, s60, 0x6000
  s_mul_i32 s65, s62, 229376
  v_mfma_f32_16x16x32_bf16 v[20:23], v[164:167], a[200:203], v[20:23]
  ds_read_b64_tr_b16 v[184:185], v206 offset:4096
  s_xor_b32 s62, s58, 3
  v_mfma_f32_16x16x32_bf16 v[28:31], v[164:167], a[204:207], v[28:31]
  s_waitcnt lgkmcnt(8)
  ds_read_b64_tr_b16 v[186:187], v206 offset:4608
  v_mfma_f32_16x16x32_bf16 v[32:35], a[192:195], v[168:171], v[32:35]
  ds_read_b128 a[212:215], v205 offset:2048
  buffer_load_dwordx4 v202, s[44:47], s65 offen lds
  v_mfma_f32_16x16x32_bf16 v[40:43], a[196:199], v[168:171], v[40:43]
  s_add_u32 m0, s60, 0x8000
  v_mfma_f32_16x16x32_bf16 v[48:51], a[200:203], v[168:171], v[48:51]
  ds_read_b128 a[216:219], v205 offset:4096
  v_mfma_f32_16x16x32_bf16 v[56:59], a[204:207], v[168:171], v[56:59]
  s_waitcnt lgkmcnt(7)
  v_mfma_f32_16x16x32_bf16 v[36:39], a[192:195], v[172:175], v[36:39]
  ds_read_b128 a[220:223], v205 offset:6144
  buffer_load_dwordx4 v202, s[48:51], s65 offen lds
  v_mfma_f32_16x16x32_bf16 v[44:47], a[196:199], v[172:175], v[44:47]
  s_add_u32 m0, s10, 0x6000
  v_mfma_f32_16x16x32_bf16 v[52:55], a[200:203], v[172:175], v[52:55]
  ds_read_b64_tr_b16 v[188:189], v207 offset:4096
  v_mfma_f32_16x16x32_bf16 v[60:63], a[204:207], v[172:175], v[60:63]
  ds_read_b64_tr_b16 v[190:191], v207 offset:4608
  v_mfma_f32_16x16x32_bf16 v[64:67], a[192:195], v[176:179], v[64:67]
  ds_read_b64_tr_b16 v[160:161], v206 offset:12288
  v_mfma_f32_16x16x32_bf16 v[72:75], a[196:199], v[176:179], v[72:75]
  ds_read_b64_tr_b16 v[162:163], v206 offset:12800
  buffer_load_dwordx4 v203, s[44:47], s65 offen lds
  v_mfma_f32_16x16x32_bf16 v[80:83], a[200:203], v[176:179], v[80:83]
  ds_read_b64_tr_b16 v[164:165], v207 offset:12288
  s_add_u32 m0, s10, 0x8000
  v_mfma_f32_16x16x32_bf16 v[88:91], a[204:207], v[176:179], v[88:91]
  s_waitcnt lgkmcnt(7)
  ds_read_b64_tr_b16 v[166:167], v207 offset:12800
  v_mfma_f32_16x16x32_bf16 v[68:71], a[192:195], v[180:183], v[68:71]
  ds_read_b64_tr_b16 v[168:169], v206 offset:20480
  v_mfma_f32_16x16x32_bf16 v[76:79], a[196:199], v[180:183], v[76:79]
  ds_read_b64_tr_b16 v[170:171], v206 offset:20992
  buffer_load_dwordx4 v203, s[48:51], s65 offen lds
  v_mfma_f32_16x16x32_bf16 v[84:87], a[200:203], v[180:183], v[84:87]
  ds_read_b64_tr_b16 v[172:173], v207 offset:20480
  s_add_u32 m0, s60, 0xa000
  v_mfma_f32_16x16x32_bf16 v[92:95], a[204:207], v[180:183], v[92:95]
  ds_read_b64_tr_b16 v[174:175], v207 offset:20992
  s_mul_i32 s65, s62, 229376
  v_mfma_f32_16x16x32_bf16 v[0:3], v[184:187], a[208:211], v[0:3]
  s_xor_b32 s62, s58, 4
  v_mfma_f32_16x16x32_bf16 v[8:11], v[184:187], a[212:215], v[8:11]
  s_waitcnt lgkmcnt(8)
  v_mfma_f32_16x16x32_bf16 v[16:19], v[184:187], a[216:219], v[16:19]
  buffer_load_dwordx4 v202, s[44:47], s65 offen lds
  s_add_u32 m0, s60, 0xc000
  v_mfma_f32_16x16x32_bf16 v[24:27], v[184:187], a[220:223], v[24:27]
  v_mfma_f32_16x16x32_bf16 v[4:7], v[188:191], a[208:211], v[4:7]
  v_mfma_f32_16x16x32_bf16 v[12:15], v[188:191], a[212:215], v[12:15]
  v_mfma_f32_16x16x32_bf16 v[20:23], v[188:191], a[216:219], v[20:23]
  v_mfma_f32_16x16x32_bf16 v[28:31], v[188:191], a[220:223], v[28:31]
  s_waitcnt lgkmcnt(2)
  buffer_load_dwordx4 v202, s[48:51], s65 offen lds
  v_mfma_f32_16x16x32_bf16 v[32:35], a[208:211], v[160:163], v[32:35]
  s_waitcnt vmcnt(15) lgkmcnt(0)
  s_barrier
  v_mfma_f32_16x16x32_bf16 v[40:43], a[212:215], v[160:163], v[40:43]
  ds_read_b128 a[224:227], v204 offset:40960
  s_add_u32 m0, s10, 0xa000
  v_mfma_f32_16x16x32_bf16 v[48:51], a[216:219], v[160:163], v[48:51]
  ds_read_b64_tr_b16 v[176:177], v206 offset:40960
  v_mfma_f32_16x16x32_bf16 v[56:59], a[220:223], v[160:163], v[56:59]
  ds_read_b64_tr_b16 v[178:179], v206 offset:41472
  v_mfma_f32_16x16x32_bf16 v[36:39], a[208:211], v[164:167], v[36:39]
  ds_read_b128 a[228:231], v204 offset:43008
  buffer_load_dwordx4 v203, s[44:47], s65 offen lds
  v_mfma_f32_16x16x32_bf16 v[44:47], a[212:215], v[164:167], v[44:47]
  s_add_u32 m0, s10, 0xc000
  v_mfma_f32_16x16x32_bf16 v[52:55], a[216:219], v[164:167], v[52:55]
  ds_read_b128 a[232:235], v204 offset:45056
  v_mfma_f32_16x16x32_bf16 v[60:63], a[220:223], v[164:167], v[60:63]
  v_mfma_f32_16x16x32_bf16 v[64:67], a[208:211], v[168:171], v[64:67]
  ds_read_b128 a[236:239], v204 offset:47104
  v_mfma_f32_16x16x32_bf16 v[72:75], a[212:215], v[168:171], v[72:75]
  buffer_load_dwordx4 v203, s[48:51], s65 offen lds
  s_add_u32 m0, s60, 0x10000
  v_mfma_f32_16x16x32_bf16 v[80:83], a[216:219], v[168:171], v[80:83]
  ds_read_b64_tr_b16 v[180:181], v207 offset:40960
  s_mul_i32 s65, s62, 229376
  v_mfma_f32_16x16x32_bf16 v[88:91], a[220:223], v[168:171], v[88:91]
  ds_read_b64_tr_b16 v[182:183], v207 offset:41472
  s_xor_b32 s62, s58, 5
  v_mfma_f32_16x16x32_bf16 v[68:71], a[208:211], v[172:175], v[68:71]
  ds_read_b64_tr_b16 v[184:185], v206 offset:49152
  v_mfma_f32_16x16x32_bf16 v[76:79], a[212:215], v[172:175], v[76:79]
  ds_read_b64_tr_b16 v[186:187], v206 offset:49664
  buffer_load_dwordx4 v202, s[44:47], s65 offen lds
  v_mfma_f32_16x16x32_bf16 v[84:87], a[216:219], v[172:175], v[84:87]
L_pg8:
  s_cbranch_execz L_walked
  ds_read_b64_tr_b16 v[188:189], v207 offset:49152
  s_add_u32 m0, s60, 0x12000
  v_mfma_f32_16x16x32_bf16 v[92:95], a[220:223], v[172:175], v[92:95]
  s_waitcnt lgkmcnt(7)
  ds_read_b64_tr_b16 v[190:191], v207 offset:49664
  v_mfma_f32_16x16x32_bf16 v[0:3], v[176:179], a[224:227], v[0:3]
  ds_read_b64_tr_b16 v[160:161], v206 offset:57344
  v_mfma_f32_16x16x32_bf16 v[8:11], v[176:179], a[228:231], v[8:11]
  s_waitcnt lgkmcnt(8)
  ds_read_b64_tr_b16 v[162:163], v206 offset:57856
  v_mfma_f32_16x16x32_bf16 v[16:19], v[176:179], a[232:235], v[16:19]
  s_waitcnt lgkmcnt(8)
  ds_read_b64_tr_b16 v[164:165], v207 offset:57344
  v_mfma_f32_16x16x32_bf16 v[24:27], v[176:179], a[236:239], v[24:27]
  s_waitcnt lgkmcnt(7)
  ds_read_b64_tr_b16 v[166:167], v207 offset:57856
  v_mfma_f32_16x16x32_bf16 v[4:7], v[180:183], a[224:227], v[4:7]
  ds_read_b128 a[240:243], v205 offset:40960
  buffer_load_dwordx4 v202, s[48:51], s65 offen lds
  v_mfma_f32_16x16x32_bf16 v[12:15], v[180:183], a[228:231], v[12:15]
  s_add_u32 m0, s10, 0x10000
  v_mfma_f32_16x16x32_bf16 v[20:23], v[180:183], a[232:235], v[20:23]
  ds_read_b64_tr_b16 v[168:169], v206 offset:45056
  v_mfma_f32_16x16x32_bf16 v[28:31], v[180:183], a[236:239], v[28:31]
  s_waitcnt lgkmcnt(8)
  ds_read_b64_tr_b16 v[170:171], v206 offset:45568
  v_mfma_f32_16x16x32_bf16 v[32:35], a[224:227], v[184:187], v[32:35]
  ds_read_b128 a[244:247], v205 offset:43008
  buffer_load_dwordx4 v203, s[44:47], s65 offen lds
  v_mfma_f32_16x16x32_bf16 v[40:43], a[228:231], v[184:187], v[40:43]
  s_add_u32 m0, s10, 0x12000
  v_mfma_f32_16x16x32_bf16 v[48:51], a[232:235], v[184:187], v[48:51]
  ds_read_b128 a[248:251], v205 offset:45056
  v_mfma_f32_16x16x32_bf16 v[56:59], a[236:239], v[184:187], v[56:59]
  s_waitcnt lgkmcnt(7)
  v_mfma_f32_16x16x32_bf16 v[36:39], a[224:227], v[188:191], v[36:39]
  ds_read_b128 a[252:255], v205 offset:47104
  buffer_load_dwordx4 v203, s[48:51], s65 offen lds
  v_mfma_f32_16x16x32_bf16 v[44:47], a[228:231], v[188:191], v[44:47]
  s_add_u32 m0, s60, 0x14000
  s_mul_i32 s65, s62, 229376
  v_mfma_f32_16x16x32_bf16 v[52:55], a[232:235], v[188:191], v[52:55]
  ds_read_b64_tr_b16 v[172:173], v207 offset:45056
  s_xor_b32 s62, s58, 6
  v_mfma_f32_16x16x32_bf16 v[60:63], a[236:239], v[188:191], v[60:63]
  ds_read_b64_tr_b16 v[174:175], v207 offset:45568
  v_mfma_f32_16x16x32_bf16 v[64:67], a[224:227], v[160:163], v[64:67]
  ds_read_b64_tr_b16 v[176:177], v206 offset:53248
  v_mfma_f32_16x16x32_bf16 v[72:75], a[228:231], v[160:163], v[72:75]
  buffer_load_dwordx4 v202, s[44:47], s65 offen lds
  s_add_u32 m0, s60, 0x16000
  v_mfma_f32_16x16x32_bf16 v[80:83], a[232:235], v[160:163], v[80:83]
  ds_read_b64_tr_b16 v[178:179], v206 offset:53760
  ds_read_b64_tr_b16 v[180:181], v207 offset:53248
  v_mfma_f32_16x16x32_bf16 v[88:91], a[236:239], v[160:163], v[88:91]
  s_waitcnt lgkmcnt(7)
  ds_read_b64_tr_b16 v[182:183], v207 offset:53760
  v_mfma_f32_16x16x32_bf16 v[68:71], a[224:227], v[164:167], v[68:71]
  ds_read_b64_tr_b16 v[184:185], v206 offset:61440
  v_mfma_f32_16x16x32_bf16 v[76:79], a[228:231], v[164:167], v[76:79]
  buffer_load_dwordx4 v202, s[48:51], s65 offen lds
  s_add_u32 m0, s10, 0x14000
  v_mfma_f32_16x16x32_bf16 v[84:87], a[232:235], v[164:167], v[84:87]
  ds_read_b64_tr_b16 v[186:187], v206 offset:61952
  ds_read_b64_tr_b16 v[188:189], v207 offset:61440
  v_mfma_f32_16x16x32_bf16 v[92:95], a[236:239], v[164:167], v[92:95]
  ds_read_b64_tr_b16 v[190:191], v207 offset:61952
  v_add_u32 v206, 0xfffe8000, v206
  v_mfma_f32_16x16x32_bf16 v[0:3], v[168:171], a[240:243], v[0:3]
  v_add_u32 v207, 0xfffe8000, v207
  v_mfma_f32_16x16x32_bf16 v[8:11], v[168:171], a[244:247], v[8:11]
  s_waitcnt lgkmcnt(8)
  v_mfma_f32_16x16x32_bf16 v[16:19], v[168:171], a[248:251], v[16:19]
  buffer_load_dwordx4 v203, s[44:47], s65 offen lds
  s_add_u32 m0, s10, 0x16000
  v_mfma_f32_16x16x32_bf16 v[24:27], v[168:171], a[252:255], v[24:27]
  v_mfma_f32_16x16x32_bf16 v[4:7], v[172:175], a[240:243], v[4:7]
  v_mul_f32 v0, s66, v0
  v_mul_f32 v1, s66, v1
  v_mfma_f32_16x16x32_bf16 v[12:15], v[172:175], a[244:247], v[12:15]
  v_mul_f32 v2, s66, v2
  v_mul_f32 v3, s66, v3
  v_mfma_f32_16x16x32_bf16 v[20:23], v[172:175], a[248:251], v[20:23]
  v_cvt_pk_bf16_f32 v0, v0, v1
  v_mul_f32 v8, s66, v8
  v_mfma_f32_16x16x32_bf16 v[28:31], v[172:175], a[252:255], v[28:31]
  s_waitcnt lgkmcnt(3)
  buffer_load_dwordx4 v203, s[48:51], s65 offen lds
  v_mfma_f32_16x16x32_bf16 v[32:35], a[240:243], v[176:179], v[32:35]
  s_waitcnt vmcnt(16) lgkmcnt(0)
  s_barrier
  v_mfma_f32_16x16x32_bf16 v[40:43], a[244:247], v[176:179], v[40:43]
  s_add_u32 m0, s60, 0x1a000
  s_mul_i32 s65, s62, 229376
  v_mfma_f32_16x16x32_bf16 v[48:51], a[248:251], v[176:179], v[48:51]
  ds_read_b64_tr_b16 v[160:161], v206 offset:0
  ds_read_b64_tr_b16 v[162:163], v206 offset:512
  v_mfma_f32_16x16x32_bf16 v[56:59], a[252:255], v[176:179], v[56:59]
  ds_read_b64_tr_b16 v[164:165], v207 offset:0
  s_xor_b32 s62, s58, 7
  v_mfma_f32_16x16x32_bf16 v[36:39], a[240:243], v[180:183], v[36:39]
  ds_read_b64_tr_b16 v[166:167], v207 offset:512
  v_mul_f32 v4, s66, v4
  v_mfma_f32_16x16x32_bf16 v[44:47], a[244:247], v[180:183], v[44:47]
  ds_read_b64_tr_b16 v[168:169], v206 offset:8192
  v_mul_f32 v5, s66, v5
  v_mfma_f32_16x16x32_bf16 v[52:55], a[248:251], v[180:183], v[52:55]
  ds_read_b64_tr_b16 v[170:171], v206 offset:8704
  v_mul_f32 v9, s66, v9
  v_mfma_f32_16x16x32_bf16 v[60:63], a[252:255], v[180:183], v[60:63]
  ds_read_b64_tr_b16 v[172:173], v207 offset:8192
  v_mul_f32 v10, s66, v10
  v_mfma_f32_16x16x32_bf16 v[64:67], a[240:243], v[184:187], v[64:67]
  ds_read_b64_tr_b16 v[174:175], v207 offset:8704
  v_mul_f32 v11, s66, v11
  v_mfma_f32_16x16x32_bf16 v[72:75], a[244:247], v[184:187], v[72:75]
  buffer_load_dwordx4 v202, s[44:47], s65 offen lds
  s_add_u32 m0, s60, 0x1c000
  v_mfma_f32_16x16x32_bf16 v[80:83], a[248:251], v[184:187], v[80:83]
  ds_read_b64_tr_b16 v[176:177], v206 offset:4096
  ds_read_b64_tr_b16 v[178:179], v206 offset:4608
  v_mfma_f32_16x16x32_bf16 v[88:91], a[252:255], v[184:187], v[88:91]
  ds_read_b64_tr_b16 v[180:181], v207 offset:4096
  v_cvt_pk_bf16_f32 v1, v2, v3
  v_mfma_f32_16x16x32_bf16 v[68:71], a[240:243], v[188:191], v[68:71]
  buffer_load_dwordx4 v202, s[48:51], s65 offen lds
  s_add_u32 m0, s10, 0x1a000
  v_mfma_f32_16x16x32_bf16 v[76:79], a[244:247], v[188:191], v[76:79]
  ds_read_b64_tr_b16 v[182:183], v207 offset:4608
  ds_read_b64_tr_b16 v[184:185], v206 offset:12288
  v_mfma_f32_16x16x32_bf16 v[84:87], a[248:251], v[188:191], v[84:87]
  ds_read_b64_tr_b16 v[186:187], v206 offset:12800
  v_mul_f32 v6, s66, v6
  v_mfma_f32_16x16x32_bf16 v[92:95], a[252:255], v[188:191], v[92:95]
  s_waitcnt lgkmcnt(9)
  buffer_load_dwordx4 v203, s[44:47], s65 offen lds
  v_mfma_f32_16x16x32_bf16 v[96:99], v[160:163], a[0:3], 0
  s_add_u32 m0, s10, 0x1c000
  ds_read_b64_tr_b16 v[188:189], v207 offset:12288
  v_mfma_f32_16x16x32_bf16 v[104:107], v[160:163], a[4:7], 0
  buffer_load_dwordx4 v203, s[48:51], s65 offen lds
  s_add_u32 m0, s60, 0x1e000
  v_mfma_f32_16x16x32_bf16 v[112:115], v[160:163], a[8:11], 0
  s_mul_i32 s65, s62, 229376
  ds_read_b64_tr_b16 v[190:191], v207 offset:12800
  v_mfma_f32_16x16x32_bf16 v[120:123], v[160:163], a[12:15], 0
  ds_read_b64_tr_b16 v[160:161], v206 offset:16384
  ds_read_b64_tr_b16 v[162:163], v206 offset:16896
  v_mfma_f32_16x16x32_bf16 v[100:103], v[164:167], a[0:3], 0
  buffer_load_dwordx4 v202, s[44:47], s65 offen lds
  s_add_u32 m0, s60, 0x20000
  v_mfma_f32_16x16x32_bf16 v[108:111], v[164:167], a[4:7], 0
  s_add_u32 s60, s61, 32768
  v_mul_f32 v7, s66, v7
  v_mfma_f32_16x16x32_bf16 v[116:119], v[164:167], a[8:11], 0
  v_cvt_pk_bf16_f32 v4, v4, v5
  v_mul_f32 v16, s66, v16
  v_mfma_f32_16x16x32_bf16 v[124:127], v[164:167], a[12:15], 0
  s_waitcnt lgkmcnt(5)
  buffer_load_dwordx4 v202, s[48:51], s65 offen lds
  v_mfma_f32_16x16x32_bf16 v[128:131], v[168:171], a[0:3], 0
  s_add_u32 m0, s10, 0x1e000
  ds_read_b64_tr_b16 v[164:165], v207 offset:16384
  v_mfma_f32_16x16x32_bf16 v[136:139], v[168:171], a[4:7], 0
  buffer_load_dwordx4 v203, s[44:47], s65 offen lds
  s_add_u32 m0, s10, 0x20000
  v_mfma_f32_16x16x32_bf16 v[144:147], v[168:171], a[8:11], 0
  ds_read_b64_tr_b16 v[166:167], v207 offset:16896
  v_mul_f32 v17, s66, v17
  v_mfma_f32_16x16x32_bf16 v[152:155], v[168:171], a[12:15], 0
  ds_read_b64_tr_b16 v[168:169], v206 offset:24576
  ds_read_b64_tr_b16 v[170:171], v206 offset:25088
  v_mfma_f32_16x16x32_bf16 v[132:135], v[172:175], a[0:3], 0
  buffer_load_dwordx4 v203, s[48:51], s65 offen lds
  buffer_store_dword v253, v212, s[52:55], s71 offen sc1
  v_mfma_f32_16x16x32_bf16 v[140:143], v[172:175], a[4:7], 0
  v_cvt_pk_bf16_f32 v2, v8, v9
  v_cvt_pk_bf16_f32 v3, v10, v11
  v_mfma_f32_16x16x32_bf16 v[148:151], v[172:175], a[8:11], 0
  v_mul_f32 v12, s66, v12
  v_mul_f32 v13, s66, v13
  v_mfma_f32_16x16x32_bf16 v[156:159], v[172:175], a[12:15], 0
  ds_read_b64_tr_b16 v[172:173], v207 offset:24576
  ds_read_b64_tr_b16 v[174:175], v207 offset:25088
  v_mfma_f32_16x16x32_bf16 v[96:99], v[176:179], a[16:19], v[96:99]
  v_mul_f32 v14, s66, v14
  v_mul_f32 v15, s66, v15
  v_mfma_f32_16x16x32_bf16 v[104:107], v[176:179], a[20:23], v[104:107]
  v_cvt_pk_bf16_f32 v5, v6, v7
  v_mul_f32 v18, s66, v18
  v_mfma_f32_16x16x32_bf16 v[112:115], v[176:179], a[24:27], v[112:115]
  v_mul_f32 v19, s66, v19
  v_cvt_pk_bf16_f32 v16, v16, v17
  v_mfma_f32_16x16x32_bf16 v[120:123], v[176:179], a[28:31], v[120:123]
  ds_read_b64_tr_b16 v[176:177], v206 offset:20480
  ds_read_b64_tr_b16 v[178:179], v206 offset:20992
  v_mfma_f32_16x16x32_bf16 v[100:103], v[180:183], a[16:19], v[100:103]
  v_mul_f32 v20, s66, v20
  v_mul_f32 v21, s66, v21
  v_mfma_f32_16x16x32_bf16 v[108:111], v[180:183], a[20:23], v[108:111]
  v_permlane16_swap_b32 v0, v2
  v_permlane16_swap_b32 v1, v3
  v_mfma_f32_16x16x32_bf16 v[116:119], v[180:183], a[24:27], v[116:119]
  buffer_store_dwordx4 v[0:3], v211, s[52:55], s4 offen sc1
  v_cvt_pk_bf16_f32 v6, v12, v13
  v_mfma_f32_16x16x32_bf16 v[124:127], v[180:183], a[28:31], v[124:127]
  s_waitcnt lgkmcnt(4)
  ds_read_b64_tr_b16 v[180:181], v207 offset:20480
  v_mfma_f32_16x16x32_bf16 v[128:131], v[184:187], a[16:19], v[128:131]
  ds_read_b64_tr_b16 v[182:183], v207 offset:20992
  v_cvt_pk_bf16_f32 v7, v14, v15
  v_mfma_f32_16x16x32_bf16 v[136:139], v[184:187], a[20:23], v[136:139]
  v_mul_f32 v24, s66, v24
  v_mul_f32 v25, s66, v25
  v_mfma_f32_16x16x32_bf16 v[144:147], v[184:187], a[24:27], v[144:147]
  v_mul_f32 v26, s66, v26
  v_mul_f32 v27, s66, v27
  v_mfma_f32_16x16x32_bf16 v[152:155], v[184:187], a[28:31], v[152:155]
  ds_read_b64_tr_b16 v[184:185], v206 offset:28672
  ds_read_b64_tr_b16 v[186:187], v206 offset:29184
  v_mfma_f32_16x16x32_bf16 v[132:135], v[188:191], a[16:19], v[132:135]
  v_add_u32 v206, 0xa000, v206
  v_cvt_pk_bf16_f32 v17, v18, v19
  v_mfma_f32_16x16x32_bf16 v[140:143], v[188:191], a[20:23], v[140:143]
  v_mul_f32 v22, s66, v22
  v_mul_f32 v23, s66, v23
  v_mfma_f32_16x16x32_bf16 v[148:151], v[188:191], a[24:27], v[148:151]
  v_cvt_pk_bf16_f32 v20, v20, v21
  v_permlane16_swap_b32 v4, v6
  v_mfma_f32_16x16x32_bf16 v[156:159], v[188:191], a[28:31], v[156:159]
  ds_read_b64_tr_b16 v[188:189], v207 offset:28672
  ds_read_b64_tr_b16 v[190:191], v207 offset:29184
  v_mfma_f32_16x16x32_bf16 v[96:99], v[160:163], a[32:35], v[96:99]
  v_add_u32 v207, 0xa000, v207
  v_permlane16_swap_b32 v5, v7
  v_mfma_f32_16x16x32_bf16 v[104:107], v[160:163], a[36:39], v[104:107]
  buffer_store_dwordx4 v[4:7], v211, s[52:55], s5 offen sc1
  v_cvt_pk_bf16_f32 v18, v24, v25
  v_mfma_f32_16x16x32_bf16 v[112:115], v[160:163], a[40:43], v[112:115]
  v_cvt_pk_bf16_f32 v19, v26, v27
  v_mul_f32 v28, s66, v28
  v_mfma_f32_16x16x32_bf16 v[120:123], v[160:163], a[44:47], v[120:123]
  v_mul_f32 v29, s66, v29
  v_mul_f32 v30, s66, v30
  v_mfma_f32_16x16x32_bf16 v[100:103], v[164:167], a[32:35], v[100:103]
  v_mul_f32 v31, s66, v31
  v_cvt_pk_bf16_f32 v21, v22, v23
  v_mfma_f32_16x16x32_bf16 v[108:111], v[164:167], a[36:39], v[108:111]
  v_cvt_pk_bf16_f32 v32, v32, v33
  v_permlane16_swap_b32 v16, v18
  v_mfma_f32_16x16x32_bf16 v[116:119], v[164:167], a[40:43], v[116:119]
  v_permlane16_swap_b32 v17, v19
  v_cvt_pk_bf16_f32 v22, v28, v29
  v_mfma_f32_16x16x32_bf16 v[124:127], v[164:167], a[44:47], v[124:127]
  buffer_store_dwordx4 v[16:19], v211, s[52:55], s6 offen sc1
  v_cvt_pk_bf16_f32 v23, v30, v31
  v_mfma_f32_16x16x32_bf16 v[128:131], v[168:171], a[32:35], v[128:131]
  v_cvt_pk_bf16_f32 v33, v34, v35
  v_cvt_pk_bf16_f32 v40, v40, v41
  v_mfma_f32_16x16x32_bf16 v[136:139], v[168:171], a[36:39], v[136:139]
  v_cvt_pk_bf16_f32 v34, v36, v37
  v_cvt_pk_bf16_f32 v35, v38, v39
  v_mfma_f32_16x16x32_bf16 v[144:147], v[168:171], a[40:43], v[144:147]
  v_cvt_pk_bf16_f32 v41, v42, v43
  v_cvt_pk_bf16_f32 v48, v48, v49
  v_mfma_f32_16x16x32_bf16 v[152:155], v[168:171], a[44:47], v[152:155]
  s_waitcnt lgkmcnt(0)
  v_permlane16_swap_b32 v20, v22
  v_mfma_f32_16x16x32_bf16 v[132:135], v[172:175], a[32:35], v[132:135]
  v_permlane16_swap_b32 v21, v23
  v_permlane16_swap_b32 v32, v34
  v_mfma_f32_16x16x32_bf16 v[140:143], v[172:175], a[36:39], v[140:143]
  buffer_store_dwordx4 v[20:23], v211, s[52:55], s7 offen sc1
  v_permlane16_swap_b32 v33, v35
  v_mfma_f32_16x16x32_bf16 v[148:151], v[172:175], a[40:43], v[148:151]
  v_cvt_pk_bf16_f32 v42, v44, v45
  v_cvt_pk_bf16_f32 v43, v46, v47
  v_mfma_f32_16x16x32_bf16 v[156:159], v[172:175], a[44:47], v[156:159]
  v_cvt_pk_bf16_f32 v49, v50, v51
  v_cvt_pk_bf16_f32 v56, v56, v57
  v_mfma_f32_16x16x32_bf16 v[96:99], v[176:179], a[48:51], v[96:99]
  v_permlane32_swap_b32 v32, v34
  v_permlane32_swap_b32 v33, v35
  v_mfma_f32_16x16x32_bf16 v[104:107], v[176:179], a[52:55], v[104:107]
  v_permlane16_swap_b32 v40, v42
  v_permlane16_swap_b32 v41, v43
  v_mfma_f32_16x16x32_bf16 v[112:115], v[176:179], a[56:59], v[112:115]
  s_waitcnt vmcnt(13)
  s_barrier
  v_mfma_f32_16x16x32_bf16 v[120:123], v[176:179], a[60:63], v[120:123]
  ds_read_b64_tr_b16 v[160:161], v206 offset:0
  ds_read_b64_tr_b16 v[162:163], v206 offset:512
  v_mfma_f32_16x16x32_bf16 v[100:103], v[180:183], a[48:51], v[100:103]
  ds_read_b64_tr_b16 v[164:165], v207 offset:0
  v_cvt_pk_bf16_f32 v50, v52, v53
  v_mfma_f32_16x16x32_bf16 v[108:111], v[180:183], a[52:55], v[108:111]
  ds_read_b64_tr_b16 v[166:167], v207 offset:512
  v_cvt_pk_bf16_f32 v51, v54, v55
  v_mfma_f32_16x16x32_bf16 v[116:119], v[180:183], a[56:59], v[116:119]
  ds_read_b64_tr_b16 v[168:169], v206 offset:8192
  v_cvt_pk_bf16_f32 v57, v58, v59
  v_mfma_f32_16x16x32_bf16 v[124:127], v[180:183], a[60:63], v[124:127]
  ds_read_b64_tr_b16 v[170:171], v206 offset:8704
  v_cvt_pk_bf16_f32 v64, v64, v65
  v_mfma_f32_16x16x32_bf16 v[128:131], v[184:187], a[48:51], v[128:131]
  ds_read_b64_tr_b16 v[172:173], v207 offset:8192
  s_add_u32 s62, s68, 0
  v_mfma_f32_16x16x32_bf16 v[136:139], v[184:187], a[52:55], v[136:139]
  buffer_store_dwordx4 v[32:35], v211, s[52:55], s62 offen offset:0 sc1
  ds_read_b64_tr_b16 v[174:175], v207 offset:8704
  v_mfma_f32_16x16x32_bf16 v[144:147], v[184:187], a[56:59], v[144:147]
  ds_read_b64_tr_b16 v[176:177], v206 offset:4096
  v_permlane32_swap_b32 v40, v42
  v_mfma_f32_16x16x32_bf16 v[152:155], v[184:187], a[60:63], v[152:155]
  ds_read_b64_tr_b16 v[178:179], v206 offset:4608
  v_permlane32_swap_b32 v41, v43
  v_mfma_f32_16x16x32_bf16 v[132:135], v[188:191], a[48:51], v[132:135]
  ds_read_b64_tr_b16 v[180:181], v207 offset:4096
  v_permlane16_swap_b32 v48, v50
  v_mfma_f32_16x16x32_bf16 v[140:143], v[188:191], a[52:55], v[140:143]
  ds_read_b64_tr_b16 v[182:183], v207 offset:4608
  v_permlane16_swap_b32 v49, v51
  v_mfma_f32_16x16x32_bf16 v[148:151], v[188:191], a[56:59], v[148:151]
  buffer_store_dwordx4 v[40:43], v211, s[52:55], s62 offen offset:1024 sc1
  ds_read_b64_tr_b16 v[184:185], v206 offset:12288
  v_mfma_f32_16x16x32_bf16 v[156:159], v[188:191], a[60:63], v[156:159]
  s_waitcnt lgkmcnt(9)
  ds_read_b64_tr_b16 v[186:187], v206 offset:12800
  v_mfma_f32_16x16x32_bf16 v[96:99], v[160:163], a[64:67], v[96:99]
  ds_read_b64_tr_b16 v[188:189], v207 offset:12288
  v_cvt_pk_bf16_f32 v58, v60, v61
  v_mfma_f32_16x16x32_bf16 v[104:107], v[160:163], a[68:71], v[104:107]
  ds_read_b64_tr_b16 v[190:191], v207 offset:12800
  v_cvt_pk_bf16_f32 v59, v62, v63
  v_mfma_f32_16x16x32_bf16 v[112:115], v[160:163], a[72:75], v[112:115]
  v_cvt_pk_bf16_f32 v65, v66, v67
  v_cvt_pk_bf16_f32 v72, v72, v73
  v_mfma_f32_16x16x32_bf16 v[120:123], v[160:163], a[76:79], v[120:123]
  ds_read_b64_tr_b16 v[160:161], v206 offset:16384
  ds_read_b64_tr_b16 v[162:163], v206 offset:16896
  v_mfma_f32_16x16x32_bf16 v[100:103], v[164:167], a[64:67], v[100:103]
  v_permlane32_swap_b32 v48, v50
  v_permlane32_swap_b32 v49, v51
  v_mfma_f32_16x16x32_bf16 v[108:111], v[164:167], a[68:71], v[108:111]
  buffer_store_dwordx4 v[48:51], v211, s[52:55], s63 offen offset:0 sc1
  v_permlane16_swap_b32 v56, v58
  v_mfma_f32_16x16x32_bf16 v[116:119], v[164:167], a[72:75], v[116:119]
  v_permlane16_swap_b32 v57, v59
  v_cvt_pk_bf16_f32 v66, v68, v69
  v_mfma_f32_16x16x32_bf16 v[124:127], v[164:167], a[76:79], v[124:127]
  s_waitcnt lgkmcnt(6)
  ds_read_b64_tr_b16 v[164:165], v207 offset:16384
  v_mfma_f32_16x16x32_bf16 v[128:131], v[168:171], a[64:67], v[128:131]
  ds_read_b64_tr_b16 v[166:167], v207 offset:16896
  v_cvt_pk_bf16_f32 v67, v70, v71
  v_mfma_f32_16x16x32_bf16 v[136:139], v[168:171], a[68:71], v[136:139]
  v_cvt_pk_bf16_f32 v73, v74, v75
  v_cvt_pk_bf16_f32 v80, v80, v81
  v_mfma_f32_16x16x32_bf16 v[144:147], v[168:171], a[72:75], v[144:147]
  v_permlane32_swap_b32 v56, v58
  v_permlane32_swap_b32 v57, v59
  v_mfma_f32_16x16x32_bf16 v[152:155], v[168:171], a[76:79], v[152:155]
  buffer_store_dwordx4 v[56:59], v211, s[52:55], s63 offen offset:1024 sc1
  ds_read_b64_tr_b16 v[168:169], v206 offset:24576
  v_mfma_f32_16x16x32_bf16 v[132:135], v[172:175], a[64:67], v[132:135]
  ds_read_b64_tr_b16 v[170:171], v206 offset:25088
  v_permlane16_swap_b32 v64, v66
  v_mfma_f32_16x16x32_bf16 v[140:143], v[172:175], a[68:71], v[140:143]
  v_permlane16_swap_b32 v65, v67
  v_cvt_pk_bf16_f32 v74, v76, v77
  v_mfma_f32_16x16x32_bf16 v[148:151], v[172:175], a[72:75], v[148:151]
  v_cvt_pk_bf16_f32 v75, v78, v79
  v_cvt_pk_bf16_f32 v81, v82, v83
  v_mfma_f32_16x16x32_bf16 v[156:159], v[172:175], a[76:79], v[156:159]
  ds_read_b64_tr_b16 v[172:173], v207 offset:24576
  ds_read_b64_tr_b16 v[174:175], v207 offset:25088
  v_mfma_f32_16x16x32_bf16 v[96:99], v[176:179], a[80:83], v[96:99]
  v_cvt_pk_bf16_f32 v88, v88, v89
  v_permlane32_swap_b32 v64, v66
  v_mfma_f32_16x16x32_bf16 v[104:107], v[176:179], a[84:87], v[104:107]
  v_permlane32_swap_b32 v65, v67
  v_permlane16_swap_b32 v72, v74
  v_mfma_f32_16x16x32_bf16 v[112:115], v[176:179], a[88:91], v[112:115]
  buffer_store_dwordx4 v[64:67], v211, s[52:55], s64 offen offset:0 sc1
  v_permlane16_swap_b32 v73, v75
  v_mfma_f32_16x16x32_bf16 v[120:123], v[176:179], a[92:95], v[120:123]
  ds_read_b64_tr_b16 v[176:177], v206 offset:20480
  ds_read_b64_tr_b16 v[178:179], v206 offset:20992
  v_mfma_f32_16x16x32_bf16 v[100:103], v[180:183], a[80:83], v[100:103]
  s_add_u32 m0, s8, 0
  v_cvt_pk_bf16_f32 v82, v84, v85
  v_mfma_f32_16x16x32_bf16 v[108:111], v[180:183], a[84:87], v[108:111]
  buffer_load_dwordx4 v232, s[88:91], s16 offen offset:0  lds
  v_cvt_pk_bf16_f32 v83, v86, v87
  v_mfma_f32_16x16x32_bf16 v[116:119], v[180:183], a[88:91], v[116:119]
  v_cvt_pk_bf16_f32 v89, v90, v91
  v_permlane32_swap_b32 v72, v74
  v_mfma_f32_16x16x32_bf16 v[124:127], v[180:183], a[92:95], v[124:127]
  s_waitcnt lgkmcnt(4)
  ds_read_b64_tr_b16 v[180:181], v207 offset:20480
  v_mfma_f32_16x16x32_bf16 v[128:131], v[184:187], a[80:83], v[128:131]
  ds_read_b64_tr_b16 v[182:183], v207 offset:20992
  v_permlane32_swap_b32 v73, v75
  v_mfma_f32_16x16x32_bf16 v[136:139], v[184:187], a[84:87], v[136:139]
  buffer_store_dwordx4 v[72:75], v211, s[52:55], s64 offen offset:1024 sc1
  v_permlane16_swap_b32 v80, v82
  v_mfma_f32_16x16x32_bf16 v[144:147], v[184:187], a[88:91], v[144:147]
  v_permlane16_swap_b32 v81, v83
  v_cvt_pk_bf16_f32 v90, v92, v93
  v_mfma_f32_16x16x32_bf16 v[152:155], v[184:187], a[92:95], v[152:155]
  ds_read_b64_tr_b16 v[184:185], v206 offset:28672
  ds_read_b64_tr_b16 v[186:187], v206 offset:29184
  v_mfma_f32_16x16x32_bf16 v[132:135], v[188:191], a[80:83], v[132:135]
  v_add_u32 v206, 0xa000, v206
  v_cvt_pk_bf16_f32 v91, v94, v95
  v_mfma_f32_16x16x32_bf16 v[140:143], v[188:191], a[84:87], v[140:143]
  buffer_load_dwordx4 v233, s[88:91], s16 offen offset:1024  lds
  v_permlane32_swap_b32 v80, v82
  v_mfma_f32_16x16x32_bf16 v[148:151], v[188:191], a[88:91], v[148:151]
  v_permlane32_swap_b32 v81, v83
  v_permlane16_swap_b32 v88, v90
  v_mfma_f32_16x16x32_bf16 v[156:159], v[188:191], a[92:95], v[156:159]
  ds_read_b64_tr_b16 v[188:189], v207 offset:28672
  ds_read_b64_tr_b16 v[190:191], v207 offset:29184
  v_mfma_f32_16x16x32_bf16 v[96:99], v[160:163], a[96:99], v[96:99]
  v_add_u32 v207, 0xa000, v207
  v_permlane16_swap_b32 v89, v91
  v_mfma_f32_16x16x32_bf16 v[104:107], v[160:163], a[100:103], v[104:107]
  s_add_u32 s65, s68, 264192
  buffer_store_dwordx4 v[80:83], v211, s[52:55], s65 offen offset:0 sc1
  v_mfma_f32_16x16x32_bf16 v[112:115], v[160:163], a[104:107], v[112:115]
  v_permlane32_swap_b32 v88, v90
  v_permlane32_swap_b32 v89, v91
  v_mfma_f32_16x16x32_bf16 v[120:123], v[160:163], a[108:111], v[120:123]
  ds_read_b64_tr_b16 v[160:161], v206 offset:0
  ds_read_b64_tr_b16 v[162:163], v206 offset:512
  v_mfma_f32_16x16x32_bf16 v[100:103], v[164:167], a[96:99], v[100:103]
  buffer_load_dwordx4 v234, s[88:91], s16 offen offset:2048  lds
  v_mfma_f32_16x16x32_bf16 v[108:111], v[164:167], a[100:103], v[108:111]
  v_min_u32 v251, v216, v217
  v_cmp_eq_u32 vcc, 0, v251
  s_nop 0
  s_cbranch_vccnz L_slow_nB
L_back_nB:
  v_mfma_f32_16x16x32_bf16 v[116:119], v[164:167], a[104:107], v[116:119]
  buffer_store_dwordx4 v[88:91], v211, s[52:55], s65 offen offset:1024 sc1
  v_mfma_f32_16x16x32_bf16 v[124:127], v[164:167], a[108:111], v[124:127]
  ds_read_b64_tr_b16 v[164:165], v207 offset:0
  ds_read_b64_tr_b16 v[166:167], v207 offset:512
  v_mfma_f32_16x16x32_bf16 v[128:131], v[168:171], a[96:99], v[128:131]
  v_mfma_f32_16x16x32_bf16 v[136:139], v[168:171], a[100:103], v[136:139]
  v_mfma_f32_16x16x32_bf16 v[144:147], v[168:171], a[104:107], v[144:147]
  v_mfma_f32_16x16x32_bf16 v[152:155], v[168:171], a[108:111], v[152:155]
  s_waitcnt lgkmcnt(4)
  ds_read_b64_tr_b16 v[168:169], v206 offset:8192
  v_mfma_f32_16x16x32_bf16 v[132:135], v[172:175], a[96:99], v[132:135]
  ds_read_b64_tr_b16 v[170:171], v206 offset:8704
  buffer_load_dwordx4 v235, s[88:91], s16 offen offset:3072  lds
  v_mfma_f32_16x16x32_bf16 v[140:143], v[172:175], a[100:103], v[140:143]
  s_add_u32 s16, s14, 65536
  v_mfma_f32_16x16x32_bf16 v[148:151], v[172:175], a[104:107], v[148:151]
  v_mfma_f32_16x16x32_bf16 v[156:159], v[172:175], a[108:111], v[156:159]
  ds_read_b64_tr_b16 v[172:173], v207 offset:8192
  ds_read_b64_tr_b16 v[174:175], v207 offset:8704
  v_mfma_f32_16x16x32_bf16 v[96:99], v[176:179], a[112:115], v[96:99]
  v_mfma_f32_16x16x32_bf16 v[104:107], v[176:179], a[116:119], v[104:107]
  v_mfma_f32_16x16x32_bf16 v[112:115], v[176:179], a[120:123], v[112:115]
  s_waitcnt vmcnt(17)
  s_barrier
  v_mfma_f32_16x16x32_bf16 v[120:123], v[176:179], a[124:127], v[120:123]
  s_waitcnt vmcnt(12)
  buffer_store_dwordx2 v[216:217], v252, s[52:55], s61 offen sc1
  v_mfma_f32_16x16x32_bf16 v[100:103], v[180:183], a[112:115], v[100:103]
  ds_read_b64_tr_b16 v[176:177], v206 offset:4096
  ds_read_b64_tr_b16 v[178:179], v206 offset:4608
  v_mfma_f32_16x16x32_bf16 v[108:111], v[180:183], a[116:119], v[108:111]
  s_add_u32 m0, s8, 81920
  v_mfma_f32_16x16x32_bf16 v[116:119], v[180:183], a[120:123], v[116:119]
  buffer_load_dwordx4 v232, s[88:91], s16 offen offset:0  lds
  v_mfma_f32_16x16x32_bf16 v[124:127], v[180:183], a[124:127], v[124:127]
  ds_read_b64_tr_b16 v[180:181], v207 offset:4096
  ds_read_b64_tr_b16 v[182:183], v207 offset:4608
  v_mfma_f32_16x16x32_bf16 v[128:131], v[184:187], a[112:115], v[128:131]
  v_mfma_f32_16x16x32_bf16 v[136:139], v[184:187], a[116:119], v[136:139]
  v_mfma_f32_16x16x32_bf16 v[144:147], v[184:187], a[120:123], v[144:147]
  v_mfma_f32_16x16x32_bf16 v[152:155], v[184:187], a[124:127], v[152:155]
  ds_read_b64_tr_b16 v[184:185], v206 offset:12288
  ds_read_b64_tr_b16 v[186:187], v206 offset:12800
  v_mfma_f32_16x16x32_bf16 v[132:135], v[188:191], a[112:115], v[132:135]
  v_mfma_f32_16x16x32_bf16 v[140:143], v[188:191], a[116:119], v[140:143]
  buffer_load_dwordx4 v233, s[88:91], s16 offen offset:1024  lds
  v_mfma_f32_16x16x32_bf16 v[148:151], v[188:191], a[120:123], v[148:151]
  v_mfma_f32_16x16x32_bf16 v[156:159], v[188:191], a[124:127], v[156:159]
  s_waitcnt lgkmcnt(4)
  ds_read_b64_tr_b16 v[188:189], v207 offset:12288
  v_mfma_f32_16x16x32_bf16 v[96:99], v[160:163], a[128:131], v[96:99]
  s_waitcnt vmcnt(4)
  buffer_store_dwordx2 v[216:217], v252, s[52:55], s60 offen sc1
  v_mfma_f32_16x16x32_bf16 v[104:107], v[160:163], a[132:135], v[104:107]
  ds_read_b64_tr_b16 v[190:191], v207 offset:12800
  v_mfma_f32_16x16x32_bf16 v[112:115], v[160:163], a[136:139], v[112:115]
  v_mfma_f32_16x16x32_bf16 v[120:123], v[160:163], a[140:143], v[120:123]
  ds_read_b64_tr_b16 v[160:161], v206 offset:16384
  ds_read_b64_tr_b16 v[162:163], v206 offset:16896
  v_mfma_f32_16x16x32_bf16 v[100:103], v[164:167], a[128:131], v[100:103]
  buffer_load_dwordx4 v234, s[88:91], s16 offen offset:2048  lds
  v_mfma_f32_16x16x32_bf16 v[108:111], v[164:167], a[132:135], v[108:111]
  v_mfma_f32_16x16x32_bf16 v[116:119], v[164:167], a[136:139], v[116:119]
  v_mfma_f32_16x16x32_bf16 v[124:127], v[164:167], a[140:143], v[124:127]
  ds_read_b64_tr_b16 v[164:165], v207 offset:16384
  ds_read_b64_tr_b16 v[166:167], v207 offset:16896
  v_mfma_f32_16x16x32_bf16 v[128:131], v[168:171], a[128:131], v[128:131]
  v_mfma_f32_16x16x32_bf16 v[136:139], v[168:171], a[132:135], v[136:139]
  v_mfma_f32_16x16x32_bf16 v[144:147], v[168:171], a[136:139], v[144:147]
  v_mfma_f32_16x16x32_bf16 v[152:155], v[168:171], a[140:143], v[152:155]
  ds_read_b64_tr_b16 v[168:169], v206 offset:24576
  ds_read_b64_tr_b16 v[170:171], v206 offset:25088
  v_mfma_f32_16x16x32_bf16 v[132:135], v[172:175], a[128:131], v[132:135]
  buffer_load_dwordx4 v235, s[88:91], s16 offen offset:3072  lds
  s_add_u32 s16, s14, 131072
  v_mfma_f32_16x16x32_bf16 v[140:143], v[172:175], a[132:135], v[140:143]
  v_mfma_f32_16x16x32_bf16 v[148:151], v[172:175], a[136:139], v[148:151]
  v_mfma_f32_16x16x32_bf16 v[156:159], v[172:175], a[140:143], v[156:159]
  ds_read_b64_tr_b16 v[172:173], v207 offset:24576
  ds_read_b64_tr_b16 v[174:175], v207 offset:25088
  v_mfma_f32_16x16x32_bf16 v[96:99], v[176:179], a[144:147], v[96:99]
  v_mfma_f32_16x16x32_bf16 v[104:107], v[176:179], a[148:151], v[104:107]
  v_mfma_f32_16x16x32_bf16 v[112:115], v[176:179], a[152:155], v[112:115]
  v_mfma_f32_16x16x32_bf16 v[120:123], v[176:179], a[156:159], v[120:123]
  s_waitcnt lgkmcnt(4)
  ds_read_b64_tr_b16 v[176:177], v206 offset:20480
  v_mfma_f32_16x16x32_bf16 v[100:103], v[180:183], a[144:147], v[100:103]
  ds_read_b64_tr_b16 v[178:179], v206 offset:20992
  s_add_u32 m0, s59, 0
  v_mfma_f32_16x16x32_bf16 v[108:111], v[180:183], a[148:151], v[108:111]
  buffer_load_dwordx4 v232, s[88:91], s16 offen offset:0  lds
  v_mfma_f32_16x16x32_bf16 v[116:119], v[180:183], a[152:155], v[116:119]
  v_mfma_f32_16x16x32_bf16 v[124:127], v[180:183], a[156:159], v[124:127]
  ds_read_b64_tr_b16 v[180:181], v207 offset:20480
  ds_read_b64_tr_b16 v[182:183], v207 offset:20992
  v_mfma_f32_16x16x32_bf16 v[128:131], v[184:187], a[144:147], v[128:131]
  v_mfma_f32_16x16x32_bf16 v[136:139], v[184:187], a[148:151], v[136:139]
  v_mfma_f32_16x16x32_bf16 v[144:147], v[184:187], a[152:155], v[144:147]
  v_mfma_f32_16x16x32_bf16 v[152:155], v[184:187], a[156:159], v[152:155]
  ds_read_b64_tr_b16 v[184:185], v206 offset:28672
  ds_read_b64_tr_b16 v[186:187], v206 offset:29184
  v_mfma_f32_16x16x32_bf16 v[132:135], v[188:191], a[144:147], v[132:135]
  buffer_load_dwordx4 v233, s[88:91], s16 offen offset:1024  lds
  v_add_u32 v206, 0xa000, v206
  v_mfma_f32_16x16x32_bf16 v[140:143], v[188:191], a[148:151], v[140:143]
  v_mfma_f32_16x16x32_bf16 v[148:151], v[188:191], a[152:155], v[148:151]
  v_mfma_f32_16x16x32_bf16 v[156:159], v[188:191], a[156:159], v[156:159]
  ds_read_b64_tr_b16 v[188:189], v207 offset:28672
  ds_read_b64_tr_b16 v[190:191], v207 offset:29184
  v_mfma_f32_16x16x32_bf16 v[96:99], v[160:163], a[160:163], v[96:99]
  v_add_u32 v207, 0xa000, v207
  v_mfma_f32_16x16x32_bf16 v[104:107], v[160:163], a[164:167], v[104:107]
  v_mfma_f32_16x16x32_bf16 v[112:115], v[160:163], a[168:171], v[112:115]
  v_mfma_f32_16x16x32_bf16 v[120:123], v[160:163], a[172:175], v[120:123]
  ds_read_b64_tr_b16 v[160:161], v206 offset:0
  ds_read_b64_tr_b16 v[162:163], v206 offset:512
  v_mfma_f32_16x16x32_bf16 v[100:103], v[164:167], a[160:163], v[100:103]
  buffer_load_dwordx4 v234, s[88:91], s16 offen offset:2048  lds
  v_mfma_f32_16x16x32_bf16 v[108:111], v[164:167], a[164:167], v[108:111]
  v_mfma_f32_16x16x32_bf16 v[116:119], v[164:167], a[168:171], v[116:119]
  v_mfma_f32_16x16x32_bf16 v[124:127], v[164:167], a[172:175], v[124:127]
  s_waitcnt lgkmcnt(4)
L_pg9:
  s_cbranch_execz L_walked
  ds_read_b64_tr_b16 v[164:165], v207 offset:0
  v_mfma_f32_16x16x32_bf16 v[128:131], v[168:171], a[160:163], v[128:131]
  ds_read_b64_tr_b16 v[166:167], v207 offset:512
  v_mfma_f32_16x16x32_bf16 v[136:139], v[168:171], a[164:167], v[136:139]
  v_mfma_f32_16x16x32_bf16 v[144:147], v[168:171], a[168:171], v[144:147]
  v_mfma_f32_16x16x32_bf16 v[152:155], v[168:171], a[172:175], v[152:155]
  ds_read_b64_tr_b16 v[168:169], v206 offset:8192
  ds_read_b64_tr_b16 v[170:171], v206 offset:8704
  v_mfma_f32_16x16x32_bf16 v[132:135], v[172:175], a[160:163], v[132:135]
  buffer_load_dwordx4 v235, s[88:91], s16 offen offset:3072  lds
  s_add_u32 s16, s15, 0
  v_mfma_f32_16x16x32_bf16 v[140:143], v[172:175], a[164:167], v[140:143]
  v_mfma_f32_16x16x32_bf16 v[148:151], v[172:175], a[168:171], v[148:151]
  v_mfma_f32_16x16x32_bf16 v[156:159], v[172:175], a[172:175], v[156:159]
  ds_read_b64_tr_b16 v[172:173], v207 offset:8192
  ds_read_b64_tr_b16 v[174:175], v207 offset:8704
  v_mfma_f32_16x16x32_bf16 v[96:99], v[176:179], a[176:179], v[96:99]
  v_mfma_f32_16x16x32_bf16 v[104:107], v[176:179], a[180:183], v[104:107]
  v_mfma_f32_16x16x32_bf16 v[112:115], v[176:179], a[184:187], v[112:115]
  s_waitcnt lgkmcnt(4)
  s_barrier
  v_mfma_f32_16x16x32_bf16 v[120:123], v[176:179], a[188:191], v[120:123]
  ds_read_b64_tr_b16 v[176:177], v206 offset:4096
  ds_read_b64_tr_b16 v[178:179], v206 offset:4608
  v_mfma_f32_16x16x32_bf16 v[100:103], v[180:183], a[176:179], v[100:103]
  s_add_u32 m0, s59, 16384
  v_mfma_f32_16x16x32_bf16 v[108:111], v[180:183], a[180:183], v[108:111]
  buffer_load_dwordx4 v232, s[88:91], s16 offen offset:0  lds
  v_mfma_f32_16x16x32_bf16 v[116:119], v[180:183], a[184:187], v[116:119]
  v_mfma_f32_16x16x32_bf16 v[124:127], v[180:183], a[188:191], v[124:127]
  ds_read_b64_tr_b16 v[180:181], v207 offset:4096
  ds_read_b64_tr_b16 v[182:183], v207 offset:4608
  v_mfma_f32_16x16x32_bf16 v[128:131], v[184:187], a[176:179], v[128:131]
  v_mfma_f32_16x16x32_bf16 v[136:139], v[184:187], a[180:183], v[136:139]
  v_mfma_f32_16x16x32_bf16 v[144:147], v[184:187], a[184:187], v[144:147]
  v_mfma_f32_16x16x32_bf16 v[152:155], v[184:187], a[188:191], v[152:155]
  ds_read_b64_tr_b16 v[184:185], v206 offset:12288
  ds_read_b64_tr_b16 v[186:187], v206 offset:12800
  v_mfma_f32_16x16x32_bf16 v[132:135], v[188:191], a[176:179], v[132:135]
  buffer_load_dwordx4 v233, s[88:91], s16 offen offset:1024  lds
  v_mfma_f32_16x16x32_bf16 v[140:143], v[188:191], a[180:183], v[140:143]
  v_mfma_f32_16x16x32_bf16 v[148:151], v[188:191], a[184:187], v[148:151]
  v_mfma_f32_16x16x32_bf16 v[156:159], v[188:191], a[188:191], v[156:159]
  ds_read_b64_tr_b16 v[188:189], v207 offset:12288
  ds_read_b64_tr_b16 v[190:191], v207 offset:12800
  v_mfma_f32_16x16x32_bf16 v[96:99], v[160:163], a[192:195], v[96:99]
  v_mfma_f32_16x16x32_bf16 v[104:107], v[160:163], a[196:199], v[104:107]
  v_mfma_f32_16x16x32_bf16 v[112:115], v[160:163], a[200:203], v[112:115]
  v_mfma_f32_16x16x32_bf16 v[120:123], v[160:163], a[204:207], v[120:123]
  buffer_load_dwordx4 v234, s[88:91], s16 offen offset:2048  lds
  ds_read_b64_tr_b16 v[160:161], v206 offset:16384
  v_mfma_f32_16x16x32_bf16 v[100:103], v[164:167], a[192:195], v[100:103]
  ds_read_b64_tr_b16 v[162:163], v206 offset:16896
  v_mfma_f32_16x16x32_bf16 v[108:111], v[164:167], a[196:199], v[108:111]
  v_mfma_f32_16x16x32_bf16 v[116:119], v[164:167], a[200:203], v[116:119]
  v_mfma_f32_16x16x32_bf16 v[124:127], v[164:167], a[204:207], v[124:127]
  s_waitcnt lgkmcnt(4)
  ds_read_b64_tr_b16 v[164:165], v207 offset:16384
  v_mfma_f32_16x16x32_bf16 v[128:131], v[168:171], a[192:195], v[128:131]
  ds_read_b64_tr_b16 v[166:167], v207 offset:16896
  v_mfma_f32_16x16x32_bf16 v[136:139], v[168:171], a[196:199], v[136:139]
  v_mfma_f32_16x16x32_bf16 v[144:147], v[168:171], a[200:203], v[144:147]
  buffer_load_dwordx4 v235, s[88:91], s16 offen offset:3072  lds
  v_mfma_f32_16x16x32_bf16 v[152:155], v[168:171], a[204:207], v[152:155]
  ds_read_b64_tr_b16 v[168:169], v206 offset:24576
  ds_read_b64_tr_b16 v[170:171], v206 offset:25088
  v_mfma_f32_16x16x32_bf16 v[132:135], v[172:175], a[192:195], v[132:135]
  v_mfma_f32_16x16x32_bf16 v[140:143], v[172:175], a[196:199], v[140:143]
  v_mfma_f32_16x16x32_bf16 v[148:151], v[172:175], a[200:203], v[148:151]
  v_mfma_f32_16x16x32_bf16 v[156:159], v[172:175], a[204:207], v[156:159]
  ds_read_b64_tr_b16 v[172:173], v207 offset:24576
  ds_read_b64_tr_b16 v[174:175], v207 offset:25088
  v_mfma_f32_16x16x32_bf16 v[96:99], v[176:179], a[208:211], v[96:99]
  v_mfma_f32_16x16x32_bf16 v[104:107], v[176:179], a[212:215], v[104:107]
  v_mfma_f32_16x16x32_bf16 v[112:115], v[176:179], a[216:219], v[112:115]
  v_mfma_f32_16x16x32_bf16 v[120:123], v[176:179], a[220:223], v[120:123]
  v_mfma_f32_16x16x32_bf16 v[100:103], v[180:183], a[208:211], v[100:103]
  v_mfma_f32_16x16x32_bf16 v[108:111], v[180:183], a[212:215], v[108:111]
  v_mfma_f32_16x16x32_bf16 v[116:119], v[180:183], a[216:219], v[116:119]
  v_mfma_f32_16x16x32_bf16 v[124:127], v[180:183], a[220:223], v[124:127]
  v_mfma_f32_16x16x32_bf16 v[128:131], v[184:187], a[208:211], v[128:131]
  v_mfma_f32_16x16x32_bf16 v[136:139], v[184:187], a[212:215], v[136:139]
  v_mfma_f32_16x16x32_bf16 v[144:147], v[184:187], a[216:219], v[144:147]
  v_mfma_f32_16x16x32_bf16 v[152:155], v[184:187], a[220:223], v[152:155]
  s_waitcnt lgkmcnt(0)
  v_mfma_f32_16x16x32_bf16 v[132:135], v[188:191], a[208:211], v[132:135]
  v_mfma_f32_16x16x32_bf16 v[140:143], v[188:191], a[212:215], v[140:143]
  v_mfma_f32_16x16x32_bf16 v[148:151], v[188:191], a[216:219], v[148:151]
  s_waitcnt lgkmcnt(0)
  v_mfma_f32_16x16x32_bf16 v[156:159], v[188:191], a[220:223], v[156:159]
  s_branch L_join
L_slow_nA:
  s_mov_b32 s101, 1
L_spin_nA:
  s_sleep 1
  global_load_dwordx2 v[216:217], v250, s[22:23] sc1
  s_waitcnt vmcnt(0)
  v_min_u32 v251, v216, v217
  v_cmp_eq_u32 vcc, 0, v251
  s_nop 4
  s_cbranch_vccz L_back_nA
  s_add_u32 s101, s101, 1
  s_cmp_lt_u32 s101, 1000000
  s_cbranch_scc1 L_spin_nA
  s_branch L_back_nA
L_slow_nB:
  s_mov_b32 s101, 1
L_spin_nB:
  s_sleep 1
  global_load_dwordx2 v[216:217], v250, s[22:23] sc1
  s_waitcnt vmcnt(0)
  v_min_u32 v251, v216, v217
  v_cmp_eq_u32 vcc, 0, v251
  s_nop 4
  s_cbranch_vccz L_back_nB
  s_add_u32 s101, s101, 1
  s_cmp_lt_u32 s101, 1000000
  s_cbranch_scc1 L_spin_nB
  s_branch L_back_nB
L_slow_q:
  s_mov_b32 s101, 1
  s_mov_b32 s100, 15794176
  buffer_load_dwordx2 v[250:251], v246, s[52:55], s100 offen sc1
L_spin_q:
  s_sleep 2
  buffer_load_dwordx2 v[186:187], v246, s[52:55], s100 offen sc1
  s_waitcnt vmcnt(1)
  v_cmp_ne_u64 vcc, v[250:251], v[216:217]
  s_nop 4
  s_cbranch_vccz L_back_q
  s_sleep 2
  buffer_load_dwordx2 v[250:251], v246, s[52:55], s100 offen sc1
  s_waitcnt vmcnt(1)
  v_cmp_ne_u64 vcc, v[186:187], v[216:217]
  s_nop 4
  s_cbranch_vccz L_back_q
  s_add_u32 s101, s101, 1
  s_cmp_lt_u32 s101, 1000000
  s_cbranch_scc1 L_spin_q
  s_branch L_back_q
L_slow_v:
  s_mov_b32 s101, 1
  s_mov_b32 s100, 15859712
  buffer_load_dwordx2 v[250:251], v249, s[52:55], s100 offen sc1
L_spin_v:
  s_sleep 2
  buffer_load_dwordx2 v[186:187], v249, s[52:55], s100 offen sc1
  s_waitcnt vmcnt(1)
  v_cmp_ne_u64 vcc, v[250:251], v[216:217]
  s_nop 4
  s_cbranch_vccz L_back_v
  s_sleep 2
  buffer_load_dwordx2 v[250:251], v249, s[52:55], s100 offen sc1
  s_waitcnt vmcnt(1)
  v_cmp_ne_u64 vcc, v[186:187], v[216:217]
  s_nop 4
  s_cbranch_vccz L_back_v
  s_add_u32 s101, s101, 1
  s_cmp_lt_u32 s101, 1000000
  s_cbranch_scc1 L_spin_v
  s_branch L_back_v
L_slow_h:
  s_mov_b32 s101, 1
  s_mov_b32 s100, 15892480
  buffer_load_dwordx2 v[250:251], v247, s[52:55], s100 offen sc1
L_spin_h:
  s_sleep 2
  buffer_load_dwordx2 v[186:187], v247, s[52:55], s100 offen sc1
  s_waitcnt vmcnt(1)
  v_cmp_ne_u64 vcc, v[250:251], v[216:217]
  s_nop 4
  s_cbranch_vccz L_back_h
  s_sleep 2
  buffer_load_dwordx2 v[250:251], v247, s[52:55], s100 offen sc1
  s_waitcnt vmcnt(1)
  v_cmp_ne_u64 vcc, v[186:187], v[216:217]
  s_nop 4
  s_cbranch_vccz L_back_h
  s_add_u32 s101, s101, 1
  s_cmp_lt_u32 s101, 1000000
  s_cbranch_scc1 L_spin_h
  s_branch L_back_h
L_slow_o:
  s_mov_b32 s101, 1
  s_mov_b32 s100, 15794176
  buffer_load_dwordx2 v[250:251], v248, s[52:55], s100 offen sc1
L_spin_o:
  s_sleep 2
  buffer_load_dwordx2 v[186:187], v248, s[52:55], s100 offen sc1
  s_waitcnt vmcnt(1)
  v_cmp_ne_u64 vcc, v[250:251], v[216:217]
  s_nop 4
  s_cbranch_vccz L_back_o
  s_sleep 2
  buffer_load_dwordx2 v[250:251], v248, s[52:55], s100 offen sc1
  s_waitcnt vmcnt(1)
  v_cmp_ne_u64 vcc, v[186:187], v[216:217]
  s_nop 4
  s_cbranch_vccz L_back_o
  s_add_u32 s101, s101, 1
  s_cmp_lt_u32 s101, 1000000
  s_cbranch_scc1 L_spin_o
  s_branch L_back_o
L_slow_p:
  s_mov_b32 s101, 1
  s_mov_b32 s100, 15958016
  buffer_load_dwordx2 v[250:251], v245, s[52:55], s100 offen sc1
L_spin_p:
  s_sleep 2
  buffer_load_dwordx2 v[186:187], v245, s[52:55], s100 offen sc1
  s_waitcnt vmcnt(1)
  v_cmp_ne_u64 vcc, v[250:251], v[216:217]
  s_nop 4
  s_cbranch_vccz L_back_p
  s_sleep 2
  buffer_load_dwordx2 v[250:251], v245, s[52:55], s100 offen sc1
  s_waitcnt vmcnt(1)
  v_cmp_ne_u64 vcc, v[186:187], v[216:217]
  s_nop 4
  s_cbranch_vccz L_back_p
  s_add_u32 s101, s101, 1
  s_cmp_lt_u32 s101, 1000000
  s_cbranch_scc1 L_spin_p
  s_branch L_back_p
L_safe:
  s_nop 15
  v_mfma_f32_32x32x16_bf16 v[0:15], a[0:3], a[120:123], 0
  v_mfma_f32_32x32x16_bf16 v[16:31], a[32:35], a[120:123], 0
  v_mfma_f32_32x32x16_bf16 v[32:47], a[4:7], a[120:123], 0
  s_nop 10
  v_cndmask_b32 v48, v0, v16, s[28:29]
  v_cndmask_b32 v49, v1, v17, s[30:31]
  v_cndmask_b32 v50, v2, v18, s[32:33]
  v_max3_f32 v184, v48, v49, v50
  v_cndmask_b32 v51, v3, v19, s[34:35]
  v_cndmask_b32 v52, v4, v20, s[36:37]
  v_cndmask_b32 v53, v5, v21, s[38:39]
  v_max3_f32 v185, v51, v52, v53
  v_cndmask_b32 v54, v6, v22, s[40:41]
  v_cndmask_b32 v55, v7, v23, s[42:43]
  v_max3_f32 v184, v184, v54, v55
  v_cndmask_b32 v56, v8, v24, s[44:45]
  v_cndmask_b32 v57, v9, v25, s[46:47]
  v_cndmask_b32 v58, v10, v26, s[48:49]
  v_cndmask_b32 v59, v11, v27, s[50:51]
  v_cndmask_b32 v60, v12, v28, s[72:73]
  v_cndmask_b32 v61, v13, v29, s[74:75]
  v_cndmask_b32 v62, v14, v30, s[76:77]
  v_cndmask_b32 v63, v15, v31, s[78:79]
  v_mfma_f32_32x32x16_bf16 v[0:15], a[8:11], a[120:123], 0
  v_max3_f32 v185, v185, v56, v57
  v_max3_f32 v184, v184, v58, v59
  v_max3_f32 v185, v185, v60, v61
  v_max3_f32 v184, v184, v62, v63
  v_max3_f32 v184, v184, v32, v33
  v_max3_f32 v185, v185, v34, v35
  v_mfma_f32_32x32x16_bf16 v[16:31], a[12:15], a[120:123], 0
  v_max3_f32 v184, v184, v36, v37
  v_max3_f32 v185, v185, v38, v39
  v_max3_f32 v184, v184, v40, v41
  v_max3_f32 v185, v185, v42, v43
  v_max3_f32 v184, v184, v44, v45
  v_max3_f32 v185, v185, v46, v47
  v_mfma_f32_32x32x16_bf16 v[32:47], a[16:19], a[120:123], 0
  v_max3_f32 v184, v184, v0, v1
  v_max3_f32 v185, v185, v2, v3
  v_max3_f32 v184, v184, v4, v5
  v_max3_f32 v185, v185, v6, v7
  v_max3_f32 v184, v184, v8, v9
  v_max3_f32 v185, v185, v10, v11
  v_max3_f32 v184, v184, v12, v13
  v_max3_f32 v185, v185, v14, v15
  v_mfma_f32_32x32x16_bf16 v[0:15], a[20:23], a[120:123], 0
  v_max3_f32 v184, v184, v16, v17
  v_max3_f32 v185, v185, v18, v19
  v_max3_f32 v184, v184, v20, v21
  v_max3_f32 v185, v185, v22, v23
  v_max3_f32 v184, v184, v24, v25
  v_max3_f32 v185, v185, v26, v27
  v_max3_f32 v184, v184, v28, v29
  v_max3_f32 v185, v185, v30, v31
  v_mfma_f32_32x32x16_bf16 v[16:31], a[24:27], a[120:123], 0
  v_max3_f32 v184, v184, v32, v33
  v_max3_f32 v185, v185, v34, v35
  v_max3_f32 v184, v184, v36, v37
  v_max3_f32 v185, v185, v38, v39
  v_max3_f32 v184, v184, v40, v41
  v_max3_f32 v185, v185, v42, v43
  v_max3_f32 v184, v184, v44, v45
  v_max3_f32 v185, v185, v46, v47
  v_mfma_f32_32x32x16_bf16 v[32:47], a[28:31], a[120:123], 0
  v_max3_f32 v184, v184, v0, v1
  v_max3_f32 v185, v185, v2, v3
  v_max3_f32 v184, v184, v4, v5
  v_max3_f32 v185, v185, v6, v7
  v_max3_f32 v184, v184, v8, v9
  v_max3_f32 v185, v185, v10, v11
  v_max3_f32 v184, v184, v12, v13
  v_max3_f32 v185, v185, v14, v15
  v_max3_f32 v184, v184, v16, v17
  v_max3_f32 v185, v185, v18, v19
  v_max3_f32 v184, v184, v20, v21
  v_max3_f32 v185, v185, v22, v23
  v_max3_f32 v184, v184, v24, v25
  v_max3_f32 v185, v185, v26, v27
  v_max3_f32 v184, v184, v28, v29
  v_max3_f32 v185, v185, v30, v31
  v_max3_f32 v184, v184, v32, v33
  v_max3_f32 v185, v185, v34, v35
  v_max3_f32 v184, v184, v36, v37
  v_max3_f32 v185, v185, v38, v39
  v_max3_f32 v184, v184, v40, v41
  v_max3_f32 v185, v185, v42, v43
  v_max3_f32 v184, v184, v44, v45
  v_max3_f32 v185, v185, v46, v47
  v_max_f32 v184, v184, v185
  v_mov_b32 v185, v184
  s_nop 1
  v_permlane32_swap_b32 v184, v185
  v_max_f32 v184, v184, v185
  v_sub_f32 v64, 0, v184
  v_sub_f32 v65, 0, v184
  v_sub_f32 v66, 0, v184
  v_sub_f32 v67, 0, v184
  v_sub_f32 v68, 0, v184
  v_sub_f32 v69, 0, v184
  v_sub_f32 v70, 0, v184
  v_sub_f32 v71, 0, v184
  v_sub_f32 v72, 0, v184
  v_sub_f32 v73, 0, v184
  v_sub_f32 v74, 0, v184
  v_sub_f32 v75, 0, v184
  v_sub_f32 v76, 0, v184
  v_sub_f32 v77, 0, v184
  v_sub_f32 v78, 0, v184
  v_sub_f32 v79, 0, v184
  v_sub_f32 v48, v48, v184
  v_sub_f32 v49, v49, v184
  v_mfma_f32_32x32x16_bf16 v[0:15], a[4:7], a[120:123], v[64:79]
  v_exp_f32 v48, v48
  v_exp_f32 v49, v49
  v_sub_f32 v50, v50, v184
  v_sub_f32 v51, v51, v184
  v_mfma_f32_32x32x16_bf16 v[16:31], a[8:11], a[120:123], v[64:79]
  v_exp_f32 v50, v50
  v_exp_f32 v51, v51
  v_sub_f32 v52, v52, v184
  v_sub_f32 v53, v53, v184
  v_mfma_f32_32x32x16_bf16 v[32:47], a[12:15], a[120:123], v[64:79]
  v_sub_f32 v54, v54, v184
  v_sub_f32 v55, v55, v184
  v_exp_f32 v52, v52
  v_exp_f32 v53, v53
  v_exp_f32 v54, v54
  v_exp_f32 v55, v55
  v_cvt_pk_bf16_f32 v48, v48, v49
  v_cvt_pk_bf16_f32 v49, v50, v51
  v_cvt_pk_bf16_f32 v50, v52, v53
  v_cvt_pk_bf16_f32 v51, v54, v55
  v_and_b32 v176, v224, v48
  v_and_b32 v177, v225, v49
  v_and_b32 v178, v226, v50
  v_and_b32 v179, v227, v51
  v_bfi_b32 v48, v224, 0, v48
  v_bfi_b32 v49, v225, 0, v49
  v_bfi_b32 v50, v226, 0, v50
  v_bfi_b32 v51, v227, 0, v51
  v_sub_f32 v56, v56, v184
  v_sub_f32 v57, v57, v184
  v_mfma_f32_32x32x16_bf16 v[80:95], a[40:43], v[48:51], 0
  v_sub_f32 v58, v58, v184
  v_sub_f32 v59, v59, v184
  v_sub_f32 v60, v60, v184
  v_sub_f32 v61, v61, v184
  v_sub_f32 v62, v62, v184
  v_sub_f32 v63, v63, v184
  v_exp_f32 v56, v56
  v_exp_f32 v57, v57
  v_exp_f32 v58, v58
  v_exp_f32 v59, v59
  v_exp_f32 v60, v60
  v_exp_f32 v61, v61
  v_exp_f32 v62, v62
  v_exp_f32 v63, v63
  v_cvt_pk_bf16_f32 v52, v56, v57
  v_cvt_pk_bf16_f32 v53, v58, v59
  v_cvt_pk_bf16_f32 v54, v60, v61
  v_cvt_pk_bf16_f32 v55, v62, v63
  v_and_b32 v180, v228, v52
  v_and_b32 v181, v229, v53
  v_and_b32 v182, v230, v54
  v_and_b32 v183, v231, v55
  v_bfi_b32 v52, v228, 0, v52
  v_bfi_b32 v53, v229, 0, v53
  v_bfi_b32 v54, v230, 0, v54
  v_bfi_b32 v55, v231, 0, v55
  v_exp_f32 v0, v0
  v_exp_f32 v1, v1
  v_mfma_f32_32x32x16_bf16 v[80:95], a[44:47], v[52:55], v[80:95]
  v_exp_f32 v2, v2
  v_exp_f32 v3, v3
  v_exp_f32 v4, v4
  v_mfma_f32_32x32x16_bf16 v[80:95], a[104:107], v[176:179], v[80:95]
  v_exp_f32 v5, v5
  v_exp_f32 v6, v6
  v_exp_f32 v7, v7
  v_mfma_f32_32x32x16_bf16 v[80:95], a[108:111], v[180:183], v[80:95]
  v_cvt_pk_bf16_f32 v0, v0, v1
  v_cvt_pk_bf16_f32 v1, v2, v3
  v_cvt_pk_bf16_f32 v2, v4, v5
  v_cvt_pk_bf16_f32 v3, v6, v7
  v_exp_f32 v8, v8
  v_exp_f32 v9, v9
  v_mfma_f32_32x32x16_bf16 v[80:95], a[48:51], v[0:3], v[80:95]
  v_exp_f32 v10, v10
  v_exp_f32 v11, v11
  v_exp_f32 v12, v12
  v_exp_f32 v13, v13
  v_exp_f32 v14, v14
  v_exp_f32 v15, v15
  v_cvt_pk_bf16_f32 v4, v8, v9
  v_cvt_pk_bf16_f32 v5, v10, v11
  v_cvt_pk_bf16_f32 v6, v12, v13
  v_cvt_pk_bf16_f32 v7, v14, v15
  v_exp_f32 v16, v16
  v_exp_f32 v17, v17
  v_mfma_f32_32x32x16_bf16 v[80:95], a[52:55], v[4:7], v[80:95]
  v_exp_f32 v18, v18
  v_exp_f32 v19, v19
  v_exp_f32 v20, v20
  v_mfma_f32_32x32x16_bf16 v[0:15], a[16:19], a[120:123], v[64:79]
  v_exp_f32 v21, v21
  v_exp_f32 v22, v22
  v_exp_f32 v23, v23
  v_cvt_pk_bf16_f32 v16, v16, v17
  v_cvt_pk_bf16_f32 v17, v18, v19
  v_cvt_pk_bf16_f32 v18, v20, v21
  v_cvt_pk_bf16_f32 v19, v22, v23
  v_exp_f32 v24, v24
  v_exp_f32 v25, v25
  v_mfma_f32_32x32x16_bf16 v[80:95], a[56:59], v[16:19], v[80:95]
  v_exp_f32 v26, v26
  v_exp_f32 v27, v27
  v_exp_f32 v28, v28
  v_exp_f32 v29, v29
  v_exp_f32 v30, v30
  v_exp_f32 v31, v31
  v_cvt_pk_bf16_f32 v20, v24, v25
  v_cvt_pk_bf16_f32 v21, v26, v27
  v_cvt_pk_bf16_f32 v22, v28, v29
  v_cvt_pk_bf16_f32 v23, v30, v31
  v_exp_f32 v32, v32
  v_exp_f32 v33, v33
  v_mfma_f32_32x32x16_bf16 v[80:95], a[60:63], v[20:23], v[80:95]
  v_exp_f32 v34, v34
  v_exp_f32 v35, v35
  v_exp_f32 v36, v36
  v_mfma_f32_32x32x16_bf16 v[16:31], a[20:23], a[120:123], v[64:79]
  v_exp_f32 v37, v37
  v_exp_f32 v38, v38
  v_exp_f32 v39, v39
  v_cvt_pk_bf16_f32 v32, v32, v33
  v_cvt_pk_bf16_f32 v33, v34, v35
  v_cvt_pk_bf16_f32 v34, v36, v37
  v_cvt_pk_bf16_f32 v35, v38, v39
  v_exp_f32 v40, v40
  v_exp_f32 v41, v41
  v_mfma_f32_32x32x16_bf16 v[80:95], a[64:67], v[32:35], v[80:95]
  v_exp_f32 v42, v42
  v_exp_f32 v43, v43
  v_exp_f32 v44, v44
  v_exp_f32 v45, v45
  v_exp_f32 v46, v46
  v_exp_f32 v47, v47
  v_cvt_pk_bf16_f32 v36, v40, v41
  v_cvt_pk_bf16_f32 v37, v42, v43
  v_cvt_pk_bf16_f32 v38, v44, v45
  v_cvt_pk_bf16_f32 v39, v46, v47
  v_exp_f32 v0, v0
  v_exp_f32 v1, v1
  v_mfma_f32_32x32x16_bf16 v[80:95], a[68:71], v[36:39], v[80:95]
  v_exp_f32 v2, v2
  v_exp_f32 v3, v3
  v_exp_f32 v4, v4
  v_mfma_f32_32x32x16_bf16 v[32:47], a[24:27], a[120:123], v[64:79]
  v_exp_f32 v5, v5
  v_exp_f32 v6, v6
  v_exp_f32 v7, v7
  v_cvt_pk_bf16_f32 v0, v0, v1
  v_cvt_pk_bf16_f32 v1, v2, v3
  v_cvt_pk_bf16_f32 v2, v4, v5
  v_cvt_pk_bf16_f32 v3, v6, v7
  v_exp_f32 v8, v8
  v_exp_f32 v9, v9
  v_mfma_f32_32x32x16_bf16 v[80:95], a[72:75], v[0:3], v[80:95]
  v_exp_f32 v10, v10
  v_exp_f32 v11, v11
  v_exp_f32 v12, v12
  v_exp_f32 v13, v13
  v_exp_f32 v14, v14
  v_exp_f32 v15, v15
  v_cvt_pk_bf16_f32 v4, v8, v9
  v_cvt_pk_bf16_f32 v5, v10, v11
  v_cvt_pk_bf16_f32 v6, v12, v13
  v_cvt_pk_bf16_f32 v7, v14, v15
  v_exp_f32 v16, v16
  v_exp_f32 v17, v17
  v_mfma_f32_32x32x16_bf16 v[80:95], a[76:79], v[4:7], v[80:95]
  v_exp_f32 v18, v18
  v_exp_f32 v19, v19
  v_exp_f32 v20, v20
  v_mfma_f32_32x32x16_bf16 v[0:15], a[28:31], a[120:123], v[64:79]
  v_exp_f32 v21, v21
  v_exp_f32 v22, v22
  v_exp_f32 v23, v23
  v_cvt_pk_bf16_f32 v16, v16, v17
  v_cvt_pk_bf16_f32 v17, v18, v19
  v_cvt_pk_bf16_f32 v18, v20, v21
  v_cvt_pk_bf16_f32 v19, v22, v23
  v_exp_f32 v24, v24
  v_exp_f32 v25, v25
  v_mfma_f32_32x32x16_bf16 v[80:95], a[80:83], v[16:19], v[80:95]
  v_exp_f32 v26, v26
  v_exp_f32 v27, v27
  v_exp_f32 v28, v28
  v_exp_f32 v29, v29
  v_exp_f32 v30, v30
  v_exp_f32 v31, v31
  v_cvt_pk_bf16_f32 v20, v24, v25
  v_cvt_pk_bf16_f32 v21, v26, v27
  v_cvt_pk_bf16_f32 v22, v28, v29
  v_cvt_pk_bf16_f32 v23, v30, v31
  v_exp_f32 v32, v32
  v_exp_f32 v33, v33
  v_mfma_f32_32x32x16_bf16 v[80:95], a[84:87], v[20:23], v[80:95]
  v_exp_f32 v34, v34
  v_exp_f32 v35, v35
  v_exp_f32 v36, v36
  v_mfma_f32_32x32x16_bf16 v[16:31], a[4:7], a[124:127], 0
  v_exp_f32 v37, v37
  v_exp_f32 v38, v38
  v_exp_f32 v39, v39
  v_cvt_pk_bf16_f32 v32, v32, v33
  v_cvt_pk_bf16_f32 v33, v34, v35
  v_cvt_pk_bf16_f32 v34, v36, v37
  v_cvt_pk_bf16_f32 v35, v38, v39
  v_exp_f32 v40, v40
  v_exp_f32 v41, v41
  v_mfma_f32_32x32x16_bf16 v[80:95], a[88:91], v[32:35], v[80:95]
  v_exp_f32 v42, v42
  v_exp_f32 v43, v43
  v_exp_f32 v44, v44
  v_exp_f32 v45, v45
  v_exp_f32 v46, v46
  v_exp_f32 v47, v47
  v_cvt_pk_bf16_f32 v36, v40, v41
  v_cvt_pk_bf16_f32 v37, v42, v43
  v_cvt_pk_bf16_f32 v38, v44, v45
  v_cvt_pk_bf16_f32 v39, v46, v47
  v_exp_f32 v0, v0
  v_exp_f32 v1, v1
  v_mfma_f32_32x32x16_bf16 v[80:95], a[92:95], v[36:39], v[80:95]
  v_exp_f32 v2, v2
  v_exp_f32 v3, v3
  v_exp_f32 v4, v4
  v_mfma_f32_32x32x16_bf16 v[32:47], a[36:39], a[124:127], 0
  v_exp_f32 v5, v5
  v_exp_f32 v6, v6
  v_exp_f32 v7, v7
  v_cvt_pk_bf16_f32 v0, v0, v1
  v_cvt_pk_bf16_f32 v1, v2, v3
  v_cvt_pk_bf16_f32 v2, v4, v5
  v_cvt_pk_bf16_f32 v3, v6, v7
  v_exp_f32 v8, v8
  v_exp_f32 v9, v9
  v_mfma_f32_32x32x16_bf16 v[80:95], a[96:99], v[0:3], v[80:95]
  v_exp_f32 v10, v10
  v_exp_f32 v11, v11
  v_exp_f32 v12, v12
  v_exp_f32 v13, v13
  v_exp_f32 v14, v14
  v_exp_f32 v15, v15
  v_cvt_pk_bf16_f32 v4, v8, v9
  v_cvt_pk_bf16_f32 v5, v10, v11
  v_cvt_pk_bf16_f32 v6, v12, v13
  v_cvt_pk_bf16_f32 v7, v14, v15
  v_cndmask_b32 v48, v16, v32, s[28:29]
  v_cndmask_b32 v49, v17, v33, s[30:31]
  v_mfma_f32_32x32x16_bf16 v[80:95], a[100:103], v[4:7], v[80:95]
  v_cndmask_b32 v50, v18, v34, s[32:33]
  v_cndmask_b32 v51, v19, v35, s[34:35]
  v_cndmask_b32 v52, v20, v36, s[36:37]
  v_cndmask_b32 v53, v21, v37, s[38:39]
  v_cndmask_b32 v54, v22, v38, s[40:41]
  v_cndmask_b32 v55, v23, v39, s[42:43]
  v_mfma_f32_32x32x16_bf16 v[0:15], a[8:11], a[124:127], 0
  v_cndmask_b32 v56, v24, v40, s[44:45]
  v_cndmask_b32 v57, v25, v41, s[46:47]
  v_cndmask_b32 v58, v26, v42, s[48:49]
  v_cndmask_b32 v59, v27, v43, s[50:51]
  v_cndmask_b32 v60, v28, v44, s[72:73]
  v_cndmask_b32 v61, v29, v45, s[74:75]
  v_cndmask_b32 v62, v30, v46, s[76:77]
  v_cndmask_b32 v63, v31, v47, s[78:79]
  v_mfma_f32_32x32x16_bf16 v[16:31], a[12:15], a[124:127], 0
  v_max3_f32 v184, v48, v49, v50
  v_max3_f32 v185, v51, v52, v53
  v_max3_f32 v184, v184, v54, v55
  v_max3_f32 v185, v185, v56, v57
  v_max3_f32 v184, v184, v58, v59
  v_max3_f32 v185, v185, v60, v61
  v_mfma_f32_32x32x16_bf16 v[32:47], a[16:19], a[124:127], 0
  v_max3_f32 v184, v184, v62, v63
  v_max3_f32 v184, v184, v0, v1
  v_max3_f32 v185, v185, v2, v3
  v_max3_f32 v184, v184, v4, v5
  v_max3_f32 v185, v185, v6, v7
  v_max3_f32 v184, v184, v8, v9
  v_max3_f32 v185, v185, v10, v11
  v_max3_f32 v184, v184, v12, v13
  v_max3_f32 v185, v185, v14, v15
  v_mfma_f32_32x32x16_bf16 v[0:15], a[20:23], a[124:127], 0
  v_max3_f32 v184, v184, v16, v17
  v_max3_f32 v185, v185, v18, v19
  v_max3_f32 v184, v184, v20, v21
  v_max3_f32 v185, v185, v22, v23
  v_max3_f32 v184, v184, v24, v25
  v_max3_f32 v185, v185, v26, v27
  v_max3_f32 v184, v184, v28, v29
  v_max3_f32 v185, v185, v30, v31
  v_mfma_f32_32x32x16_bf16 v[16:31], a[24:27], a[124:127], 0
  v_max3_f32 v184, v184, v32, v33
  v_max3_f32 v185, v185, v34, v35
  v_max3_f32 v184, v184, v36, v37
  v_max3_f32 v185, v185, v38, v39
  v_max3_f32 v184, v184, v40, v41
  v_max3_f32 v185, v185, v42, v43
  v_max3_f32 v184, v184, v44, v45
  v_max3_f32 v185, v185, v46, v47
  v_mfma_f32_32x32x16_bf16 v[32:47], a[28:31], a[124:127], 0
  v_max3_f32 v184, v184, v0, v1
  v_max3_f32 v185, v185, v2, v3
  v_max3_f32 v184, v184, v4, v5
  v_max3_f32 v185, v185, v6, v7
  v_max3_f32 v184, v184, v8, v9
  v_max3_f32 v185, v185, v10, v11
  v_max3_f32 v184, v184, v12, v13
  v_max3_f32 v185, v185, v14, v15
  v_mfma_f32_32x32x16_bf16 v[0:15], a[32:35], a[124:127], 0
  v_max3_f32 v184, v184, v16, v17
  v_max3_f32 v185, v185, v18, v19
  v_max3_f32 v184, v184, v20, v21
  v_max3_f32 v185, v185, v22, v23
  v_max3_f32 v184, v184, v24, v25
  v_max3_f32 v185, v185, v26, v27
  v_max3_f32 v184, v184, v28, v29
  v_max3_f32 v185, v185, v30, v31
  v_max3_f32 v184, v184, v32, v33
  v_max3_f32 v185, v185, v34, v35
  v_max3_f32 v184, v184, v36, v37
  v_max3_f32 v185, v185, v38, v39
  v_max3_f32 v184, v184, v40, v41
  v_max3_f32 v185, v185, v42, v43
  v_max3_f32 v184, v184, v44, v45
  v_max3_f32 v185, v185, v46, v47
  v_max3_f32 v184, v184, v0, v1
  v_max3_f32 v185, v185, v2, v3
  v_max3_f32 v184, v184, v4, v5
  v_max3_f32 v185, v185, v6, v7
  v_max3_f32 v184, v184, v8, v9
  v_max3_f32 v185, v185, v10, v11
  v_max3_f32 v184, v184, v12, v13
  v_max3_f32 v185, v185, v14, v15
  v_max_f32 v184, v184, v185
  v_mov_b32 v185, v184
  s_nop 1
  v_permlane32_swap_b32 v184, v185
  v_max_f32 v184, v184, v185
  v_sub_f32 v64, 0, v184
  v_sub_f32 v65, 0, v184
  v_sub_f32 v66, 0, v184
  v_sub_f32 v67, 0, v184
  v_sub_f32 v68, 0, v184
  v_sub_f32 v69, 0, v184
  v_sub_f32 v70, 0, v184
  v_sub_f32 v71, 0, v184
  v_sub_f32 v72, 0, v184
  v_sub_f32 v73, 0, v184
  v_sub_f32 v74, 0, v184
  v_sub_f32 v75, 0, v184
  v_sub_f32 v76, 0, v184
  v_sub_f32 v77, 0, v184
  v_sub_f32 v78, 0, v184
  v_sub_f32 v79, 0, v184
  v_sub_f32 v48, v48, v184
  v_sub_f32 v49, v49, v184
  v_mfma_f32_32x32x16_bf16 v[16:31], a[8:11], a[124:127], v[64:79]
  v_exp_f32 v48, v48
  v_exp_f32 v49, v49
  v_sub_f32 v50, v50, v184
  v_sub_f32 v51, v51, v184
  v_mfma_f32_32x32x16_bf16 v[32:47], a[12:15], a[124:127], v[64:79]
  v_exp_f32 v50, v50
  v_exp_f32 v51, v51
  v_sub_f32 v52, v52, v184
  v_sub_f32 v53, v53, v184
  v_mfma_f32_32x32x16_bf16 v[0:15], a[16:19], a[124:127], v[64:79]
  v_sub_f32 v54, v54, v184
  v_sub_f32 v55, v55, v184
  v_exp_f32 v52, v52
  v_exp_f32 v53, v53
  v_exp_f32 v54, v54
  v_exp_f32 v55, v55
  v_cvt_pk_bf16_f32 v48, v48, v49
  v_cvt_pk_bf16_f32 v49, v50, v51
  v_cvt_pk_bf16_f32 v50, v52, v53
  v_cvt_pk_bf16_f32 v51, v54, v55
  v_and_b32 v176, v224, v48
  v_and_b32 v177, v225, v49
  v_and_b32 v178, v226, v50
  v_and_b32 v179, v227, v51
  v_bfi_b32 v48, v224, 0, v48
  v_bfi_b32 v49, v225, 0, v49
  v_bfi_b32 v50, v226, 0, v50
  v_bfi_b32 v51, v227, 0, v51
  v_sub_f32 v56, v56, v184
  v_sub_f32 v57, v57, v184
  v_mfma_f32_32x32x16_bf16 v[160:175], a[48:51], v[48:51], 0
  v_sub_f32 v58, v58, v184
  v_sub_f32 v59, v59, v184
  v_sub_f32 v60, v60, v184
  v_sub_f32 v61, v61, v184
  v_sub_f32 v62, v62, v184
  v_sub_f32 v63, v63, v184
  v_exp_f32 v56, v56
  v_exp_f32 v57, v57
  v_exp_f32 v58, v58
  v_exp_f32 v59, v59
  v_exp_f32 v60, v60
  v_exp_f32 v61, v61
  v_exp_f32 v62, v62
  v_exp_f32 v63, v63
  v_cvt_pk_bf16_f32 v52, v56, v57
  v_cvt_pk_bf16_f32 v53, v58, v59
  v_cvt_pk_bf16_f32 v54, v60, v61
  v_cvt_pk_bf16_f32 v55, v62, v63
  v_and_b32 v180, v228, v52
  v_and_b32 v181, v229, v53
  v_and_b32 v182, v230, v54
  v_and_b32 v183, v231, v55
  v_bfi_b32 v52, v228, 0, v52
  v_bfi_b32 v53, v229, 0, v53
  v_bfi_b32 v54, v230, 0, v54
  v_bfi_b32 v55, v231, 0, v55
  v_exp_f32 v16, v16
  v_exp_f32 v17, v17
  v_mfma_f32_32x32x16_bf16 v[160:175], a[52:55], v[52:55], v[160:175]
  v_exp_f32 v18, v18
  v_exp_f32 v19, v19
  v_exp_f32 v20, v20
  v_mfma_f32_32x32x16_bf16 v[160:175], a[112:115], v[176:179], v[160:175]
  v_exp_f32 v21, v21
  v_exp_f32 v22, v22
  v_exp_f32 v23, v23
  v_mfma_f32_32x32x16_bf16 v[160:175], a[116:119], v[180:183], v[160:175]
  v_cvt_pk_bf16_f32 v16, v16, v17
  v_cvt_pk_bf16_f32 v17, v18, v19
  v_cvt_pk_bf16_f32 v18, v20, v21
  v_cvt_pk_bf16_f32 v19, v22, v23
  v_exp_f32 v24, v24
  v_exp_f32 v25, v25
  v_mfma_f32_32x32x16_bf16 v[160:175], a[56:59], v[16:19], v[160:175]
  v_exp_f32 v26, v26
  v_exp_f32 v27, v27
  v_exp_f32 v28, v28
  v_exp_f32 v29, v29
  v_exp_f32 v30, v30
  v_exp_f32 v31, v31
  v_cvt_pk_bf16_f32 v20, v24, v25
  v_cvt_pk_bf16_f32 v21, v26, v27
  v_cvt_pk_bf16_f32 v22, v28, v29
  v_cvt_pk_bf16_f32 v23, v30, v31
  v_exp_f32 v32, v32
  v_exp_f32 v33, v33
  v_mfma_f32_32x32x16_bf16 v[160:175], a[60:63], v[20:23], v[160:175]
  v_exp_f32 v34, v34
  v_exp_f32 v35, v35
  v_exp_f32 v36, v36
  v_mfma_f32_32x32x16_bf16 v[16:31], a[20:23], a[124:127], v[64:79]
  v_exp_f32 v37, v37
  v_exp_f32 v38, v38
  v_exp_f32 v39, v39
  v_cvt_pk_bf16_f32 v32, v32, v33
  v_cvt_pk_bf16_f32 v33, v34, v35
  v_cvt_pk_bf16_f32 v34, v36, v37
  v_cvt_pk_bf16_f32 v35, v38, v39
  v_exp_f32 v40, v40
  v_exp_f32 v41, v41
  v_mfma_f32_32x32x16_bf16 v[160:175], a[64:67], v[32:35], v[160:175]
  v_exp_f32 v42, v42
  v_exp_f32 v43, v43
  v_exp_f32 v44, v44
  v_exp_f32 v45, v45
  v_exp_f32 v46, v46
  v_exp_f32 v47, v47
  v_cvt_pk_bf16_f32 v36, v40, v41
  v_cvt_pk_bf16_f32 v37, v42, v43
  v_cvt_pk_bf16_f32 v38, v44, v45
  v_cvt_pk_bf16_f32 v39, v46, v47
  v_exp_f32 v0, v0
  v_exp_f32 v1, v1
  v_mfma_f32_32x32x16_bf16 v[160:175], a[68:71], v[36:39], v[160:175]
  v_exp_f32 v2, v2
  v_exp_f32 v3, v3
  v_exp_f32 v4, v4
  v_mfma_f32_32x32x16_bf16 v[32:47], a[24:27], a[124:127], v[64:79]
  v_exp_f32 v5, v5
  v_exp_f32 v6, v6
  v_exp_f32 v7, v7
  v_cvt_pk_bf16_f32 v0, v0, v1
  v_cvt_pk_bf16_f32 v1, v2, v3
  v_cvt_pk_bf16_f32 v2, v4, v5
  v_cvt_pk_bf16_f32 v3, v6, v7
  v_exp_f32 v8, v8
  v_exp_f32 v9, v9
  v_mfma_f32_32x32x16_bf16 v[160:175], a[72:75], v[0:3], v[160:175]
  v_exp_f32 v10, v10
  v_exp_f32 v11, v11
  v_exp_f32 v12, v12
  v_exp_f32 v13, v13
  v_exp_f32 v14, v14
  v_exp_f32 v15, v15
  v_cvt_pk_bf16_f32 v4, v8, v9
  v_cvt_pk_bf16_f32 v5, v10, v11
  v_cvt_pk_bf16_f32 v6, v12, v13
  v_cvt_pk_bf16_f32 v7, v14, v15
  v_exp_f32 v16, v16
  v_exp_f32 v17, v17
  v_mfma_f32_32x32x16_bf16 v[160:175], a[76:79], v[4:7], v[160:175]
  v_exp_f32 v18, v18
  v_exp_f32 v19, v19
  v_exp_f32 v20, v20
  v_mfma_f32_32x32x16_bf16 v[0:15], a[28:31], a[124:127], v[64:79]
  v_exp_f32 v21, v21
  v_exp_f32 v22, v22
  v_exp_f32 v23, v23
  v_cvt_pk_bf16_f32 v16, v16, v17
  v_cvt_pk_bf16_f32 v17, v18, v19
  v_cvt_pk_bf16_f32 v18, v20, v21
  v_cvt_pk_bf16_f32 v19, v22, v23
  v_exp_f32 v24, v24
  v_exp_f32 v25, v25
  v_mfma_f32_32x32x16_bf16 v[160:175], a[80:83], v[16:19], v[160:175]
  v_exp_f32 v26, v26
  v_exp_f32 v27, v27
  v_exp_f32 v28, v28
  v_exp_f32 v29, v29
  v_exp_f32 v30, v30
  v_exp_f32 v31, v31
  v_cvt_pk_bf16_f32 v20, v24, v25
  v_cvt_pk_bf16_f32 v21, v26, v27
  v_cvt_pk_bf16_f32 v22, v28, v29
  v_cvt_pk_bf16_f32 v23, v30, v31
  v_exp_f32 v32, v32
  v_exp_f32 v33, v33
  v_mfma_f32_32x32x16_bf16 v[160:175], a[84:87], v[20:23], v[160:175]
  v_exp_f32 v34, v34
  v_exp_f32 v35, v35
  v_exp_f32 v36, v36
  v_mfma_f32_32x32x16_bf16 v[16:31], a[32:35], a[124:127], v[64:79]
  v_exp_f32 v37, v37
  v_exp_f32 v38, v38
  v_exp_f32 v39, v39
  v_cvt_pk_bf16_f32 v32, v32, v33
  v_cvt_pk_bf16_f32 v33, v34, v35
  v_cvt_pk_bf16_f32 v34, v36, v37
  v_cvt_pk_bf16_f32 v35, v38, v39
  v_exp_f32 v40, v40
  v_exp_f32 v41, v41
  v_mfma_f32_32x32x16_bf16 v[160:175], a[88:91], v[32:35], v[160:175]
  v_exp_f32 v42, v42
  v_exp_f32 v43, v43
  v_exp_f32 v44, v44
  v_exp_f32 v45, v45
  v_exp_f32 v46, v46
  v_exp_f32 v47, v47
  v_cvt_pk_bf16_f32 v36, v40, v41
  v_cvt_pk_bf16_f32 v37, v42, v43
  v_cvt_pk_bf16_f32 v38, v44, v45
  v_cvt_pk_bf16_f32 v39, v46, v47
  v_exp_f32 v0, v0
  v_exp_f32 v1, v1
  v_mfma_f32_32x32x16_bf16 v[160:175], a[92:95], v[36:39], v[160:175]
  v_exp_f32 v2, v2
  v_exp_f32 v3, v3
  v_exp_f32 v4, v4
  v_exp_f32 v5, v5
  v_exp_f32 v6, v6
  v_exp_f32 v7, v7
  v_cvt_pk_bf16_f32 v0, v0, v1
  v_cvt_pk_bf16_f32 v1, v2, v3
  v_cvt_pk_bf16_f32 v2, v4, v5
  v_cvt_pk_bf16_f32 v3, v6, v7
  v_exp_f32 v8, v8
  v_exp_f32 v9, v9
  v_mfma_f32_32x32x16_bf16 v[160:175], a[96:99], v[0:3], v[160:175]
  v_exp_f32 v10, v10
  v_exp_f32 v11, v11
  v_exp_f32 v12, v12
  v_exp_f32 v13, v13
  v_exp_f32 v14, v14
  v_exp_f32 v15, v15
  v_cvt_pk_bf16_f32 v4, v8, v9
  v_cvt_pk_bf16_f32 v5, v10, v11
  v_cvt_pk_bf16_f32 v6, v12, v13
  v_cvt_pk_bf16_f32 v7, v14, v15
  v_exp_f32 v16, v16
  v_exp_f32 v17, v17
  v_mfma_f32_32x32x16_bf16 v[160:175], a[100:103], v[4:7], v[160:175]
  v_exp_f32 v18, v18
  v_exp_f32 v19, v19
  v_exp_f32 v20, v20
  v_exp_f32 v21, v21
  v_exp_f32 v22, v22
  v_exp_f32 v23, v23
  v_cvt_pk_bf16_f32 v16, v16, v17
  v_cvt_pk_bf16_f32 v17, v18, v19
  v_cvt_pk_bf16_f32 v18, v20, v21
  v_cvt_pk_bf16_f32 v19, v22, v23
  v_exp_f32 v24, v24
  v_exp_f32 v25, v25
  v_mfma_f32_32x32x16_bf16 v[160:175], a[104:107], v[16:19], v[160:175]
  v_exp_f32 v26, v26
  v_exp_f32 v27, v27
  v_exp_f32 v28, v28
  v_exp_f32 v29, v29
  v_exp_f32 v30, v30
  v_exp_f32 v31, v31
  v_cvt_pk_bf16_f32 v20, v24, v25
  v_cvt_pk_bf16_f32 v21, v26, v27
  v_cvt_pk_bf16_f32 v22, v28, v29
  v_cvt_pk_bf16_f32 v23, v30, v31
  s_nop 1
  v_mfma_f32_32x32x16_bf16 v[160:175], a[108:111], v[20:23], v[160:175]
  s_nop 15
  s_nop 3
  s_branch L_safe_back
.section .rodata,"a"
.p2align 6
.amdhsa_kernel gated_mix__sliding_block__swiglu_ffn__prompt_kernel
  .amdhsa_next_free_vgpr 512
  .amdhsa_next_free_sgpr 102
  .amdhsa_accum_offset 256
  .amdhsa_group_segment_fixed_size 0
  .amdhsa_kernarg_size 88
  .amdhsa_user_sgpr_count 2
  .amdhsa_user_sgpr_kernarg_segment_ptr 1
  .amdhsa_system_sgpr_workgroup_id_x 1
.end_amdhsa_kernel
```
